```python
import torch

def _softmax(x, axis=-1):
    return torch.softmax(x, dim=axis)
def _gelu(x):
    return torch.nn.functional.gelu(x, approximate="tanh")
def _silu(x):
    return torch.nn.functional.silu(x)
def _sigmoid(x):
    return torch.sigmoid(x)
def _layernorm(x, axis=-1, eps=1e-5):
    m = x.mean(dim=axis, keepdim=True)
    v = x.var(dim=axis, keepdim=True, unbiased=False)
    return (x - m) / torch.sqrt(v + eps)
def _scatter_add(tgt, idx, src, axis=0):
    return tgt.clone().index_add_(axis, idx, src)
def _segment_sum(src, seg, n):
    out = torch.zeros((n,) + src.shape[1:], dtype=src.dtype)
    return out.index_add_(0, seg, src)
def _pad(x, pw):
    flat = tuple(v for pair in reversed(pw) for v in pair)
    return torch.nn.functional.pad(x, flat)

kernel_name = 'parallel_sum__grouped_kv_mqa__dense_activation_silu__prompt'

def setup_inputs():

    _w = (lambda a: (lambda t: t.to(torch.bfloat16) if t.is_floating_point() else t)(torch.as_tensor(a)))
    def _A_setup():
        B, S, D, H = 1, 2048, 576, 32
        Dh = D // H
        return {
            "x": _w((lambda *s: torch.randn(*s, dtype=torch.bfloat16) * 0.05)(B, S, D)),
            "wq": _w((lambda *s: torch.randn(*s, dtype=torch.bfloat16) * 0.05)(D, H * Dh)),
            "wk": _w((lambda *s: torch.randn(*s, dtype=torch.bfloat16) * 0.05)(D, Dh)),
            "wv": _w((lambda *s: torch.randn(*s, dtype=torch.bfloat16) * 0.05)(D, Dh)),
            "wo": _w((lambda *s: torch.randn(*s, dtype=torch.bfloat16) * 0.05)(H * Dh, D)),
        }
    _A_in = _A_setup()

    def _B_setup():
        B, S, D, F = 1, 2048, 576, 4608
        return {
            "x": _w((lambda *s: torch.randn(*s, dtype=torch.bfloat16) * 0.05)(B, S, D)),
            "w1": _w((lambda *s: torch.randn(*s, dtype=torch.bfloat16) * 1.6)(D, F) * (D ** -0.5)),
            "w2": _w((lambda *s: torch.randn(*s, dtype=torch.bfloat16) * 0.2)(F, D) * (F ** -0.5)),
        }
    _B_in = _B_setup()

    return {
        "A_x": _A_in["x"],
        "A_wq": _A_in["wq"],
        "A_wk": _A_in["wk"],
        "A_wv": _A_in["wv"],
        "A_wo": _A_in["wo"],
        "B_x": _B_in["x"],
        "B_w1": _B_in["w1"],
        "B_w2": _B_in["w2"],
    }

def reference(A_x, A_wq, A_wk, A_wv, A_wo, B_x, B_w1, B_w2):
    def _A_ref(x, wq, wk, wv, wo):
        B, S, D = x.shape
        H = 32
        Dh = D // H
        q = (lambda x, *d: x.permute(*d))((x @ wq).reshape(B, S, H, Dh), 0, 2, 1, 3)
        k = x @ wk
        v = x @ wv
        scores = torch.einsum("bhqd,bkd->bhqk", q, k) * (Dh ** -0.5)
        p = _softmax(scores, axis=-1)
        o = torch.einsum("bhqk,bkd->bhqd", p, v)
        return (lambda x, *d: x.permute(*d))(o, 0, 2, 1, 3).reshape(B, S, H * Dh) @ wo

    def _B_ref(x, w1, w2):
        h = torch.einsum("bsd,df->bsf", x, w1)
        h = _silu(h)
        out = torch.einsum("bsf,fd->bsd", h, w2)
        return out

    x = A_x
    xn = _layernorm(x, axis=-1)
    return x + _A_ref(xn, A_wq, A_wk, A_wv, A_wo) + _B_ref(xn, B_w1, B_w2)
```

```asm
; @launch grid=(256,1,1) block=(512,1,1) lds=163840
.amdgcn_target "amdgcn-amd-amdhsa--gfx950"
.text
.globl parallel_sum__grouped_kv_mqa__dense_activation_silu__prompt_kernel
.p2align 8
.type parallel_sum__grouped_kv_mqa__dense_activation_silu__prompt_kernel,@function
parallel_sum__grouped_kv_mqa__dense_activation_silu__prompt_kernel:
    s_cmp_ge_u32 s2, 256
    s_cbranch_scc1 L_END
    s_load_dwordx16 s[4:19], s[0:1], 0
    s_load_dwordx4 s[20:23], s[0:1], 64
    s_load_dwordx2 s[24:25], s[0:1], 80
    s_memrealtime s[26:27]
    s_getpc_b64 s[86:87]
L_PC:
    s_bfe_u32 s77, s2, 131075
    s_lshl_b32 s77, s77, 14
    v_lshrrev_b32 v126, 1, v0
    v_lshl_add_u32 v126, v126, 6, s77
    v_min_u32 v126, L_END-L_PC, v126
    v_mov_b32 v127, s87
    v_add_co_u32 v126, vcc, s86, v126
    s_nop 1
    v_addc_co_u32 v127, vcc, 0, v127, vcc
    global_load_dword v251, v[126:127], off
    s_bfe_u32 s64, s2, 65538
    s_lshl_b32 s64, s64, 4
    s_lshr_b32 s78, s2, 4
    s_add_u32 s64, s64, s78
    v_lshrrev_b32 v120, 3, v0
    v_and_b32 v121, 7, v0
    v_lshl_add_u32 v122, s64, 6, v120
    v_mul_u32_u24 v122, 1152, v122
    v_lshl_add_u32 v122, v121, 4, v122
    s_mov_b32 s30, 2359296
    s_mov_b32 s31, 0x20000
    v_lshrrev_b32 v119, 6, v0
    v_and_b32 v250, 63, v0
    s_waitcnt lgkmcnt(0)
    s_mov_b32 s28, s4
    s_mov_b32 s29, s5
    buffer_load_dwordx4 v[0:3], v122, s[28:31], 0 offen offset:0
    buffer_load_dwordx4 v[4:7], v122, s[28:31], 0 offen offset:128
    buffer_load_dwordx4 v[8:11], v122, s[28:31], 0 offen offset:256
    buffer_load_dwordx4 v[12:15], v122, s[28:31], 0 offen offset:384
    buffer_load_dwordx4 v[16:19], v122, s[28:31], 0 offen offset:512
    buffer_load_dwordx4 v[20:23], v122, s[28:31], 0 offen offset:640
    buffer_load_dwordx4 v[24:27], v122, s[28:31], 0 offen offset:768
    buffer_load_dwordx4 v[28:31], v122, s[28:31], 0 offen offset:896
    buffer_load_dwordx4 v[32:35], v122, s[28:31], 0 offen offset:1024
    v_readfirstlane_b32 s66, v119
    s_lshr_b32 s84, s2, 3
    s_and_b32 s65, s2, 3
    s_lshl_b32 s65, s65, 1
    s_and_b32 s78, s84, 1
    s_add_u32 s65, s65, s78
    s_mul_i32 s95, s64, 720896
    s_add_u32 s95, s95, 262144
    s_and_b32 s67, s66, 3
    v_mul_u32_u24 v123, 1040, v121
    v_lshl_add_u32 v123, v120, 4, v123
    v_add_u32 v124, 8320, v123
    v_mov_b32 v216, 0
    v_mov_b32 v217, 0
    v_mov_b32 v222, 0
    v_mov_b32 v224, 0
    s_barrier
    s_mov_b32 s32, s16
    s_mov_b32 s33, s17
    s_mov_b32 s34, 5308416
    s_mov_b32 s35, 0x20000
    s_mov_b32 s36, s18
    s_mov_b32 s37, s19
    s_mov_b32 s38, 5308416
    s_mov_b32 s39, 0x20000
    s_mov_b32 s40, s6
    s_mov_b32 s41, s7
    s_mov_b32 s42, 663552
    s_mov_b32 s43, 0x20000
    s_mov_b32 s48, s12
    s_mov_b32 s49, s13
    s_mov_b32 s50, 663552
    s_mov_b32 s51, 0x20000
    s_mov_b32 s52, s24
    s_mov_b32 s53, s25
    s_mov_b32 s54, 25296896
    s_mov_b32 s55, 0x20000
    s_mov_b32 s56, s22
    s_mov_b32 s57, s23
    s_mov_b32 s58, 256
    s_mov_b32 s59, 0x20000
    s_mov_b32 s60, s20
    s_mov_b32 s61, s21
    s_mov_b32 s62, 2359296
    s_mov_b32 s63, 0x20000
    s_cmp_ge_u32 s65, 3
    s_cselect_b32 s44, s10, s8
    s_cselect_b32 s45, s11, s9
    s_mov_b32 s46, 20736
    s_mov_b32 s47, 0x20000
    s_mov_b32 s71, 0xbfb8aa3b
    s_mov_b32 s73, 0
    s_cmp_ge_u32 s66, 4
    s_cbranch_scc1 L_PRO_A
    s_mul_i32 s79, s66, 5
    s_lshl_b32 s80, s66, 2
    s_cmp_eq_u32 s66, 3
    s_cselect_b32 s79, 14, s79
    s_cselect_b32 s80, 13, s80
    s_mul_i32 s68, s66, 15360
    s_add_u32 s68, s68, 74880
    v_lshrrev_b32 v125, 2, v250
    v_and_b32 v126, 3, v250
    s_mul_i32 s77, s65, 1152
    s_lshl_b32 s78, s79, 6
    s_add_u32 s77, s77, s78
    v_mul_u32_u24 v216, 9216, v125
    v_lshl_add_u32 v216, v126, 4, v216
    v_add_u32 v216, s77, v216
    s_and_b32 s92, s64, 15
    s_mul_i32 s92, s92, 72
    s_lshr_b32 s92, s92, 5
    s_mul_i32 s69, s92, 147456
    s_mul_i32 s77, s65, 144
    s_lshl_b32 s78, s66, 6
    s_add_u32 s77, s77, s78
    s_sub_u32 s77, s77, 128
    v_mul_u32_u24 v224, 1152, v125
    v_lshl_add_u32 v224, v126, 4, v224
    v_add_u32 v224, s77, v224
    s_mul_i32 s96, s92, 18432
    s_mul_i32 s77, s65, 663552
    s_lshl_b32 s78, s80, 6
    s_add_u32 s77, s77, s78
    v_mul_u32_u24 v217, 1152, v125
    v_lshl_add_u32 v217, v126, 4, v217
    v_add_u32 v217, s77, v217
    v_lshrrev_b32 v127, 5, v250
    v_bfe_u32 v128, v250, 2, 2
    v_bfe_u32 v129, v250, 4, 1
    v_lshlrev_b32 v129, 5, v129
    v_lshl_add_u32 v129, v126, 3, v129
    v_lshl_add_u32 v129, v128, 6, v129
    v_add_u32 v129, s68, v129
    v_lshl_add_u32 v218, v127, 9, v129
    v_lshl_add_u32 v219, v127, 8, v129
    v_and_b32 v128, 31, v250
    v_lshlrev_b32 v128, 4, v128
    v_mul_u32_u24 v223, 1040, v127
    v_add_u32 v223, v223, v128
    s_mul_i32 s77, s79, 4160
    v_add_u32 v221, s77, v223
    s_lshl_b32 s77, s80, 15
    s_lshl_b32 s78, s65, 10
    s_add_u32 s77, s77, s78
    s_add_u32 s77, s77, s95
    v_lshl_add_u32 v222, v127, 13, v128
    v_add_u32 v222, s77, v222
    v_mov_b32 v112, 0
    v_mov_b32 v113, 0
    v_mov_b32 v114, 0
    v_mov_b32 v115, 0
    s_mov_b32 s85, 0x3f803f80
    s_mov_b32 s86, 0xffff0000
    s_waitcnt vmcnt(8)
    s_cmp_ge_u32 s66, 2
    s_cbranch_scc1 PFL_1
    s_add_u32 m0, s68, 0
    s_nop 0
    buffer_load_dwordx4 v216, s[32:35], s69 offen offset:0 lds
    s_add_u32 m0, s68, 960
    s_nop 0
    buffer_load_dwordx4 v216, s[32:35], s69 offen offset:64 lds
    s_add_u32 m0, s68, 1920
    s_nop 0
    buffer_load_dwordx4 v216, s[32:35], s69 offen offset:128 lds
    s_add_u32 m0, s68, 2880
    s_nop 0
    buffer_load_dwordx4 v216, s[32:35], s69 offen offset:192 lds
    s_add_u32 m0, s68, 3840
    s_nop 0
    buffer_load_dwordx4 v216, s[32:35], s69 offen offset:256 lds
    s_add_u32 s69, s69, 147456
    s_cmp_eq_u32 s69, 5308416
    s_cselect_b32 s69, 0, s69
    s_branch PFJ_2
PFL_1:
    s_add_u32 m0, s68, 9216
    s_nop 0
    buffer_load_dwordx4 v224, s[40:43], s96 offen lds
    s_add_u32 s96, s96, 18432
    s_cmp_eq_u32 s96, 663552
    s_cselect_b32 s96, 0, s96
    s_add_u32 m0, s68, 10240
    s_nop 0
    buffer_load_dwordx4 v224, s[40:43], s96 offen lds
    s_add_u32 s96, s96, 18432
    s_cmp_eq_u32 s96, 663552
    s_cselect_b32 s96, 0, s96
    s_add_u32 m0, s68, 11264
    s_nop 0
    buffer_load_dwordx4 v224, s[40:43], s96 offen lds
    s_add_u32 s96, s96, 18432
    s_cmp_eq_u32 s96, 663552
    s_cselect_b32 s96, 0, s96
    s_add_u32 m0, s68, 12288
    s_nop 0
    buffer_load_dwordx4 v224, s[40:43], s96 offen lds
    s_add_u32 s96, s96, 18432
    s_cmp_eq_u32 s96, 663552
    s_cselect_b32 s96, 0, s96
    s_add_u32 m0, s68, 13312
    s_nop 0
    buffer_load_dwordx4 v224, s[40:43], s96 offen lds
    s_add_u32 s96, s96, 18432
    s_cmp_eq_u32 s96, 663552
    s_cselect_b32 s96, 0, s96
PFJ_2:
    v_dot2_f32_bf16 v112, v0, s85, v112
    v_lshlrev_b32 v40, 16, v0
    v_dot2_f32_bf16 v114, v0, v0, v114
    v_and_b32 v41, s86, v0
    v_dot2_f32_bf16 v113, v1, s85, v113
    v_lshlrev_b32 v42, 16, v1
    v_dot2_f32_bf16 v115, v1, v1, v115
    v_and_b32 v43, s86, v1
    v_dot2_f32_bf16 v112, v2, s85, v112
    v_lshlrev_b32 v44, 16, v2
    v_dot2_f32_bf16 v114, v2, v2, v114
    v_and_b32 v45, s86, v2
    v_dot2_f32_bf16 v113, v3, s85, v113
    v_lshlrev_b32 v46, 16, v3
    v_dot2_f32_bf16 v115, v3, v3, v115
    v_and_b32 v47, s86, v3
    s_waitcnt vmcnt(12)
    v_dot2_f32_bf16 v112, v4, s85, v112
    v_lshlrev_b32 v48, 16, v4
    v_dot2_f32_bf16 v114, v4, v4, v114
    v_and_b32 v49, s86, v4
    v_dot2_f32_bf16 v113, v5, s85, v113
    v_lshlrev_b32 v50, 16, v5
    v_dot2_f32_bf16 v115, v5, v5, v115
    v_and_b32 v51, s86, v5
    v_dot2_f32_bf16 v112, v6, s85, v112
    v_lshlrev_b32 v52, 16, v6
    v_dot2_f32_bf16 v114, v6, v6, v114
    v_and_b32 v53, s86, v6
    v_dot2_f32_bf16 v113, v7, s85, v113
    v_lshlrev_b32 v54, 16, v7
    v_dot2_f32_bf16 v115, v7, v7, v115
    v_and_b32 v55, s86, v7
    s_waitcnt vmcnt(11)
    v_dot2_f32_bf16 v112, v8, s85, v112
    v_lshlrev_b32 v56, 16, v8
    v_dot2_f32_bf16 v114, v8, v8, v114
    v_and_b32 v57, s86, v8
    v_dot2_f32_bf16 v113, v9, s85, v113
    v_lshlrev_b32 v58, 16, v9
    v_dot2_f32_bf16 v115, v9, v9, v115
    v_and_b32 v59, s86, v9
    v_dot2_f32_bf16 v112, v10, s85, v112
    v_lshlrev_b32 v60, 16, v10
    v_dot2_f32_bf16 v114, v10, v10, v114
    v_and_b32 v61, s86, v10
    v_dot2_f32_bf16 v113, v11, s85, v113
    v_lshlrev_b32 v62, 16, v11
    v_dot2_f32_bf16 v115, v11, v11, v115
    v_and_b32 v63, s86, v11
    s_waitcnt vmcnt(10)
    v_dot2_f32_bf16 v112, v12, s85, v112
    v_lshlrev_b32 v64, 16, v12
    v_dot2_f32_bf16 v114, v12, v12, v114
    v_and_b32 v65, s86, v12
    v_dot2_f32_bf16 v113, v13, s85, v113
    v_lshlrev_b32 v66, 16, v13
    v_dot2_f32_bf16 v115, v13, v13, v115
    v_and_b32 v67, s86, v13
    v_dot2_f32_bf16 v112, v14, s85, v112
    v_lshlrev_b32 v68, 16, v14
    v_dot2_f32_bf16 v114, v14, v14, v114
    v_and_b32 v69, s86, v14
    v_dot2_f32_bf16 v113, v15, s85, v113
    v_lshlrev_b32 v70, 16, v15
    v_dot2_f32_bf16 v115, v15, v15, v115
    v_and_b32 v71, s86, v15
    s_waitcnt vmcnt(9)
    v_dot2_f32_bf16 v112, v16, s85, v112
    v_lshlrev_b32 v72, 16, v16
    v_dot2_f32_bf16 v114, v16, v16, v114
    v_and_b32 v73, s86, v16
    v_dot2_f32_bf16 v113, v17, s85, v113
    v_lshlrev_b32 v74, 16, v17
    v_dot2_f32_bf16 v115, v17, v17, v115
    v_and_b32 v75, s86, v17
    v_dot2_f32_bf16 v112, v18, s85, v112
    v_lshlrev_b32 v76, 16, v18
    v_dot2_f32_bf16 v114, v18, v18, v114
    v_and_b32 v77, s86, v18
    v_dot2_f32_bf16 v113, v19, s85, v113
    v_lshlrev_b32 v78, 16, v19
    v_dot2_f32_bf16 v115, v19, v19, v115
    v_and_b32 v79, s86, v19
    s_waitcnt vmcnt(8)
    v_dot2_f32_bf16 v112, v20, s85, v112
    v_lshlrev_b32 v80, 16, v20
    v_dot2_f32_bf16 v114, v20, v20, v114
    v_and_b32 v81, s86, v20
    v_dot2_f32_bf16 v113, v21, s85, v113
    v_lshlrev_b32 v82, 16, v21
    v_dot2_f32_bf16 v115, v21, v21, v115
    v_and_b32 v83, s86, v21
    v_dot2_f32_bf16 v112, v22, s85, v112
    v_lshlrev_b32 v84, 16, v22
    v_dot2_f32_bf16 v114, v22, v22, v114
    v_and_b32 v85, s86, v22
    v_dot2_f32_bf16 v113, v23, s85, v113
    v_lshlrev_b32 v86, 16, v23
    v_dot2_f32_bf16 v115, v23, v23, v115
    v_and_b32 v87, s86, v23
    s_waitcnt vmcnt(7)
    v_dot2_f32_bf16 v112, v24, s85, v112
    v_lshlrev_b32 v88, 16, v24
    v_dot2_f32_bf16 v114, v24, v24, v114
    v_and_b32 v89, s86, v24
    v_dot2_f32_bf16 v113, v25, s85, v113
    v_lshlrev_b32 v90, 16, v25
    v_dot2_f32_bf16 v115, v25, v25, v115
    v_and_b32 v91, s86, v25
    v_dot2_f32_bf16 v112, v26, s85, v112
    v_lshlrev_b32 v92, 16, v26
    v_dot2_f32_bf16 v114, v26, v26, v114
    v_and_b32 v93, s86, v26
    v_dot2_f32_bf16 v113, v27, s85, v113
    v_lshlrev_b32 v94, 16, v27
    v_dot2_f32_bf16 v115, v27, v27, v115
    v_and_b32 v95, s86, v27
    s_waitcnt vmcnt(6)
    v_dot2_f32_bf16 v112, v28, s85, v112
    v_lshlrev_b32 v96, 16, v28
    v_dot2_f32_bf16 v114, v28, v28, v114
    v_and_b32 v97, s86, v28
    v_dot2_f32_bf16 v113, v29, s85, v113
    v_lshlrev_b32 v98, 16, v29
    v_dot2_f32_bf16 v115, v29, v29, v115
    v_and_b32 v99, s86, v29
    v_dot2_f32_bf16 v112, v30, s85, v112
    v_lshlrev_b32 v100, 16, v30
    v_dot2_f32_bf16 v114, v30, v30, v114
    v_and_b32 v101, s86, v30
    v_dot2_f32_bf16 v113, v31, s85, v113
    v_lshlrev_b32 v102, 16, v31
    v_dot2_f32_bf16 v115, v31, v31, v115
    v_and_b32 v103, s86, v31
    s_waitcnt vmcnt(5)
    v_dot2_f32_bf16 v112, v32, s85, v112
    v_lshlrev_b32 v104, 16, v32
    v_dot2_f32_bf16 v114, v32, v32, v114
    v_and_b32 v105, s86, v32
    v_dot2_f32_bf16 v113, v33, s85, v113
    v_lshlrev_b32 v106, 16, v33
    v_dot2_f32_bf16 v115, v33, v33, v115
    v_and_b32 v107, s86, v33
    v_dot2_f32_bf16 v112, v34, s85, v112
    v_lshlrev_b32 v108, 16, v34
    v_dot2_f32_bf16 v114, v34, v34, v114
    v_and_b32 v109, s86, v34
    v_dot2_f32_bf16 v113, v35, s85, v113
    v_lshlrev_b32 v110, 16, v35
    v_dot2_f32_bf16 v115, v35, v35, v115
    v_and_b32 v111, s86, v35
    s_branch L_PRO_J
L_PRO_A:
    v_mov_b32 v112, 0
    v_mov_b32 v113, 0
    v_mov_b32 v114, 0
    v_mov_b32 v115, 0
    s_mov_b32 s85, 0x3f803f80
    s_mov_b32 s86, 0xffff0000
    s_waitcnt vmcnt(8)
    s_mov_b64 exec, 7
    s_cmp_eq_u32 s67, 1
    s_cbranch_scc1 L_TLB1
    s_cmp_eq_u32 s67, 2
    s_cbranch_scc1 L_TLB2
    s_cmp_eq_u32 s67, 3
    s_cbranch_scc1 L_TLB3
    s_mov_b64 exec, 0xfff
    v_lshlrev_b32 v126, 21, v250
    v_add_u32 v126, 0x30000, v126
    buffer_load_dword v253, v126, s[52:55], 0 offen
    s_branch L_TLBD
L_TLB1:
    s_mul_i32 s78, s65, 663552
    v_mul_u32_u24 v126, 331000, v250
    buffer_load_dword v253, v126, s[36:39], s78 offen
    s_branch L_TLBD
L_TLB2:
    s_mul_i32 s77, s64, 73728
    v_mul_u32_u24 v126, 36000, v250
    buffer_load_dword v253, v126, s[60:63], s77 offen
    s_branch L_TLBD
L_TLB3:
    v_mov_b32 v126, 0
    buffer_load_dword v253, v126, s[48:51], 0 offen offset:128
L_TLBD:
    s_mov_b64 exec, -1
    v_dot2_f32_bf16 v112, v0, s85, v112
    v_lshlrev_b32 v40, 16, v0
    v_dot2_f32_bf16 v114, v0, v0, v114
    v_and_b32 v41, s86, v0
    v_dot2_f32_bf16 v113, v1, s85, v113
    v_lshlrev_b32 v42, 16, v1
    v_dot2_f32_bf16 v115, v1, v1, v115
    v_and_b32 v43, s86, v1
    v_dot2_f32_bf16 v112, v2, s85, v112
    v_lshlrev_b32 v44, 16, v2
    v_dot2_f32_bf16 v114, v2, v2, v114
    v_and_b32 v45, s86, v2
    v_dot2_f32_bf16 v113, v3, s85, v113
    v_lshlrev_b32 v46, 16, v3
    v_dot2_f32_bf16 v115, v3, v3, v115
    v_and_b32 v47, s86, v3
    s_waitcnt vmcnt(8)
    v_dot2_f32_bf16 v112, v4, s85, v112
    v_lshlrev_b32 v48, 16, v4
    v_dot2_f32_bf16 v114, v4, v4, v114
    v_and_b32 v49, s86, v4
    v_dot2_f32_bf16 v113, v5, s85, v113
    v_lshlrev_b32 v50, 16, v5
    v_dot2_f32_bf16 v115, v5, v5, v115
    v_and_b32 v51, s86, v5
    v_dot2_f32_bf16 v112, v6, s85, v112
    v_lshlrev_b32 v52, 16, v6
    v_dot2_f32_bf16 v114, v6, v6, v114
    v_and_b32 v53, s86, v6
    v_dot2_f32_bf16 v113, v7, s85, v113
    v_lshlrev_b32 v54, 16, v7
    v_dot2_f32_bf16 v115, v7, v7, v115
    v_and_b32 v55, s86, v7
    s_waitcnt vmcnt(7)
    v_dot2_f32_bf16 v112, v8, s85, v112
    v_lshlrev_b32 v56, 16, v8
    v_dot2_f32_bf16 v114, v8, v8, v114
    v_and_b32 v57, s86, v8
    v_dot2_f32_bf16 v113, v9, s85, v113
    v_lshlrev_b32 v58, 16, v9
    v_dot2_f32_bf16 v115, v9, v9, v115
    v_and_b32 v59, s86, v9
    v_dot2_f32_bf16 v112, v10, s85, v112
    v_lshlrev_b32 v60, 16, v10
    v_dot2_f32_bf16 v114, v10, v10, v114
    v_and_b32 v61, s86, v10
    v_dot2_f32_bf16 v113, v11, s85, v113
    v_lshlrev_b32 v62, 16, v11
    v_dot2_f32_bf16 v115, v11, v11, v115
    v_and_b32 v63, s86, v11
    s_waitcnt vmcnt(6)
    v_dot2_f32_bf16 v112, v12, s85, v112
    v_lshlrev_b32 v64, 16, v12
    v_dot2_f32_bf16 v114, v12, v12, v114
    v_and_b32 v65, s86, v12
    v_dot2_f32_bf16 v113, v13, s85, v113
    v_lshlrev_b32 v66, 16, v13
    v_dot2_f32_bf16 v115, v13, v13, v115
    v_and_b32 v67, s86, v13
    v_dot2_f32_bf16 v112, v14, s85, v112
    v_lshlrev_b32 v68, 16, v14
    v_dot2_f32_bf16 v114, v14, v14, v114
    v_and_b32 v69, s86, v14
    v_dot2_f32_bf16 v113, v15, s85, v113
    v_lshlrev_b32 v70, 16, v15
    v_dot2_f32_bf16 v115, v15, v15, v115
    v_and_b32 v71, s86, v15
    s_waitcnt vmcnt(5)
    v_dot2_f32_bf16 v112, v16, s85, v112
    v_lshlrev_b32 v72, 16, v16
    v_dot2_f32_bf16 v114, v16, v16, v114
    v_and_b32 v73, s86, v16
    v_dot2_f32_bf16 v113, v17, s85, v113
    v_lshlrev_b32 v74, 16, v17
    v_dot2_f32_bf16 v115, v17, v17, v115
    v_and_b32 v75, s86, v17
    v_dot2_f32_bf16 v112, v18, s85, v112
    v_lshlrev_b32 v76, 16, v18
    v_dot2_f32_bf16 v114, v18, v18, v114
    v_and_b32 v77, s86, v18
    v_dot2_f32_bf16 v113, v19, s85, v113
    v_lshlrev_b32 v78, 16, v19
    v_dot2_f32_bf16 v115, v19, v19, v115
    v_and_b32 v79, s86, v19
    s_waitcnt vmcnt(4)
    v_dot2_f32_bf16 v112, v20, s85, v112
    v_lshlrev_b32 v80, 16, v20
    v_dot2_f32_bf16 v114, v20, v20, v114
    v_and_b32 v81, s86, v20
    v_dot2_f32_bf16 v113, v21, s85, v113
    v_lshlrev_b32 v82, 16, v21
    v_dot2_f32_bf16 v115, v21, v21, v115
    v_and_b32 v83, s86, v21
    v_dot2_f32_bf16 v112, v22, s85, v112
    v_lshlrev_b32 v84, 16, v22
    v_dot2_f32_bf16 v114, v22, v22, v114
    v_and_b32 v85, s86, v22
    v_dot2_f32_bf16 v113, v23, s85, v113
    v_lshlrev_b32 v86, 16, v23
    v_dot2_f32_bf16 v115, v23, v23, v115
    v_and_b32 v87, s86, v23
    s_waitcnt vmcnt(3)
    v_dot2_f32_bf16 v112, v24, s85, v112
    v_lshlrev_b32 v88, 16, v24
    v_dot2_f32_bf16 v114, v24, v24, v114
    v_and_b32 v89, s86, v24
    v_dot2_f32_bf16 v113, v25, s85, v113
    v_lshlrev_b32 v90, 16, v25
    v_dot2_f32_bf16 v115, v25, v25, v115
    v_and_b32 v91, s86, v25
    v_dot2_f32_bf16 v112, v26, s85, v112
    v_lshlrev_b32 v92, 16, v26
    v_dot2_f32_bf16 v114, v26, v26, v114
    v_and_b32 v93, s86, v26
    v_dot2_f32_bf16 v113, v27, s85, v113
    v_lshlrev_b32 v94, 16, v27
    v_dot2_f32_bf16 v115, v27, v27, v115
    v_and_b32 v95, s86, v27
    s_waitcnt vmcnt(2)
    v_dot2_f32_bf16 v112, v28, s85, v112
    v_lshlrev_b32 v96, 16, v28
    v_dot2_f32_bf16 v114, v28, v28, v114
    v_and_b32 v97, s86, v28
    v_dot2_f32_bf16 v113, v29, s85, v113
    v_lshlrev_b32 v98, 16, v29
    v_dot2_f32_bf16 v115, v29, v29, v115
    v_and_b32 v99, s86, v29
    v_dot2_f32_bf16 v112, v30, s85, v112
    v_lshlrev_b32 v100, 16, v30
    v_dot2_f32_bf16 v114, v30, v30, v114
    v_and_b32 v101, s86, v30
    v_dot2_f32_bf16 v113, v31, s85, v113
    v_lshlrev_b32 v102, 16, v31
    v_dot2_f32_bf16 v115, v31, v31, v115
    v_and_b32 v103, s86, v31
    s_waitcnt vmcnt(1)
    s_cmp_ge_u32 s65, 3
    s_cselect_b32 s77, 3, 0
    s_sub_u32 s77, s65, s77
    s_cmp_ge_u32 s77, 3
    s_cselect_b32 s77, 0, s77
    s_lshl_b32 s78, s77, 4
    s_min_u32 s78, s78, 20
    v_mul_u32_u24 v126, 36, v250
    v_add_u32 v126, s78, v126
    s_mul_i32 s79, s67, 2304
    s_lshl_b32 s80, s67, 10
    s_add_u32 s80, s80, 145600
    s_add_u32 m0, s80, 0
    s_add_u32 s77, s79, 0
    buffer_load_dwordx4 v126, s[44:47], s77 offen lds
    s_add_u32 m0, s80, 4096
    s_add_u32 s77, s79, 9216
    buffer_load_dwordx4 v126, s[44:47], s77 offen lds
    s_mov_b32 m0, 153792
    s_mov_b32 s77, 18432
    buffer_load_dwordx4 v126, s[44:47], s77 offen lds
    v_mul_u32_u24 v125, 1152, v250
    s_mul_i32 s77, s65, 144
    s_add_u32 s77, s77, 128
    v_add_u32 v125, s77, v125
    s_mul_i32 s79, s67, 73728
    s_lshl_b32 s80, s67, 10
    s_add_u32 s80, s80, 136320
    s_add_u32 m0, s80, 0
    s_add_u32 s77, s79, 0
    buffer_load_dwordx4 v125, s[40:43], s77 offen lds
    s_add_u32 m0, s80, 4096
    s_add_u32 s77, s79, 294912
    buffer_load_dwordx4 v125, s[40:43], s77 offen lds
    s_cmp_lg_u32 s67, 1
    s_cbranch_scc1 L_PA_2
    s_mov_b32 m0, 144512
    s_mov_b32 s77, 589824
    buffer_load_dwordx4 v125, s[40:43], s77 offen lds
L_PA_2:
    v_dot2_f32_bf16 v112, v32, s85, v112
    v_lshlrev_b32 v104, 16, v32
    v_dot2_f32_bf16 v114, v32, v32, v114
    v_and_b32 v105, s86, v32
    v_dot2_f32_bf16 v113, v33, s85, v113
    v_lshlrev_b32 v106, 16, v33
    v_dot2_f32_bf16 v115, v33, v33, v115
    v_and_b32 v107, s86, v33
    v_dot2_f32_bf16 v112, v34, s85, v112
    v_lshlrev_b32 v108, 16, v34
    v_dot2_f32_bf16 v114, v34, v34, v114
    v_and_b32 v109, s86, v34
    v_dot2_f32_bf16 v113, v35, s85, v113
    v_lshlrev_b32 v110, 16, v35
    v_dot2_f32_bf16 v115, v35, v35, v115
    v_and_b32 v111, s86, v35
    s_or_b32 s77, s2, s67
    s_cmp_lg_u32 s77, 0
    s_cbranch_scc1 L_NOTAG
    s_or_b32 s77, s26, 1
    v_mov_b32 v126, s77
    v_mov_b32 v127, s27
    v_mov_b32 v128, 0
    s_mov_b64 exec, 1
    buffer_store_dwordx2 v[126:127], v128, s[56:59], 0 offen sc1
    s_mov_b64 exec, -1
L_NOTAG:
    v_lshlrev_b32 v127, 2, v250
    v_add_u32 v127, 163584, v127
    v_mov_b32 v128, 0
    ds_write_b32 v127, v128
L_PRO_J:
    s_nop 2
    v_add_f32 v112, v112, v113
    v_add_f32 v114, v114, v115
    s_nop 1
    v_add_f32_dpp v112, v112, v112 quad_perm:[1,0,3,2] row_mask:0xf bank_mask:0xf
    v_add_f32_dpp v114, v114, v114 quad_perm:[1,0,3,2] row_mask:0xf bank_mask:0xf
    s_nop 1
    v_add_f32_dpp v112, v112, v112 quad_perm:[2,3,0,1] row_mask:0xf bank_mask:0xf
    v_add_f32_dpp v114, v114, v114 quad_perm:[2,3,0,1] row_mask:0xf bank_mask:0xf
    s_nop 1
    v_add_f32_dpp v112, v112, v112 row_half_mirror row_mask:0xf bank_mask:0xf
    v_add_f32_dpp v114, v114, v114 row_half_mirror row_mask:0xf bank_mask:0xf
    s_nop 1
    v_mul_f32 v112, 0x3ae38e39, v112
    v_mul_f32 v114, 0x3ae38e39, v114
    v_fma_f32 v114, -v112, v112, v114
    v_max_f32 v114, 0, v114
    v_add_f32 v114, 0x3727c5ac, v114
    v_rsq_f32 v114, v114
    s_nop 0
    v_mul_f32 v114, s71, v114
    v_mul_f32 v112, v112, v114
    v_fma_f32 v40, v40, v114, -v112
    v_fma_f32 v41, v41, v114, -v112
    v_fma_f32 v42, v42, v114, -v112
    v_fma_f32 v43, v43, v114, -v112
    v_fma_f32 v44, v44, v114, -v112
    v_fma_f32 v45, v45, v114, -v112
    v_fma_f32 v46, v46, v114, -v112
    v_fma_f32 v47, v47, v114, -v112
    v_cvt_pk_bf16_f32 v0, v40, v41
    v_cvt_pk_bf16_f32 v1, v42, v43
    v_cvt_pk_bf16_f32 v2, v44, v45
    v_cvt_pk_bf16_f32 v3, v46, v47
    ds_write_b128 v123, v[0:3] offset:0
    v_fma_f32 v48, v48, v114, -v112
    v_fma_f32 v49, v49, v114, -v112
    v_fma_f32 v50, v50, v114, -v112
    v_fma_f32 v51, v51, v114, -v112
    v_fma_f32 v52, v52, v114, -v112
    v_fma_f32 v53, v53, v114, -v112
    v_fma_f32 v54, v54, v114, -v112
    v_fma_f32 v55, v55, v114, -v112
    v_cvt_pk_bf16_f32 v4, v48, v49
    v_cvt_pk_bf16_f32 v5, v50, v51
    v_cvt_pk_bf16_f32 v6, v52, v53
    v_cvt_pk_bf16_f32 v7, v54, v55
    ds_write_b128 v123, v[4:7] offset:8320
    v_fma_f32 v56, v56, v114, -v112
    v_fma_f32 v57, v57, v114, -v112
    v_fma_f32 v58, v58, v114, -v112
    v_fma_f32 v59, v59, v114, -v112
    v_fma_f32 v60, v60, v114, -v112
    v_fma_f32 v61, v61, v114, -v112
    v_fma_f32 v62, v62, v114, -v112
    v_fma_f32 v63, v63, v114, -v112
    v_cvt_pk_bf16_f32 v8, v56, v57
    v_cvt_pk_bf16_f32 v9, v58, v59
    v_cvt_pk_bf16_f32 v10, v60, v61
    v_cvt_pk_bf16_f32 v11, v62, v63
    ds_write_b128 v123, v[8:11] offset:16640
    v_fma_f32 v64, v64, v114, -v112
    v_fma_f32 v65, v65, v114, -v112
    v_fma_f32 v66, v66, v114, -v112
    v_fma_f32 v67, v67, v114, -v112
    v_fma_f32 v68, v68, v114, -v112
    v_fma_f32 v69, v69, v114, -v112
    v_fma_f32 v70, v70, v114, -v112
    v_fma_f32 v71, v71, v114, -v112
    v_cvt_pk_bf16_f32 v12, v64, v65
    v_cvt_pk_bf16_f32 v13, v66, v67
    v_cvt_pk_bf16_f32 v14, v68, v69
    v_cvt_pk_bf16_f32 v15, v70, v71
    ds_write_b128 v123, v[12:15] offset:24960
    v_fma_f32 v72, v72, v114, -v112
    v_fma_f32 v73, v73, v114, -v112
    v_fma_f32 v74, v74, v114, -v112
    v_fma_f32 v75, v75, v114, -v112
    v_fma_f32 v76, v76, v114, -v112
    v_fma_f32 v77, v77, v114, -v112
    v_fma_f32 v78, v78, v114, -v112
    v_fma_f32 v79, v79, v114, -v112
    v_cvt_pk_bf16_f32 v16, v72, v73
    v_cvt_pk_bf16_f32 v17, v74, v75
    v_cvt_pk_bf16_f32 v18, v76, v77
    v_cvt_pk_bf16_f32 v19, v78, v79
    ds_write_b128 v123, v[16:19] offset:33280
    v_fma_f32 v80, v80, v114, -v112
    v_fma_f32 v81, v81, v114, -v112
    v_fma_f32 v82, v82, v114, -v112
    v_fma_f32 v83, v83, v114, -v112
    v_fma_f32 v84, v84, v114, -v112
    v_fma_f32 v85, v85, v114, -v112
    v_fma_f32 v86, v86, v114, -v112
    v_fma_f32 v87, v87, v114, -v112
    v_cvt_pk_bf16_f32 v20, v80, v81
    v_cvt_pk_bf16_f32 v21, v82, v83
    v_cvt_pk_bf16_f32 v22, v84, v85
    v_cvt_pk_bf16_f32 v23, v86, v87
    ds_write_b128 v123, v[20:23] offset:41600
    v_fma_f32 v88, v88, v114, -v112
    v_fma_f32 v89, v89, v114, -v112
    v_fma_f32 v90, v90, v114, -v112
    v_fma_f32 v91, v91, v114, -v112
    v_fma_f32 v92, v92, v114, -v112
    v_fma_f32 v93, v93, v114, -v112
    v_fma_f32 v94, v94, v114, -v112
    v_fma_f32 v95, v95, v114, -v112
    v_cvt_pk_bf16_f32 v24, v88, v89
    v_cvt_pk_bf16_f32 v25, v90, v91
    v_cvt_pk_bf16_f32 v26, v92, v93
    v_cvt_pk_bf16_f32 v27, v94, v95
    ds_write_b128 v123, v[24:27] offset:49920
    v_fma_f32 v96, v96, v114, -v112
    v_fma_f32 v97, v97, v114, -v112
    v_fma_f32 v98, v98, v114, -v112
    v_fma_f32 v99, v99, v114, -v112
    v_fma_f32 v100, v100, v114, -v112
    v_fma_f32 v101, v101, v114, -v112
    v_fma_f32 v102, v102, v114, -v112
    v_fma_f32 v103, v103, v114, -v112
    v_cvt_pk_bf16_f32 v28, v96, v97
    v_cvt_pk_bf16_f32 v29, v98, v99
    v_cvt_pk_bf16_f32 v30, v100, v101
    v_cvt_pk_bf16_f32 v31, v102, v103
    ds_write_b128 v123, v[28:31] offset:58240
    v_fma_f32 v104, v104, v114, -v112
    v_fma_f32 v105, v105, v114, -v112
    v_fma_f32 v106, v106, v114, -v112
    v_fma_f32 v107, v107, v114, -v112
    v_fma_f32 v108, v108, v114, -v112
    v_fma_f32 v109, v109, v114, -v112
    v_fma_f32 v110, v110, v114, -v112
    v_fma_f32 v111, v111, v114, -v112
    v_cvt_pk_bf16_f32 v32, v104, v105
    v_cvt_pk_bf16_f32 v33, v106, v107
    v_cvt_pk_bf16_f32 v34, v108, v109
    v_cvt_pk_bf16_f32 v35, v110, v111
    ds_write_b128 v124, v[32:35] offset:58240
    s_cmp_ge_u32 s66, 4
    s_cbranch_scc1 L_ATT
    s_waitcnt lgkmcnt(0)
    s_barrier
    s_cmp_ge_u32 s66, 2
    s_cbranch_scc1 PFL_3
    s_add_u32 m0, s68, 5120
    s_nop 0
    buffer_load_dwordx4 v216, s[32:35], s69 offen offset:0 lds
    s_add_u32 m0, s68, 6080
    s_nop 0
    buffer_load_dwordx4 v216, s[32:35], s69 offen offset:64 lds
    s_add_u32 m0, s68, 7040
    s_nop 0
    buffer_load_dwordx4 v216, s[32:35], s69 offen offset:128 lds
    s_add_u32 m0, s68, 8000
    s_nop 0
    buffer_load_dwordx4 v216, s[32:35], s69 offen offset:192 lds
    s_add_u32 m0, s68, 8960
    s_nop 0
    buffer_load_dwordx4 v216, s[32:35], s69 offen offset:256 lds
    s_add_u32 s69, s69, 147456
    s_cmp_eq_u32 s69, 5308416
    s_cselect_b32 s69, 0, s69
    s_add_u32 m0, s68, 10240
    s_nop 0
    buffer_load_dwordx4 v216, s[32:35], s69 offen offset:0 lds
    s_add_u32 m0, s68, 11200
    s_nop 0
    buffer_load_dwordx4 v216, s[32:35], s69 offen offset:64 lds
    s_add_u32 m0, s68, 12160
    s_nop 0
    buffer_load_dwordx4 v216, s[32:35], s69 offen offset:128 lds
    s_add_u32 m0, s68, 13120
    s_nop 0
    buffer_load_dwordx4 v216, s[32:35], s69 offen offset:192 lds
    s_add_u32 m0, s68, 14080
    s_nop 0
    buffer_load_dwordx4 v216, s[32:35], s69 offen offset:256 lds
    s_add_u32 s69, s69, 147456
    s_cmp_eq_u32 s69, 5308416
    s_cselect_b32 s69, 0, s69
    s_branch PFJ_4
PFL_3:
    s_add_u32 m0, s68, 14336
    s_nop 0
    buffer_load_dwordx4 v224, s[40:43], s96 offen lds
    s_add_u32 s96, s96, 18432
    s_cmp_eq_u32 s96, 663552
    s_cselect_b32 s96, 0, s96
    s_add_u32 m0, s68, 0
    s_nop 0
    buffer_load_dwordx4 v224, s[40:43], s96 offen lds
    s_add_u32 s96, s96, 18432
    s_cmp_eq_u32 s96, 663552
    s_cselect_b32 s96, 0, s96
    s_add_u32 m0, s68, 1024
    s_nop 0
    buffer_load_dwordx4 v224, s[40:43], s96 offen lds
    s_add_u32 s96, s96, 18432
    s_cmp_eq_u32 s96, 663552
    s_cselect_b32 s96, 0, s96
    s_add_u32 m0, s68, 2048
    s_nop 0
    buffer_load_dwordx4 v224, s[40:43], s96 offen lds
    s_add_u32 s96, s96, 18432
    s_cmp_eq_u32 s96, 663552
    s_cselect_b32 s96, 0, s96
    s_add_u32 m0, s68, 3072
    s_nop 0
    buffer_load_dwordx4 v224, s[40:43], s96 offen lds
    s_add_u32 s96, s96, 18432
    s_cmp_eq_u32 s96, 663552
    s_cselect_b32 s96, 0, s96
    s_add_u32 m0, s68, 4096
    s_nop 0
    buffer_load_dwordx4 v224, s[40:43], s96 offen lds
    s_add_u32 s96, s96, 18432
    s_cmp_eq_u32 s96, 663552
    s_cselect_b32 s96, 0, s96
    s_add_u32 m0, s68, 5120
    s_nop 0
    buffer_load_dwordx4 v224, s[40:43], s96 offen lds
    s_add_u32 s96, s96, 18432
    s_cmp_eq_u32 s96, 663552
    s_cselect_b32 s96, 0, s96
    s_add_u32 m0, s68, 6144
    s_nop 0
    buffer_load_dwordx4 v224, s[40:43], s96 offen lds
    s_add_u32 s96, s96, 18432
    s_cmp_eq_u32 s96, 663552
    s_cselect_b32 s96, 0, s96
    s_add_u32 m0, s68, 7168
    s_nop 0
    buffer_load_dwordx4 v224, s[40:43], s96 offen lds
    s_add_u32 s96, s96, 18432
    s_cmp_eq_u32 s96, 663552
    s_cselect_b32 s96, 0, s96
    s_add_u32 m0, s68, 8192
    s_nop 0
    buffer_load_dwordx4 v224, s[40:43], s96 offen lds
    s_add_u32 s96, s96, 18432
    s_cmp_eq_u32 s96, 663552
    s_cselect_b32 s96, 0, s96
PFJ_4:
    s_setprio 1
    s_cmp_ge_u32 s66, 2
    s_cbranch_scc1 L_FFN_L
    s_mul_i32 s93, s92, 2080
    v_add_u32 v220, s93, v223
    s_add_u32 s93, s93, 2080
    s_cmp_eq_u32 s93, 74880
    s_cselect_b32 s93, 0, s93
    s_waitcnt vmcnt(10)
    ds_read_b128 v[200:203], v220 offset:0
    ds_read_b64_tr_b16 v[160:161], v218 offset:0
    ds_read_b64_tr_b16 v[162:163], v218 offset:256
    ds_read_b128 v[204:207], v220 offset:512
    ds_read_b64_tr_b16 v[164:165], v218 offset:1024
    ds_read_b64_tr_b16 v[166:167], v218 offset:1280
    ds_read_b64_tr_b16 v[168:169], v218 offset:2048
    ds_read_b64_tr_b16 v[170:171], v218 offset:2304
    ds_read_b64_tr_b16 v[172:173], v218 offset:3072
    ds_read_b64_tr_b16 v[174:175], v218 offset:3328
    ds_read_b64_tr_b16 v[176:177], v218 offset:4096
    ds_read_b64_tr_b16 v[178:179], v218 offset:4352
    s_waitcnt lgkmcnt(9)
    s_add_u32 m0, s68, 0
    v_mfma_f32_32x32x16_bf16 v[0:15], v[160:163], v[200:203], 0
    buffer_load_dwordx4 v216, s[32:35], s69 offen offset:0 lds
    s_waitcnt lgkmcnt(8)
    v_mfma_f32_32x32x16_bf16 v[16:31], v[160:163], v[204:207], 0
    v_add_u32 v220, s93, v223
    s_waitcnt vmcnt(10)
    ds_read_b128 v[208:211], v220 offset:0
    ds_read_b64_tr_b16 v[180:181], v218 offset:5120
    ds_read_b64_tr_b16 v[182:183], v218 offset:5376
    s_waitcnt lgkmcnt(9)
    s_add_u32 m0, s68, 960
    v_mfma_f32_32x32x16_bf16 v[32:47], v[164:167], v[200:203], 0
    buffer_load_dwordx4 v216, s[32:35], s69 offen offset:64 lds
    v_mfma_f32_32x32x16_bf16 v[48:63], v[164:167], v[204:207], 0
    s_waitcnt vmcnt(10)
    ds_read_b128 v[212:215], v220 offset:512
    ds_read_b64_tr_b16 v[184:185], v218 offset:6144
    ds_read_b64_tr_b16 v[186:187], v218 offset:6400
    s_waitcnt lgkmcnt(10)
    s_add_u32 m0, s68, 1920
    v_mfma_f32_32x32x16_bf16 v[64:79], v[168:171], v[200:203], 0
    buffer_load_dwordx4 v216, s[32:35], s69 offen offset:128 lds
    v_mfma_f32_32x32x16_bf16 v[80:95], v[168:171], v[204:207], 0
    s_waitcnt vmcnt(10)
    ds_read_b64_tr_b16 v[188:189], v218 offset:7168
    ds_read_b64_tr_b16 v[190:191], v218 offset:7424
    s_waitcnt lgkmcnt(10)
    s_add_u32 m0, s68, 2880
    v_mfma_f32_32x32x16_bf16 v[96:111], v[172:175], v[200:203], 0
    buffer_load_dwordx4 v216, s[32:35], s69 offen offset:192 lds
    v_mfma_f32_32x32x16_bf16 v[112:127], v[172:175], v[204:207], 0
    s_waitcnt vmcnt(10)
    ds_read_b64_tr_b16 v[192:193], v218 offset:8192
    ds_read_b64_tr_b16 v[194:195], v218 offset:8448
    s_add_u32 s93, s93, 2080
    s_cmp_eq_u32 s93, 74880
    s_cselect_b32 s93, 0, s93
    s_waitcnt lgkmcnt(10)
    s_add_u32 m0, s68, 3840
    v_mfma_f32_32x32x16_bf16 v[128:143], v[176:179], v[200:203], 0
    buffer_load_dwordx4 v216, s[32:35], s69 offen offset:256 lds
    v_mfma_f32_32x32x16_bf16 v[144:159], v[176:179], v[204:207], 0
    s_waitcnt vmcnt(10)
    ds_read_b64_tr_b16 v[196:197], v218 offset:9216
    ds_read_b64_tr_b16 v[198:199], v218 offset:9472
    s_add_u32 s69, s69, 147456
    s_cmp_eq_u32 s69, 5308416
    s_cselect_b32 s69, 0, s69
    s_mov_b32 s70, 0
    s_branch L_G1T5_1
.p2align 3
L_G1T5_3:
    s_waitcnt lgkmcnt(9)
    s_add_u32 m0, s68, 0
    v_mfma_f32_32x32x16_bf16 v[0:15], v[180:183], v[208:211], v[0:15]
    buffer_load_dwordx4 v216, s[32:35], s69 offen offset:0 lds
    s_waitcnt lgkmcnt(8)
    v_mfma_f32_32x32x16_bf16 v[16:31], v[180:183], v[212:215], v[16:31]
    v_add_u32 v220, s93, v223
    s_waitcnt vmcnt(10)
    ds_read_b128 v[200:203], v220 offset:0
    ds_read_b64_tr_b16 v[160:161], v218 offset:5120
    ds_read_b64_tr_b16 v[162:163], v218 offset:5376
    s_waitcnt lgkmcnt(9)
    s_add_u32 m0, s68, 960
    v_mfma_f32_32x32x16_bf16 v[32:47], v[184:187], v[208:211], v[32:47]
    buffer_load_dwordx4 v216, s[32:35], s69 offen offset:64 lds
    v_mfma_f32_32x32x16_bf16 v[48:63], v[184:187], v[212:215], v[48:63]
    s_waitcnt vmcnt(10)
    ds_read_b128 v[204:207], v220 offset:512
    ds_read_b64_tr_b16 v[164:165], v218 offset:6144
    ds_read_b64_tr_b16 v[166:167], v218 offset:6400
    s_waitcnt lgkmcnt(10)
    s_add_u32 m0, s68, 1920
    v_mfma_f32_32x32x16_bf16 v[64:79], v[188:191], v[208:211], v[64:79]
    buffer_load_dwordx4 v216, s[32:35], s69 offen offset:128 lds
    v_mfma_f32_32x32x16_bf16 v[80:95], v[188:191], v[212:215], v[80:95]
    s_waitcnt vmcnt(10)
    ds_read_b64_tr_b16 v[168:169], v218 offset:7168
    ds_read_b64_tr_b16 v[170:171], v218 offset:7424
    s_waitcnt lgkmcnt(10)
    s_add_u32 m0, s68, 2880
    v_mfma_f32_32x32x16_bf16 v[96:111], v[192:195], v[208:211], v[96:111]
    buffer_load_dwordx4 v216, s[32:35], s69 offen offset:192 lds
    v_mfma_f32_32x32x16_bf16 v[112:127], v[192:195], v[212:215], v[112:127]
    s_waitcnt vmcnt(10)
    ds_read_b64_tr_b16 v[172:173], v218 offset:8192
    ds_read_b64_tr_b16 v[174:175], v218 offset:8448
    s_add_u32 s93, s93, 2080
    s_cmp_eq_u32 s93, 74880
    s_cselect_b32 s93, 0, s93
    s_waitcnt lgkmcnt(10)
    s_add_u32 m0, s68, 3840
    v_mfma_f32_32x32x16_bf16 v[128:143], v[196:199], v[208:211], v[128:143]
    buffer_load_dwordx4 v216, s[32:35], s69 offen offset:256 lds
    v_mfma_f32_32x32x16_bf16 v[144:159], v[196:199], v[212:215], v[144:159]
    s_waitcnt vmcnt(10)
    ds_read_b64_tr_b16 v[176:177], v218 offset:9216
    ds_read_b64_tr_b16 v[178:179], v218 offset:9472
    s_add_u32 s69, s69, 147456
    s_cmp_eq_u32 s69, 5308416
    s_cselect_b32 s69, 0, s69
    s_waitcnt lgkmcnt(9)
    s_add_u32 m0, s68, 5120
    v_mfma_f32_32x32x16_bf16 v[0:15], v[160:163], v[200:203], v[0:15]
    buffer_load_dwordx4 v216, s[32:35], s69 offen offset:0 lds
    s_waitcnt lgkmcnt(8)
    v_mfma_f32_32x32x16_bf16 v[16:31], v[160:163], v[204:207], v[16:31]
    v_add_u32 v220, s93, v223
    s_waitcnt vmcnt(10)
    ds_read_b128 v[208:211], v220 offset:0
    ds_read_b64_tr_b16 v[180:181], v218 offset:10240
    ds_read_b64_tr_b16 v[182:183], v218 offset:10496
    s_waitcnt lgkmcnt(9)
    s_add_u32 m0, s68, 6080
    v_mfma_f32_32x32x16_bf16 v[32:47], v[164:167], v[200:203], v[32:47]
    buffer_load_dwordx4 v216, s[32:35], s69 offen offset:64 lds
    v_mfma_f32_32x32x16_bf16 v[48:63], v[164:167], v[204:207], v[48:63]
    s_waitcnt vmcnt(10)
    ds_read_b128 v[212:215], v220 offset:512
    ds_read_b64_tr_b16 v[184:185], v218 offset:11264
    ds_read_b64_tr_b16 v[186:187], v218 offset:11520
    s_waitcnt lgkmcnt(10)
    s_add_u32 m0, s68, 7040
    v_mfma_f32_32x32x16_bf16 v[64:79], v[168:171], v[200:203], v[64:79]
    buffer_load_dwordx4 v216, s[32:35], s69 offen offset:128 lds
    v_mfma_f32_32x32x16_bf16 v[80:95], v[168:171], v[204:207], v[80:95]
    s_waitcnt vmcnt(10)
    ds_read_b64_tr_b16 v[188:189], v218 offset:12288
    ds_read_b64_tr_b16 v[190:191], v218 offset:12544
    s_waitcnt lgkmcnt(10)
    s_add_u32 m0, s68, 8000
    v_mfma_f32_32x32x16_bf16 v[96:111], v[172:175], v[200:203], v[96:111]
    buffer_load_dwordx4 v216, s[32:35], s69 offen offset:192 lds
    v_mfma_f32_32x32x16_bf16 v[112:127], v[172:175], v[204:207], v[112:127]
    s_waitcnt vmcnt(10)
    ds_read_b64_tr_b16 v[192:193], v218 offset:13312
    ds_read_b64_tr_b16 v[194:195], v218 offset:13568
    s_add_u32 s93, s93, 2080
    s_cmp_eq_u32 s93, 74880
    s_cselect_b32 s93, 0, s93
    s_waitcnt lgkmcnt(10)
    s_add_u32 m0, s68, 8960
    v_mfma_f32_32x32x16_bf16 v[128:143], v[176:179], v[200:203], v[128:143]
    buffer_load_dwordx4 v216, s[32:35], s69 offen offset:256 lds
    v_mfma_f32_32x32x16_bf16 v[144:159], v[176:179], v[204:207], v[144:159]
    s_waitcnt vmcnt(10)
    ds_read_b64_tr_b16 v[196:197], v218 offset:14336
    ds_read_b64_tr_b16 v[198:199], v218 offset:14592
    s_add_u32 s69, s69, 147456
    s_cmp_eq_u32 s69, 5308416
    s_cselect_b32 s69, 0, s69
    s_waitcnt lgkmcnt(9)
    s_add_u32 m0, s68, 10240
    v_mfma_f32_32x32x16_bf16 v[0:15], v[180:183], v[208:211], v[0:15]
    buffer_load_dwordx4 v216, s[32:35], s69 offen offset:0 lds
    s_waitcnt lgkmcnt(8)
    v_mfma_f32_32x32x16_bf16 v[16:31], v[180:183], v[212:215], v[16:31]
    v_add_u32 v220, s93, v223
    s_waitcnt vmcnt(10)
    ds_read_b128 v[200:203], v220 offset:0
    ds_read_b64_tr_b16 v[160:161], v218 offset:0
    ds_read_b64_tr_b16 v[162:163], v218 offset:256
    s_waitcnt lgkmcnt(9)
    s_add_u32 m0, s68, 11200
    v_mfma_f32_32x32x16_bf16 v[32:47], v[184:187], v[208:211], v[32:47]
    buffer_load_dwordx4 v216, s[32:35], s69 offen offset:64 lds
    v_mfma_f32_32x32x16_bf16 v[48:63], v[184:187], v[212:215], v[48:63]
    s_waitcnt vmcnt(10)
    ds_read_b128 v[204:207], v220 offset:512
    ds_read_b64_tr_b16 v[164:165], v218 offset:1024
    ds_read_b64_tr_b16 v[166:167], v218 offset:1280
    s_waitcnt lgkmcnt(10)
    s_add_u32 m0, s68, 12160
    v_mfma_f32_32x32x16_bf16 v[64:79], v[188:191], v[208:211], v[64:79]
    buffer_load_dwordx4 v216, s[32:35], s69 offen offset:128 lds
    v_mfma_f32_32x32x16_bf16 v[80:95], v[188:191], v[212:215], v[80:95]
    s_waitcnt vmcnt(10)
    ds_read_b64_tr_b16 v[168:169], v218 offset:2048
    ds_read_b64_tr_b16 v[170:171], v218 offset:2304
    s_waitcnt lgkmcnt(10)
    s_add_u32 m0, s68, 13120
    v_mfma_f32_32x32x16_bf16 v[96:111], v[192:195], v[208:211], v[96:111]
    buffer_load_dwordx4 v216, s[32:35], s69 offen offset:192 lds
    v_mfma_f32_32x32x16_bf16 v[112:127], v[192:195], v[212:215], v[112:127]
    s_waitcnt vmcnt(10)
    ds_read_b64_tr_b16 v[172:173], v218 offset:3072
    ds_read_b64_tr_b16 v[174:175], v218 offset:3328
    s_add_u32 s93, s93, 2080
    s_cmp_eq_u32 s93, 74880
    s_cselect_b32 s93, 0, s93
    s_waitcnt lgkmcnt(10)
    s_add_u32 m0, s68, 14080
    v_mfma_f32_32x32x16_bf16 v[128:143], v[196:199], v[208:211], v[128:143]
    buffer_load_dwordx4 v216, s[32:35], s69 offen offset:256 lds
    v_mfma_f32_32x32x16_bf16 v[144:159], v[196:199], v[212:215], v[144:159]
    s_waitcnt vmcnt(10)
    ds_read_b64_tr_b16 v[176:177], v218 offset:4096
    ds_read_b64_tr_b16 v[178:179], v218 offset:4352
    s_add_u32 s69, s69, 147456
    s_cmp_eq_u32 s69, 5308416
    s_cselect_b32 s69, 0, s69
    s_waitcnt lgkmcnt(9)
    s_add_u32 m0, s68, 0
    v_mfma_f32_32x32x16_bf16 v[0:15], v[160:163], v[200:203], v[0:15]
    buffer_load_dwordx4 v216, s[32:35], s69 offen offset:0 lds
    s_waitcnt lgkmcnt(8)
    v_mfma_f32_32x32x16_bf16 v[16:31], v[160:163], v[204:207], v[16:31]
    v_add_u32 v220, s93, v223
    s_waitcnt vmcnt(10)
    ds_read_b128 v[208:211], v220 offset:0
    ds_read_b64_tr_b16 v[180:181], v218 offset:5120
    ds_read_b64_tr_b16 v[182:183], v218 offset:5376
    s_waitcnt lgkmcnt(9)
    s_add_u32 m0, s68, 960
    v_mfma_f32_32x32x16_bf16 v[32:47], v[164:167], v[200:203], v[32:47]
    buffer_load_dwordx4 v216, s[32:35], s69 offen offset:64 lds
    v_mfma_f32_32x32x16_bf16 v[48:63], v[164:167], v[204:207], v[48:63]
    s_waitcnt vmcnt(10)
    ds_read_b128 v[212:215], v220 offset:512
    ds_read_b64_tr_b16 v[184:185], v218 offset:6144
    ds_read_b64_tr_b16 v[186:187], v218 offset:6400
    s_waitcnt lgkmcnt(10)
    s_add_u32 m0, s68, 1920
    v_mfma_f32_32x32x16_bf16 v[64:79], v[168:171], v[200:203], v[64:79]
    buffer_load_dwordx4 v216, s[32:35], s69 offen offset:128 lds
    v_mfma_f32_32x32x16_bf16 v[80:95], v[168:171], v[204:207], v[80:95]
    s_waitcnt vmcnt(10)
    ds_read_b64_tr_b16 v[188:189], v218 offset:7168
    ds_read_b64_tr_b16 v[190:191], v218 offset:7424
    s_waitcnt lgkmcnt(10)
    s_add_u32 m0, s68, 2880
    v_mfma_f32_32x32x16_bf16 v[96:111], v[172:175], v[200:203], v[96:111]
    buffer_load_dwordx4 v216, s[32:35], s69 offen offset:192 lds
    v_mfma_f32_32x32x16_bf16 v[112:127], v[172:175], v[204:207], v[112:127]
    s_waitcnt vmcnt(10)
    ds_read_b64_tr_b16 v[192:193], v218 offset:8192
    ds_read_b64_tr_b16 v[194:195], v218 offset:8448
    s_add_u32 s93, s93, 2080
    s_cmp_eq_u32 s93, 74880
    s_cselect_b32 s93, 0, s93
    s_waitcnt lgkmcnt(10)
    s_add_u32 m0, s68, 3840
    v_mfma_f32_32x32x16_bf16 v[128:143], v[176:179], v[200:203], v[128:143]
    buffer_load_dwordx4 v216, s[32:35], s69 offen offset:256 lds
    v_mfma_f32_32x32x16_bf16 v[144:159], v[176:179], v[204:207], v[144:159]
    s_waitcnt vmcnt(10)
    ds_read_b64_tr_b16 v[196:197], v218 offset:9216
    ds_read_b64_tr_b16 v[198:199], v218 offset:9472
    s_add_u32 s69, s69, 147456
    s_cmp_eq_u32 s69, 5308416
    s_cselect_b32 s69, 0, s69
L_G1T5_1:
    s_waitcnt lgkmcnt(9)
    s_add_u32 m0, s68, 5120
    v_mfma_f32_32x32x16_bf16 v[0:15], v[180:183], v[208:211], v[0:15]
    buffer_load_dwordx4 v216, s[32:35], s69 offen offset:0 lds
    s_waitcnt lgkmcnt(8)
    v_mfma_f32_32x32x16_bf16 v[16:31], v[180:183], v[212:215], v[16:31]
    v_add_u32 v220, s93, v223
    s_waitcnt vmcnt(10)
    ds_read_b128 v[200:203], v220 offset:0
    ds_read_b64_tr_b16 v[160:161], v218 offset:10240
    ds_read_b64_tr_b16 v[162:163], v218 offset:10496
    s_waitcnt lgkmcnt(9)
    s_add_u32 m0, s68, 6080
    v_mfma_f32_32x32x16_bf16 v[32:47], v[184:187], v[208:211], v[32:47]
    buffer_load_dwordx4 v216, s[32:35], s69 offen offset:64 lds
    v_mfma_f32_32x32x16_bf16 v[48:63], v[184:187], v[212:215], v[48:63]
    s_waitcnt vmcnt(10)
    ds_read_b128 v[204:207], v220 offset:512
    ds_read_b64_tr_b16 v[164:165], v218 offset:11264
    ds_read_b64_tr_b16 v[166:167], v218 offset:11520
    s_waitcnt lgkmcnt(10)
    s_add_u32 m0, s68, 7040
    v_mfma_f32_32x32x16_bf16 v[64:79], v[188:191], v[208:211], v[64:79]
    buffer_load_dwordx4 v216, s[32:35], s69 offen offset:128 lds
    v_mfma_f32_32x32x16_bf16 v[80:95], v[188:191], v[212:215], v[80:95]
    s_waitcnt vmcnt(10)
    ds_read_b64_tr_b16 v[168:169], v218 offset:12288
    ds_read_b64_tr_b16 v[170:171], v218 offset:12544
    s_waitcnt lgkmcnt(10)
    s_add_u32 m0, s68, 8000
    v_mfma_f32_32x32x16_bf16 v[96:111], v[192:195], v[208:211], v[96:111]
    buffer_load_dwordx4 v216, s[32:35], s69 offen offset:192 lds
    v_mfma_f32_32x32x16_bf16 v[112:127], v[192:195], v[212:215], v[112:127]
    s_waitcnt vmcnt(10)
    ds_read_b64_tr_b16 v[172:173], v218 offset:13312
    ds_read_b64_tr_b16 v[174:175], v218 offset:13568
    s_add_u32 s93, s93, 2080
    s_cmp_eq_u32 s93, 74880
    s_cselect_b32 s93, 0, s93
    s_waitcnt lgkmcnt(10)
    s_add_u32 m0, s68, 8960
    v_mfma_f32_32x32x16_bf16 v[128:143], v[196:199], v[208:211], v[128:143]
    buffer_load_dwordx4 v216, s[32:35], s69 offen offset:256 lds
    v_mfma_f32_32x32x16_bf16 v[144:159], v[196:199], v[212:215], v[144:159]
    s_waitcnt vmcnt(10)
    ds_read_b64_tr_b16 v[176:177], v218 offset:14336
    ds_read_b64_tr_b16 v[178:179], v218 offset:14592
    s_add_u32 s69, s69, 147456
    s_cmp_eq_u32 s69, 5308416
    s_cselect_b32 s69, 0, s69
    s_waitcnt lgkmcnt(9)
    s_add_u32 m0, s68, 10240
    v_mfma_f32_32x32x16_bf16 v[0:15], v[160:163], v[200:203], v[0:15]
    buffer_load_dwordx4 v216, s[32:35], s69 offen offset:0 lds
    s_waitcnt lgkmcnt(8)
    v_mfma_f32_32x32x16_bf16 v[16:31], v[160:163], v[204:207], v[16:31]
    v_add_u32 v220, s93, v223
    s_waitcnt vmcnt(10)
    ds_read_b128 v[208:211], v220 offset:0
    ds_read_b64_tr_b16 v[180:181], v218 offset:0
    ds_read_b64_tr_b16 v[182:183], v218 offset:256
    s_waitcnt lgkmcnt(9)
    s_add_u32 m0, s68, 11200
    v_mfma_f32_32x32x16_bf16 v[32:47], v[164:167], v[200:203], v[32:47]
    buffer_load_dwordx4 v216, s[32:35], s69 offen offset:64 lds
    v_mfma_f32_32x32x16_bf16 v[48:63], v[164:167], v[204:207], v[48:63]
    s_waitcnt vmcnt(10)
    ds_read_b128 v[212:215], v220 offset:512
    ds_read_b64_tr_b16 v[184:185], v218 offset:1024
    ds_read_b64_tr_b16 v[186:187], v218 offset:1280
    s_waitcnt lgkmcnt(10)
    s_add_u32 m0, s68, 12160
    v_mfma_f32_32x32x16_bf16 v[64:79], v[168:171], v[200:203], v[64:79]
    buffer_load_dwordx4 v216, s[32:35], s69 offen offset:128 lds
    v_mfma_f32_32x32x16_bf16 v[80:95], v[168:171], v[204:207], v[80:95]
    s_waitcnt vmcnt(10)
    ds_read_b64_tr_b16 v[188:189], v218 offset:2048
    ds_read_b64_tr_b16 v[190:191], v218 offset:2304
    s_waitcnt lgkmcnt(10)
    s_add_u32 m0, s68, 13120
    v_mfma_f32_32x32x16_bf16 v[96:111], v[172:175], v[200:203], v[96:111]
    buffer_load_dwordx4 v216, s[32:35], s69 offen offset:192 lds
    v_mfma_f32_32x32x16_bf16 v[112:127], v[172:175], v[204:207], v[112:127]
    s_waitcnt vmcnt(10)
    ds_read_b64_tr_b16 v[192:193], v218 offset:3072
    ds_read_b64_tr_b16 v[194:195], v218 offset:3328
    s_add_u32 s93, s93, 2080
    s_cmp_eq_u32 s93, 74880
    s_cselect_b32 s93, 0, s93
    s_waitcnt lgkmcnt(10)
    s_add_u32 m0, s68, 14080
    v_mfma_f32_32x32x16_bf16 v[128:143], v[176:179], v[200:203], v[128:143]
    buffer_load_dwordx4 v216, s[32:35], s69 offen offset:256 lds
    v_mfma_f32_32x32x16_bf16 v[144:159], v[176:179], v[204:207], v[144:159]
    s_waitcnt vmcnt(10)
    ds_read_b64_tr_b16 v[196:197], v218 offset:4096
    ds_read_b64_tr_b16 v[198:199], v218 offset:4352
    s_add_u32 s69, s69, 147456
    s_cmp_eq_u32 s69, 5308416
    s_cselect_b32 s69, 0, s69
    s_add_u32 s70, s70, 1
    s_cmp_lt_u32 s70, 6
    s_cbranch_scc1 L_G1T5_3
    s_mul_i32 s69, s92, 18432
    s_waitcnt lgkmcnt(9)
    s_add_u32 m0, s68, 0
    v_mfma_f32_32x32x16_bf16 v[0:15], v[180:183], v[208:211], v[0:15]
    buffer_load_dwordx4 v217, s[36:39], s69 offen offset:0 lds
    s_waitcnt lgkmcnt(8)
    v_mfma_f32_32x32x16_bf16 v[16:31], v[180:183], v[212:215], v[16:31]
    v_add_u32 v220, s93, v223
    s_waitcnt vmcnt(10)
    ds_read_b128 v[200:203], v220 offset:0
    ds_read_b64_tr_b16 v[160:161], v218 offset:5120
    ds_read_b64_tr_b16 v[162:163], v218 offset:5376
    s_waitcnt lgkmcnt(9)
    s_add_u32 m0, s68, 960
    v_mfma_f32_32x32x16_bf16 v[32:47], v[184:187], v[208:211], v[32:47]
    buffer_load_dwordx4 v217, s[36:39], s69 offen offset:64 lds
    v_mfma_f32_32x32x16_bf16 v[48:63], v[184:187], v[212:215], v[48:63]
    s_waitcnt vmcnt(10)
    ds_read_b128 v[204:207], v220 offset:512
    ds_read_b64_tr_b16 v[164:165], v218 offset:6144
    ds_read_b64_tr_b16 v[166:167], v218 offset:6400
    s_waitcnt lgkmcnt(10)
    s_add_u32 m0, s68, 1920
    v_mfma_f32_32x32x16_bf16 v[64:79], v[188:191], v[208:211], v[64:79]
    buffer_load_dwordx4 v217, s[36:39], s69 offen offset:128 lds
    v_mfma_f32_32x32x16_bf16 v[80:95], v[188:191], v[212:215], v[80:95]
    s_waitcnt vmcnt(10)
    ds_read_b64_tr_b16 v[168:169], v218 offset:7168
    ds_read_b64_tr_b16 v[170:171], v218 offset:7424
    s_waitcnt lgkmcnt(10)
    s_add_u32 m0, s68, 2880
    v_mfma_f32_32x32x16_bf16 v[96:111], v[192:195], v[208:211], v[96:111]
    buffer_load_dwordx4 v217, s[36:39], s69 offen offset:192 lds
    v_mfma_f32_32x32x16_bf16 v[112:127], v[192:195], v[212:215], v[112:127]
    s_waitcnt vmcnt(10)
    ds_read_b64_tr_b16 v[172:173], v218 offset:8192
    ds_read_b64_tr_b16 v[174:175], v218 offset:8448
    s_add_u32 s93, s93, 2080
    s_cmp_eq_u32 s93, 74880
    s_cselect_b32 s93, 0, s93
    s_waitcnt lgkmcnt(10)
    v_mfma_f32_32x32x16_bf16 v[128:143], v[196:199], v[208:211], v[128:143]
    v_mfma_f32_32x32x16_bf16 v[144:159], v[196:199], v[212:215], v[144:159]
    s_waitcnt vmcnt(9)
    ds_read_b64_tr_b16 v[176:177], v218 offset:9216
    ds_read_b64_tr_b16 v[178:179], v218 offset:9472
    s_add_u32 s69, s69, 18432
    s_cmp_eq_u32 s69, 663552
    s_cselect_b32 s69, 0, s69
    s_waitcnt lgkmcnt(9)
    s_add_u32 m0, s68, 5120
    v_mfma_f32_32x32x16_bf16 v[0:15], v[160:163], v[200:203], v[0:15]
    buffer_load_dwordx4 v217, s[36:39], s69 offen offset:0 lds
    s_waitcnt lgkmcnt(8)
    v_mfma_f32_32x32x16_bf16 v[16:31], v[160:163], v[204:207], v[16:31]
    v_add_u32 v220, s93, v223
    s_waitcnt vmcnt(9)
    ds_read_b128 v[208:211], v220 offset:0
    ds_read_b64_tr_b16 v[180:181], v218 offset:10240
    ds_read_b64_tr_b16 v[182:183], v218 offset:10496
    s_waitcnt lgkmcnt(9)
    s_add_u32 m0, s68, 6080
    v_mfma_f32_32x32x16_bf16 v[32:47], v[164:167], v[200:203], v[32:47]
    buffer_load_dwordx4 v217, s[36:39], s69 offen offset:64 lds
    v_mfma_f32_32x32x16_bf16 v[48:63], v[164:167], v[204:207], v[48:63]
    s_waitcnt vmcnt(9)
    ds_read_b128 v[212:215], v220 offset:512
    ds_read_b64_tr_b16 v[184:185], v218 offset:11264
    ds_read_b64_tr_b16 v[186:187], v218 offset:11520
    s_waitcnt lgkmcnt(10)
    s_add_u32 m0, s68, 7040
    v_mfma_f32_32x32x16_bf16 v[64:79], v[168:171], v[200:203], v[64:79]
    buffer_load_dwordx4 v217, s[36:39], s69 offen offset:128 lds
    v_mfma_f32_32x32x16_bf16 v[80:95], v[168:171], v[204:207], v[80:95]
    s_waitcnt vmcnt(9)
    ds_read_b64_tr_b16 v[188:189], v218 offset:12288
    ds_read_b64_tr_b16 v[190:191], v218 offset:12544
    s_waitcnt lgkmcnt(10)
    s_add_u32 m0, s68, 8000
    v_mfma_f32_32x32x16_bf16 v[96:111], v[172:175], v[200:203], v[96:111]
    buffer_load_dwordx4 v217, s[36:39], s69 offen offset:192 lds
    v_mfma_f32_32x32x16_bf16 v[112:127], v[172:175], v[204:207], v[112:127]
    s_waitcnt vmcnt(9)
    ds_read_b64_tr_b16 v[192:193], v218 offset:13312
    ds_read_b64_tr_b16 v[194:195], v218 offset:13568
    s_waitcnt lgkmcnt(10)
    v_mfma_f32_32x32x16_bf16 v[128:143], v[176:179], v[200:203], v[128:143]
    v_mfma_f32_32x32x16_bf16 v[144:159], v[176:179], v[204:207], v[144:159]
    s_waitcnt vmcnt(8)
    ds_read_b64_tr_b16 v[196:197], v218 offset:14336
    ds_read_b64_tr_b16 v[198:199], v218 offset:14592
    s_add_u32 s69, s69, 18432
    s_cmp_eq_u32 s69, 663552
    s_cselect_b32 s69, 0, s69
    s_waitcnt lgkmcnt(9)
    s_add_u32 m0, s68, 10240
    v_mfma_f32_32x32x16_bf16 v[0:15], v[180:183], v[208:211], v[0:15]
    buffer_load_dwordx4 v217, s[36:39], s69 offen offset:0 lds
    s_waitcnt lgkmcnt(8)
    v_mfma_f32_32x32x16_bf16 v[16:31], v[180:183], v[212:215], v[16:31]
    s_waitcnt lgkmcnt(6)
    s_add_u32 m0, s68, 11200
    v_mfma_f32_32x32x16_bf16 v[32:47], v[184:187], v[208:211], v[32:47]
    buffer_load_dwordx4 v217, s[36:39], s69 offen offset:64 lds
    v_mfma_f32_32x32x16_bf16 v[48:63], v[184:187], v[212:215], v[48:63]
    s_waitcnt lgkmcnt(4)
    s_add_u32 m0, s68, 12160
    v_mfma_f32_32x32x16_bf16 v[64:79], v[188:191], v[208:211], v[64:79]
    buffer_load_dwordx4 v217, s[36:39], s69 offen offset:128 lds
    v_mfma_f32_32x32x16_bf16 v[80:95], v[188:191], v[212:215], v[80:95]
    s_waitcnt lgkmcnt(2)
    s_add_u32 m0, s68, 13120
    v_mfma_f32_32x32x16_bf16 v[96:111], v[192:195], v[208:211], v[96:111]
    buffer_load_dwordx4 v217, s[36:39], s69 offen offset:192 lds
    v_mfma_f32_32x32x16_bf16 v[112:127], v[192:195], v[212:215], v[112:127]
    s_waitcnt lgkmcnt(0)
    v_mfma_f32_32x32x16_bf16 v[128:143], v[196:199], v[208:211], v[128:143]
    v_mfma_f32_32x32x16_bf16 v[144:159], v[196:199], v[212:215], v[144:159]
    s_add_u32 s69, s69, 18432
    s_cmp_eq_u32 s69, 663552
    s_cselect_b32 s69, 0, s69
    v_mov_b32 v252, 163584
    v_mov_b32 v253, 1
    s_mov_b64 exec, 1
    ds_add_u32 v252, v253 offset:12
    s_mov_b64 exec, -1
    s_lshl_b32 s77, s66, 6
    v_add_u32 v176, s77, v250
    v_lshrrev_b32 v177, 2, v176
    v_and_b32 v178, 3, v176
    v_mul_u32_u24 v177, 1152, v177
    v_cmp_gt_u32 vcc, 144, v176
    v_mul_u32_u24 v178, 52, v178
    v_add_u32 v177, v177, v178
    v_mov_b32 v178, 1073741824
    v_cndmask_b32 v177, v178, v177, vcc
    s_and_b32 s78, s64, 15
    s_mul_i32 s78, s78, 41472
    s_mul_i32 s77, s65, 144
    s_add_u32 s78, s78, s77
    buffer_load_dword v230, v177, s[48:51], s78 offen
    s_nop 1
    v_exp_f32 v160, v0
    v_exp_f32 v161, v1
    v_exp_f32 v162, v2
    v_exp_f32 v163, v3
    v_exp_f32 v164, v4
    v_exp_f32 v165, v5
    v_exp_f32 v166, v6
    v_exp_f32 v167, v7
    v_pk_add_f32 v[160:161], v[160:161], 1.0 op_sel_hi:[1,0]
    v_pk_add_f32 v[162:163], v[162:163], 1.0 op_sel_hi:[1,0]
    v_pk_add_f32 v[164:165], v[164:165], 1.0 op_sel_hi:[1,0]
    v_pk_add_f32 v[166:167], v[166:167], 1.0 op_sel_hi:[1,0]
    v_rcp_f32 v160, v160
    v_rcp_f32 v161, v161
    v_rcp_f32 v162, v162
    v_rcp_f32 v163, v163
    v_rcp_f32 v164, v164
    v_rcp_f32 v165, v165
    v_rcp_f32 v166, v166
    v_rcp_f32 v167, v167
    v_pk_mul_f32 v[160:161], v[0:1], v[160:161]
    v_pk_mul_f32 v[162:163], v[2:3], v[162:163]
    v_pk_mul_f32 v[164:165], v[4:5], v[164:165]
    v_pk_mul_f32 v[166:167], v[6:7], v[166:167]
    v_cvt_pk_bf16_f32 v0, v160, v161
    v_cvt_pk_bf16_f32 v1, v162, v163
    v_cvt_pk_bf16_f32 v2, v164, v165
    v_cvt_pk_bf16_f32 v3, v166, v167
    v_exp_f32 v168, v8
    v_exp_f32 v169, v9
    v_exp_f32 v170, v10
    v_exp_f32 v171, v11
    v_exp_f32 v172, v12
    v_exp_f32 v173, v13
    v_exp_f32 v174, v14
    v_exp_f32 v175, v15
    v_pk_add_f32 v[168:169], v[168:169], 1.0 op_sel_hi:[1,0]
    v_pk_add_f32 v[170:171], v[170:171], 1.0 op_sel_hi:[1,0]
    v_pk_add_f32 v[172:173], v[172:173], 1.0 op_sel_hi:[1,0]
    v_pk_add_f32 v[174:175], v[174:175], 1.0 op_sel_hi:[1,0]
    v_rcp_f32 v168, v168
    v_rcp_f32 v169, v169
    v_rcp_f32 v170, v170
    v_rcp_f32 v171, v171
    v_rcp_f32 v172, v172
    v_rcp_f32 v173, v173
    v_rcp_f32 v174, v174
    v_rcp_f32 v175, v175
    v_pk_mul_f32 v[168:169], v[8:9], v[168:169]
    v_pk_mul_f32 v[170:171], v[10:11], v[170:171]
    v_pk_mul_f32 v[172:173], v[12:13], v[172:173]
    v_pk_mul_f32 v[174:175], v[14:15], v[174:175]
    v_cvt_pk_bf16_f32 v8, v168, v169
    v_cvt_pk_bf16_f32 v9, v170, v171
    v_cvt_pk_bf16_f32 v10, v172, v173
    v_cvt_pk_bf16_f32 v11, v174, v175
    v_exp_f32 v160, v16
    v_exp_f32 v161, v17
    v_exp_f32 v162, v18
    v_exp_f32 v163, v19
    v_exp_f32 v164, v20
    v_exp_f32 v165, v21
    v_exp_f32 v166, v22
    v_exp_f32 v167, v23
    v_pk_add_f32 v[160:161], v[160:161], 1.0 op_sel_hi:[1,0]
    v_pk_add_f32 v[162:163], v[162:163], 1.0 op_sel_hi:[1,0]
    v_pk_add_f32 v[164:165], v[164:165], 1.0 op_sel_hi:[1,0]
    v_pk_add_f32 v[166:167], v[166:167], 1.0 op_sel_hi:[1,0]
    v_rcp_f32 v160, v160
    v_rcp_f32 v161, v161
    v_rcp_f32 v162, v162
    v_rcp_f32 v163, v163
    v_rcp_f32 v164, v164
    v_rcp_f32 v165, v165
    v_rcp_f32 v166, v166
    v_rcp_f32 v167, v167
    v_pk_mul_f32 v[160:161], v[16:17], v[160:161]
    v_pk_mul_f32 v[162:163], v[18:19], v[162:163]
    v_pk_mul_f32 v[164:165], v[20:21], v[164:165]
    v_pk_mul_f32 v[166:167], v[22:23], v[166:167]
    v_cvt_pk_bf16_f32 v16, v160, v161
    v_cvt_pk_bf16_f32 v17, v162, v163
    v_cvt_pk_bf16_f32 v18, v164, v165
    v_cvt_pk_bf16_f32 v19, v166, v167
    v_exp_f32 v168, v24
    v_exp_f32 v169, v25
    v_exp_f32 v170, v26
    v_exp_f32 v171, v27
    v_exp_f32 v172, v28
    v_exp_f32 v173, v29
    v_exp_f32 v174, v30
    v_exp_f32 v175, v31
    v_pk_add_f32 v[168:169], v[168:169], 1.0 op_sel_hi:[1,0]
    v_pk_add_f32 v[170:171], v[170:171], 1.0 op_sel_hi:[1,0]
    v_pk_add_f32 v[172:173], v[172:173], 1.0 op_sel_hi:[1,0]
    v_pk_add_f32 v[174:175], v[174:175], 1.0 op_sel_hi:[1,0]
    v_rcp_f32 v168, v168
    v_rcp_f32 v169, v169
    v_rcp_f32 v170, v170
    v_rcp_f32 v171, v171
    v_rcp_f32 v172, v172
    v_rcp_f32 v173, v173
    v_rcp_f32 v174, v174
    v_rcp_f32 v175, v175
    v_pk_mul_f32 v[168:169], v[24:25], v[168:169]
    v_pk_mul_f32 v[170:171], v[26:27], v[170:171]
    v_pk_mul_f32 v[172:173], v[28:29], v[172:173]
    v_pk_mul_f32 v[174:175], v[30:31], v[174:175]
    v_cvt_pk_bf16_f32 v24, v168, v169
    v_cvt_pk_bf16_f32 v25, v170, v171
    v_cvt_pk_bf16_f32 v26, v172, v173
    v_cvt_pk_bf16_f32 v27, v174, v175
    v_exp_f32 v160, v32
    v_exp_f32 v161, v33
    v_exp_f32 v162, v34
    v_exp_f32 v163, v35
    v_exp_f32 v164, v36
    v_exp_f32 v165, v37
    v_exp_f32 v166, v38
    v_exp_f32 v167, v39
    v_pk_add_f32 v[160:161], v[160:161], 1.0 op_sel_hi:[1,0]
    v_pk_add_f32 v[162:163], v[162:163], 1.0 op_sel_hi:[1,0]
    v_pk_add_f32 v[164:165], v[164:165], 1.0 op_sel_hi:[1,0]
    v_pk_add_f32 v[166:167], v[166:167], 1.0 op_sel_hi:[1,0]
    v_rcp_f32 v160, v160
    v_rcp_f32 v161, v161
    v_rcp_f32 v162, v162
    v_rcp_f32 v163, v163
    v_rcp_f32 v164, v164
    v_rcp_f32 v165, v165
    v_rcp_f32 v166, v166
    v_rcp_f32 v167, v167
    v_pk_mul_f32 v[160:161], v[32:33], v[160:161]
    v_pk_mul_f32 v[162:163], v[34:35], v[162:163]
    v_pk_mul_f32 v[164:165], v[36:37], v[164:165]
    v_pk_mul_f32 v[166:167], v[38:39], v[166:167]
    v_cvt_pk_bf16_f32 v32, v160, v161
    v_cvt_pk_bf16_f32 v33, v162, v163
    v_cvt_pk_bf16_f32 v34, v164, v165
    v_cvt_pk_bf16_f32 v35, v166, v167
    v_exp_f32 v168, v40
    v_exp_f32 v169, v41
    v_exp_f32 v170, v42
    v_exp_f32 v171, v43
    v_exp_f32 v172, v44
    v_exp_f32 v173, v45
    v_exp_f32 v174, v46
    v_exp_f32 v175, v47
    v_pk_add_f32 v[168:169], v[168:169], 1.0 op_sel_hi:[1,0]
    v_pk_add_f32 v[170:171], v[170:171], 1.0 op_sel_hi:[1,0]
    v_pk_add_f32 v[172:173], v[172:173], 1.0 op_sel_hi:[1,0]
    v_pk_add_f32 v[174:175], v[174:175], 1.0 op_sel_hi:[1,0]
    v_rcp_f32 v168, v168
    v_rcp_f32 v169, v169
    v_rcp_f32 v170, v170
    v_rcp_f32 v171, v171
    v_rcp_f32 v172, v172
    v_rcp_f32 v173, v173
    v_rcp_f32 v174, v174
    v_rcp_f32 v175, v175
    v_pk_mul_f32 v[168:169], v[40:41], v[168:169]
    v_pk_mul_f32 v[170:171], v[42:43], v[170:171]
    v_pk_mul_f32 v[172:173], v[44:45], v[172:173]
    v_pk_mul_f32 v[174:175], v[46:47], v[174:175]
    v_cvt_pk_bf16_f32 v40, v168, v169
    v_cvt_pk_bf16_f32 v41, v170, v171
    v_cvt_pk_bf16_f32 v42, v172, v173
    v_cvt_pk_bf16_f32 v43, v174, v175
    v_exp_f32 v160, v48
    v_exp_f32 v161, v49
    v_exp_f32 v162, v50
    v_exp_f32 v163, v51
    v_exp_f32 v164, v52
    v_exp_f32 v165, v53
    v_exp_f32 v166, v54
    v_exp_f32 v167, v55
    v_pk_add_f32 v[160:161], v[160:161], 1.0 op_sel_hi:[1,0]
    v_pk_add_f32 v[162:163], v[162:163], 1.0 op_sel_hi:[1,0]
    v_pk_add_f32 v[164:165], v[164:165], 1.0 op_sel_hi:[1,0]
    v_pk_add_f32 v[166:167], v[166:167], 1.0 op_sel_hi:[1,0]
    v_rcp_f32 v160, v160
    v_rcp_f32 v161, v161
    v_rcp_f32 v162, v162
    v_rcp_f32 v163, v163
    v_rcp_f32 v164, v164
    v_rcp_f32 v165, v165
    v_rcp_f32 v166, v166
    v_rcp_f32 v167, v167
    v_pk_mul_f32 v[160:161], v[48:49], v[160:161]
    v_pk_mul_f32 v[162:163], v[50:51], v[162:163]
    v_pk_mul_f32 v[164:165], v[52:53], v[164:165]
    v_pk_mul_f32 v[166:167], v[54:55], v[166:167]
    v_cvt_pk_bf16_f32 v48, v160, v161
    v_cvt_pk_bf16_f32 v49, v162, v163
    v_cvt_pk_bf16_f32 v50, v164, v165
    v_cvt_pk_bf16_f32 v51, v166, v167
    v_exp_f32 v168, v56
    v_exp_f32 v169, v57
    v_exp_f32 v170, v58
    v_exp_f32 v171, v59
    v_exp_f32 v172, v60
    v_exp_f32 v173, v61
    v_exp_f32 v174, v62
    v_exp_f32 v175, v63
    v_pk_add_f32 v[168:169], v[168:169], 1.0 op_sel_hi:[1,0]
    v_pk_add_f32 v[170:171], v[170:171], 1.0 op_sel_hi:[1,0]
    v_pk_add_f32 v[172:173], v[172:173], 1.0 op_sel_hi:[1,0]
    v_pk_add_f32 v[174:175], v[174:175], 1.0 op_sel_hi:[1,0]
    v_rcp_f32 v168, v168
    v_rcp_f32 v169, v169
    v_rcp_f32 v170, v170
    v_rcp_f32 v171, v171
    v_rcp_f32 v172, v172
    v_rcp_f32 v173, v173
    v_rcp_f32 v174, v174
    v_rcp_f32 v175, v175
    v_pk_mul_f32 v[168:169], v[56:57], v[168:169]
    v_pk_mul_f32 v[170:171], v[58:59], v[170:171]
    v_pk_mul_f32 v[172:173], v[60:61], v[172:173]
    v_pk_mul_f32 v[174:175], v[62:63], v[174:175]
    v_cvt_pk_bf16_f32 v56, v168, v169
    v_cvt_pk_bf16_f32 v57, v170, v171
    v_cvt_pk_bf16_f32 v58, v172, v173
    v_cvt_pk_bf16_f32 v59, v174, v175
    v_exp_f32 v160, v64
    v_exp_f32 v161, v65
    v_exp_f32 v162, v66
    v_exp_f32 v163, v67
    v_exp_f32 v164, v68
    v_exp_f32 v165, v69
    v_exp_f32 v166, v70
    v_exp_f32 v167, v71
    v_pk_add_f32 v[160:161], v[160:161], 1.0 op_sel_hi:[1,0]
    v_pk_add_f32 v[162:163], v[162:163], 1.0 op_sel_hi:[1,0]
    v_pk_add_f32 v[164:165], v[164:165], 1.0 op_sel_hi:[1,0]
    v_pk_add_f32 v[166:167], v[166:167], 1.0 op_sel_hi:[1,0]
    v_rcp_f32 v160, v160
    v_rcp_f32 v161, v161
    v_rcp_f32 v162, v162
    v_rcp_f32 v163, v163
    v_rcp_f32 v164, v164
    v_rcp_f32 v165, v165
    v_rcp_f32 v166, v166
    v_rcp_f32 v167, v167
    v_pk_mul_f32 v[160:161], v[64:65], v[160:161]
    v_pk_mul_f32 v[162:163], v[66:67], v[162:163]
    v_pk_mul_f32 v[164:165], v[68:69], v[164:165]
    v_pk_mul_f32 v[166:167], v[70:71], v[166:167]
    v_cvt_pk_bf16_f32 v64, v160, v161
    v_cvt_pk_bf16_f32 v65, v162, v163
    v_cvt_pk_bf16_f32 v66, v164, v165
    v_cvt_pk_bf16_f32 v67, v166, v167
    v_exp_f32 v168, v72
    v_exp_f32 v169, v73
    v_exp_f32 v170, v74
    v_exp_f32 v171, v75
    v_exp_f32 v172, v76
    v_exp_f32 v173, v77
    v_exp_f32 v174, v78
    v_exp_f32 v175, v79
    v_pk_add_f32 v[168:169], v[168:169], 1.0 op_sel_hi:[1,0]
    v_pk_add_f32 v[170:171], v[170:171], 1.0 op_sel_hi:[1,0]
    v_pk_add_f32 v[172:173], v[172:173], 1.0 op_sel_hi:[1,0]
    v_pk_add_f32 v[174:175], v[174:175], 1.0 op_sel_hi:[1,0]
    v_rcp_f32 v168, v168
    v_rcp_f32 v169, v169
    v_rcp_f32 v170, v170
    v_rcp_f32 v171, v171
    v_rcp_f32 v172, v172
    v_rcp_f32 v173, v173
    v_rcp_f32 v174, v174
    v_rcp_f32 v175, v175
    v_pk_mul_f32 v[168:169], v[72:73], v[168:169]
    v_pk_mul_f32 v[170:171], v[74:75], v[170:171]
    v_pk_mul_f32 v[172:173], v[76:77], v[172:173]
    v_pk_mul_f32 v[174:175], v[78:79], v[174:175]
    v_cvt_pk_bf16_f32 v72, v168, v169
    v_cvt_pk_bf16_f32 v73, v170, v171
    v_cvt_pk_bf16_f32 v74, v172, v173
    v_cvt_pk_bf16_f32 v75, v174, v175
    v_exp_f32 v160, v80
    v_exp_f32 v161, v81
    v_exp_f32 v162, v82
    v_exp_f32 v163, v83
    v_exp_f32 v164, v84
    v_exp_f32 v165, v85
    v_exp_f32 v166, v86
    v_exp_f32 v167, v87
    v_pk_add_f32 v[160:161], v[160:161], 1.0 op_sel_hi:[1,0]
    v_pk_add_f32 v[162:163], v[162:163], 1.0 op_sel_hi:[1,0]
    v_pk_add_f32 v[164:165], v[164:165], 1.0 op_sel_hi:[1,0]
    v_pk_add_f32 v[166:167], v[166:167], 1.0 op_sel_hi:[1,0]
    v_rcp_f32 v160, v160
    v_rcp_f32 v161, v161
    v_rcp_f32 v162, v162
    v_rcp_f32 v163, v163
    v_rcp_f32 v164, v164
    v_rcp_f32 v165, v165
    v_rcp_f32 v166, v166
    v_rcp_f32 v167, v167
    v_pk_mul_f32 v[160:161], v[80:81], v[160:161]
    v_pk_mul_f32 v[162:163], v[82:83], v[162:163]
    v_pk_mul_f32 v[164:165], v[84:85], v[164:165]
    v_pk_mul_f32 v[166:167], v[86:87], v[166:167]
    v_cvt_pk_bf16_f32 v80, v160, v161
    v_cvt_pk_bf16_f32 v81, v162, v163
    v_cvt_pk_bf16_f32 v82, v164, v165
    v_cvt_pk_bf16_f32 v83, v166, v167
    v_exp_f32 v168, v88
    v_exp_f32 v169, v89
    v_exp_f32 v170, v90
    v_exp_f32 v171, v91
    v_exp_f32 v172, v92
    v_exp_f32 v173, v93
    v_exp_f32 v174, v94
    v_exp_f32 v175, v95
    v_pk_add_f32 v[168:169], v[168:169], 1.0 op_sel_hi:[1,0]
    v_pk_add_f32 v[170:171], v[170:171], 1.0 op_sel_hi:[1,0]
    v_pk_add_f32 v[172:173], v[172:173], 1.0 op_sel_hi:[1,0]
    v_pk_add_f32 v[174:175], v[174:175], 1.0 op_sel_hi:[1,0]
    v_rcp_f32 v168, v168
    v_rcp_f32 v169, v169
    v_rcp_f32 v170, v170
    v_rcp_f32 v171, v171
    v_rcp_f32 v172, v172
    v_rcp_f32 v173, v173
    v_rcp_f32 v174, v174
    v_rcp_f32 v175, v175
    v_pk_mul_f32 v[168:169], v[88:89], v[168:169]
    v_pk_mul_f32 v[170:171], v[90:91], v[170:171]
    v_pk_mul_f32 v[172:173], v[92:93], v[172:173]
    v_pk_mul_f32 v[174:175], v[94:95], v[174:175]
    v_cvt_pk_bf16_f32 v88, v168, v169
    v_cvt_pk_bf16_f32 v89, v170, v171
    v_cvt_pk_bf16_f32 v90, v172, v173
    v_cvt_pk_bf16_f32 v91, v174, v175
    v_exp_f32 v160, v96
    v_exp_f32 v161, v97
    v_exp_f32 v162, v98
    v_exp_f32 v163, v99
    v_exp_f32 v164, v100
    v_exp_f32 v165, v101
    v_exp_f32 v166, v102
    v_exp_f32 v167, v103
    v_pk_add_f32 v[160:161], v[160:161], 1.0 op_sel_hi:[1,0]
    v_pk_add_f32 v[162:163], v[162:163], 1.0 op_sel_hi:[1,0]
    v_pk_add_f32 v[164:165], v[164:165], 1.0 op_sel_hi:[1,0]
    v_pk_add_f32 v[166:167], v[166:167], 1.0 op_sel_hi:[1,0]
    v_rcp_f32 v160, v160
    v_rcp_f32 v161, v161
    v_rcp_f32 v162, v162
    v_rcp_f32 v163, v163
    v_rcp_f32 v164, v164
    v_rcp_f32 v165, v165
    v_rcp_f32 v166, v166
    v_rcp_f32 v167, v167
    v_pk_mul_f32 v[160:161], v[96:97], v[160:161]
    v_pk_mul_f32 v[162:163], v[98:99], v[162:163]
    v_pk_mul_f32 v[164:165], v[100:101], v[164:165]
    v_pk_mul_f32 v[166:167], v[102:103], v[166:167]
    v_cvt_pk_bf16_f32 v96, v160, v161
    v_cvt_pk_bf16_f32 v97, v162, v163
    v_cvt_pk_bf16_f32 v98, v164, v165
    v_cvt_pk_bf16_f32 v99, v166, v167
    v_exp_f32 v168, v104
    v_exp_f32 v169, v105
    v_exp_f32 v170, v106
    v_exp_f32 v171, v107
    v_exp_f32 v172, v108
    v_exp_f32 v173, v109
    v_exp_f32 v174, v110
    v_exp_f32 v175, v111
    v_pk_add_f32 v[168:169], v[168:169], 1.0 op_sel_hi:[1,0]
    v_pk_add_f32 v[170:171], v[170:171], 1.0 op_sel_hi:[1,0]
    v_pk_add_f32 v[172:173], v[172:173], 1.0 op_sel_hi:[1,0]
    v_pk_add_f32 v[174:175], v[174:175], 1.0 op_sel_hi:[1,0]
    v_rcp_f32 v168, v168
    v_rcp_f32 v169, v169
    v_rcp_f32 v170, v170
    v_rcp_f32 v171, v171
    v_rcp_f32 v172, v172
    v_rcp_f32 v173, v173
    v_rcp_f32 v174, v174
    v_rcp_f32 v175, v175
    v_pk_mul_f32 v[168:169], v[104:105], v[168:169]
    v_pk_mul_f32 v[170:171], v[106:107], v[170:171]
    v_pk_mul_f32 v[172:173], v[108:109], v[172:173]
    v_pk_mul_f32 v[174:175], v[110:111], v[174:175]
    v_cvt_pk_bf16_f32 v104, v168, v169
    v_cvt_pk_bf16_f32 v105, v170, v171
    v_cvt_pk_bf16_f32 v106, v172, v173
    v_cvt_pk_bf16_f32 v107, v174, v175
    v_exp_f32 v160, v112
    v_exp_f32 v161, v113
    v_exp_f32 v162, v114
    v_exp_f32 v163, v115
    v_exp_f32 v164, v116
    v_exp_f32 v165, v117
    v_exp_f32 v166, v118
    v_exp_f32 v167, v119
    v_pk_add_f32 v[160:161], v[160:161], 1.0 op_sel_hi:[1,0]
    v_pk_add_f32 v[162:163], v[162:163], 1.0 op_sel_hi:[1,0]
    v_pk_add_f32 v[164:165], v[164:165], 1.0 op_sel_hi:[1,0]
    v_pk_add_f32 v[166:167], v[166:167], 1.0 op_sel_hi:[1,0]
    v_rcp_f32 v160, v160
    v_rcp_f32 v161, v161
    v_rcp_f32 v162, v162
    v_rcp_f32 v163, v163
    v_rcp_f32 v164, v164
    v_rcp_f32 v165, v165
    v_rcp_f32 v166, v166
    v_rcp_f32 v167, v167
    v_pk_mul_f32 v[160:161], v[112:113], v[160:161]
    v_pk_mul_f32 v[162:163], v[114:115], v[162:163]
    v_pk_mul_f32 v[164:165], v[116:117], v[164:165]
    v_pk_mul_f32 v[166:167], v[118:119], v[166:167]
    v_cvt_pk_bf16_f32 v112, v160, v161
    v_cvt_pk_bf16_f32 v113, v162, v163
    v_cvt_pk_bf16_f32 v114, v164, v165
    v_cvt_pk_bf16_f32 v115, v166, v167
    v_exp_f32 v168, v120
    v_exp_f32 v169, v121
    v_exp_f32 v170, v122
    v_exp_f32 v171, v123
    v_exp_f32 v172, v124
    v_exp_f32 v173, v125
    v_exp_f32 v174, v126
    v_exp_f32 v175, v127
    v_pk_add_f32 v[168:169], v[168:169], 1.0 op_sel_hi:[1,0]
    v_pk_add_f32 v[170:171], v[170:171], 1.0 op_sel_hi:[1,0]
    v_pk_add_f32 v[172:173], v[172:173], 1.0 op_sel_hi:[1,0]
    v_pk_add_f32 v[174:175], v[174:175], 1.0 op_sel_hi:[1,0]
    v_rcp_f32 v168, v168
    v_rcp_f32 v169, v169
    v_rcp_f32 v170, v170
    v_rcp_f32 v171, v171
    v_rcp_f32 v172, v172
    v_rcp_f32 v173, v173
    v_rcp_f32 v174, v174
    v_rcp_f32 v175, v175
    v_pk_mul_f32 v[168:169], v[120:121], v[168:169]
    v_pk_mul_f32 v[170:171], v[122:123], v[170:171]
    v_pk_mul_f32 v[172:173], v[124:125], v[172:173]
    v_pk_mul_f32 v[174:175], v[126:127], v[174:175]
    v_cvt_pk_bf16_f32 v120, v168, v169
    v_cvt_pk_bf16_f32 v121, v170, v171
    v_cvt_pk_bf16_f32 v122, v172, v173
    v_cvt_pk_bf16_f32 v123, v174, v175
    v_exp_f32 v160, v128
    v_exp_f32 v161, v129
    v_exp_f32 v162, v130
    v_exp_f32 v163, v131
    v_exp_f32 v164, v132
    v_exp_f32 v165, v133
    v_exp_f32 v166, v134
    v_exp_f32 v167, v135
    v_pk_add_f32 v[160:161], v[160:161], 1.0 op_sel_hi:[1,0]
    v_pk_add_f32 v[162:163], v[162:163], 1.0 op_sel_hi:[1,0]
    v_pk_add_f32 v[164:165], v[164:165], 1.0 op_sel_hi:[1,0]
    v_pk_add_f32 v[166:167], v[166:167], 1.0 op_sel_hi:[1,0]
    v_rcp_f32 v160, v160
    v_rcp_f32 v161, v161
    v_rcp_f32 v162, v162
    v_rcp_f32 v163, v163
    v_rcp_f32 v164, v164
    v_rcp_f32 v165, v165
    v_rcp_f32 v166, v166
    v_rcp_f32 v167, v167
    v_pk_mul_f32 v[160:161], v[128:129], v[160:161]
    v_pk_mul_f32 v[162:163], v[130:131], v[162:163]
    v_pk_mul_f32 v[164:165], v[132:133], v[164:165]
    v_pk_mul_f32 v[166:167], v[134:135], v[166:167]
    v_cvt_pk_bf16_f32 v128, v160, v161
    v_cvt_pk_bf16_f32 v129, v162, v163
    v_cvt_pk_bf16_f32 v130, v164, v165
    v_cvt_pk_bf16_f32 v131, v166, v167
    v_exp_f32 v168, v136
    v_exp_f32 v169, v137
    v_exp_f32 v170, v138
    v_exp_f32 v171, v139
    v_exp_f32 v172, v140
    v_exp_f32 v173, v141
    v_exp_f32 v174, v142
    v_exp_f32 v175, v143
    v_pk_add_f32 v[168:169], v[168:169], 1.0 op_sel_hi:[1,0]
    v_pk_add_f32 v[170:171], v[170:171], 1.0 op_sel_hi:[1,0]
    v_pk_add_f32 v[172:173], v[172:173], 1.0 op_sel_hi:[1,0]
    v_pk_add_f32 v[174:175], v[174:175], 1.0 op_sel_hi:[1,0]
    v_rcp_f32 v168, v168
    v_rcp_f32 v169, v169
    v_rcp_f32 v170, v170
    v_rcp_f32 v171, v171
    v_rcp_f32 v172, v172
    v_rcp_f32 v173, v173
    v_rcp_f32 v174, v174
    v_rcp_f32 v175, v175
    v_pk_mul_f32 v[168:169], v[136:137], v[168:169]
    v_pk_mul_f32 v[170:171], v[138:139], v[170:171]
    v_pk_mul_f32 v[172:173], v[140:141], v[172:173]
    v_pk_mul_f32 v[174:175], v[142:143], v[174:175]
    v_cvt_pk_bf16_f32 v136, v168, v169
    v_cvt_pk_bf16_f32 v137, v170, v171
    v_cvt_pk_bf16_f32 v138, v172, v173
    v_cvt_pk_bf16_f32 v139, v174, v175
    v_exp_f32 v160, v144
    v_exp_f32 v161, v145
    v_exp_f32 v162, v146
    v_exp_f32 v163, v147
    v_exp_f32 v164, v148
    v_exp_f32 v165, v149
    v_exp_f32 v166, v150
    v_exp_f32 v167, v151
    v_pk_add_f32 v[160:161], v[160:161], 1.0 op_sel_hi:[1,0]
    v_pk_add_f32 v[162:163], v[162:163], 1.0 op_sel_hi:[1,0]
    v_pk_add_f32 v[164:165], v[164:165], 1.0 op_sel_hi:[1,0]
    v_pk_add_f32 v[166:167], v[166:167], 1.0 op_sel_hi:[1,0]
    v_rcp_f32 v160, v160
    v_rcp_f32 v161, v161
    v_rcp_f32 v162, v162
    v_rcp_f32 v163, v163
    v_rcp_f32 v164, v164
    v_rcp_f32 v165, v165
    v_rcp_f32 v166, v166
    v_rcp_f32 v167, v167
    v_pk_mul_f32 v[160:161], v[144:145], v[160:161]
    v_pk_mul_f32 v[162:163], v[146:147], v[162:163]
    v_pk_mul_f32 v[164:165], v[148:149], v[164:165]
    v_pk_mul_f32 v[166:167], v[150:151], v[166:167]
    v_cvt_pk_bf16_f32 v144, v160, v161
    v_cvt_pk_bf16_f32 v145, v162, v163
    v_cvt_pk_bf16_f32 v146, v164, v165
    v_cvt_pk_bf16_f32 v147, v166, v167
    v_exp_f32 v168, v152
    v_exp_f32 v169, v153
    v_exp_f32 v170, v154
    v_exp_f32 v171, v155
    v_exp_f32 v172, v156
    v_exp_f32 v173, v157
    v_exp_f32 v174, v158
    v_exp_f32 v175, v159
    v_pk_add_f32 v[168:169], v[168:169], 1.0 op_sel_hi:[1,0]
    v_pk_add_f32 v[170:171], v[170:171], 1.0 op_sel_hi:[1,0]
    v_pk_add_f32 v[172:173], v[172:173], 1.0 op_sel_hi:[1,0]
    v_pk_add_f32 v[174:175], v[174:175], 1.0 op_sel_hi:[1,0]
    v_rcp_f32 v168, v168
    v_rcp_f32 v169, v169
    v_rcp_f32 v170, v170
    v_rcp_f32 v171, v171
    v_rcp_f32 v172, v172
    v_rcp_f32 v173, v173
    v_rcp_f32 v174, v174
    v_rcp_f32 v175, v175
    v_pk_mul_f32 v[168:169], v[152:153], v[168:169]
    v_pk_mul_f32 v[170:171], v[154:155], v[170:171]
    v_pk_mul_f32 v[172:173], v[156:157], v[172:173]
    v_pk_mul_f32 v[174:175], v[158:159], v[174:175]
    v_cvt_pk_bf16_f32 v152, v168, v169
    v_cvt_pk_bf16_f32 v153, v170, v171
    v_cvt_pk_bf16_f32 v154, v172, v173
    v_cvt_pk_bf16_f32 v155, v174, v175
    v_mov_b32 v252, 163584
    s_mov_b32 s72, 0
LW_5:
    ds_read_b32 v253, v252 offset:12
    s_waitcnt lgkmcnt(0)
    v_readfirstlane_b32 s77, v253
    s_add_u32 s72, s72, 1
    s_cmp_ge_u32 s77, 8
    s_cbranch_scc1 LWD_6
    s_sleep 1
    s_cmp_lt_u32 s72, 524288
    s_cbranch_scc1 LW_5
LWD_6:
    ds_write_b128 v221, v[0:3] offset:0
    ds_write_b128 v221, v[8:11] offset:2080
    ds_write_b128 v221, v[16:19] offset:512
    ds_write_b128 v221, v[24:27] offset:2592
    ds_write_b128 v221, v[32:35] offset:4160
    ds_write_b128 v221, v[40:43] offset:6240
    ds_write_b128 v221, v[48:51] offset:4672
    ds_write_b128 v221, v[56:59] offset:6752
    ds_write_b128 v221, v[64:67] offset:8320
    ds_write_b128 v221, v[72:75] offset:10400
    ds_write_b128 v221, v[80:83] offset:8832
    ds_write_b128 v221, v[88:91] offset:10912
    ds_write_b128 v221, v[96:99] offset:12480
    ds_write_b128 v221, v[104:107] offset:14560
    ds_write_b128 v221, v[112:115] offset:12992
    ds_write_b128 v221, v[120:123] offset:15072
    ds_write_b128 v221, v[128:131] offset:16640
    ds_write_b128 v221, v[136:139] offset:18720
    ds_write_b128 v221, v[144:147] offset:17152
    ds_write_b128 v221, v[152:155] offset:19232
    s_waitcnt lgkmcnt(0)
    v_mov_b32 v252, 163584
    v_mov_b32 v253, 1
    s_mov_b64 exec, 1
    ds_add_u32 v252, v253 offset:16
    s_mov_b64 exec, -1
    v_mov_b32 v252, 163584
    s_mov_b32 s72, 0
LW_7:
    ds_read_b32 v253, v252 offset:16
    s_waitcnt lgkmcnt(0)
    v_readfirstlane_b32 s77, v253
    s_add_u32 s72, s72, 1
    s_cmp_ge_u32 s77, 4
    s_cbranch_scc1 LWD_8
    s_sleep 1
    s_cmp_lt_u32 s72, 524288
    s_cbranch_scc1 LW_7
LWD_8:
    s_mul_i32 s93, s92, 2080
    v_add_u32 v220, s93, v223
    s_add_u32 s93, s93, 2080
    s_cmp_eq_u32 s93, 74880
    s_cselect_b32 s93, 0, s93
    s_waitcnt vmcnt(8)
    ds_read_b128 v[200:203], v220 offset:0
    ds_read_b64_tr_b16 v[160:161], v219 offset:0
    ds_read_b64_tr_b16 v[162:163], v219 offset:512
    ds_read_b128 v[204:207], v220 offset:512
    ds_read_b64_tr_b16 v[164:165], v219 offset:1024
    ds_read_b64_tr_b16 v[166:167], v219 offset:1536
    ds_read_b64_tr_b16 v[168:169], v219 offset:2048
    ds_read_b64_tr_b16 v[170:171], v219 offset:2560
    ds_read_b64_tr_b16 v[172:173], v219 offset:3072
    ds_read_b64_tr_b16 v[174:175], v219 offset:3584
    s_waitcnt lgkmcnt(7)
    s_add_u32 m0, s68, 0
    v_mfma_f32_32x32x16_bf16 v[0:15], v[160:163], v[200:203], 0
    buffer_load_dwordx4 v217, s[36:39], s69 offen offset:0 lds
    s_waitcnt lgkmcnt(6)
    v_mfma_f32_32x32x16_bf16 v[16:31], v[160:163], v[204:207], 0
    v_add_u32 v220, s93, v223
    s_waitcnt vmcnt(8)
    ds_read_b128 v[208:211], v220 offset:0
    ds_read_b64_tr_b16 v[180:181], v219 offset:5120
    ds_read_b64_tr_b16 v[182:183], v219 offset:5632
    s_waitcnt lgkmcnt(7)
    s_add_u32 m0, s68, 960
    v_mfma_f32_32x32x16_bf16 v[32:47], v[164:167], v[200:203], 0
    buffer_load_dwordx4 v217, s[36:39], s69 offen offset:64 lds
    v_mfma_f32_32x32x16_bf16 v[48:63], v[164:167], v[204:207], 0
    s_waitcnt vmcnt(8)
    ds_read_b128 v[212:215], v220 offset:512
    ds_read_b64_tr_b16 v[184:185], v219 offset:6144
    ds_read_b64_tr_b16 v[186:187], v219 offset:6656
    s_waitcnt lgkmcnt(8)
    s_add_u32 m0, s68, 1920
    v_mfma_f32_32x32x16_bf16 v[64:79], v[168:171], v[200:203], 0
    buffer_load_dwordx4 v217, s[36:39], s69 offen offset:128 lds
    v_mfma_f32_32x32x16_bf16 v[80:95], v[168:171], v[204:207], 0
    s_waitcnt vmcnt(8)
    ds_read_b64_tr_b16 v[188:189], v219 offset:7168
    ds_read_b64_tr_b16 v[190:191], v219 offset:7680
    s_add_u32 s93, s93, 2080
    s_cmp_eq_u32 s93, 74880
    s_cselect_b32 s93, 0, s93
    s_waitcnt lgkmcnt(8)
    s_add_u32 m0, s68, 2880
    v_mfma_f32_32x32x16_bf16 v[96:111], v[172:175], v[200:203], 0
    buffer_load_dwordx4 v217, s[36:39], s69 offen offset:192 lds
    v_mfma_f32_32x32x16_bf16 v[112:127], v[172:175], v[204:207], 0
    s_waitcnt vmcnt(8)
    ds_read_b64_tr_b16 v[192:193], v219 offset:8192
    ds_read_b64_tr_b16 v[194:195], v219 offset:8704
    s_add_u32 s69, s69, 18432
    s_cmp_eq_u32 s69, 663552
    s_cselect_b32 s69, 0, s69
    s_mov_b32 s70, 0
    s_branch L_G2T4_1
.p2align 3
L_G2T4_3:
    s_waitcnt lgkmcnt(7)
    s_add_u32 m0, s68, 0
    v_mfma_f32_32x32x16_bf16 v[0:15], v[180:183], v[208:211], v[0:15]
    buffer_load_dwordx4 v217, s[36:39], s69 offen offset:0 lds
    s_waitcnt lgkmcnt(6)
    v_mfma_f32_32x32x16_bf16 v[16:31], v[180:183], v[212:215], v[16:31]
    v_add_u32 v220, s93, v223
    s_waitcnt vmcnt(8)
    ds_read_b128 v[200:203], v220 offset:0
    ds_read_b64_tr_b16 v[160:161], v219 offset:5120
    ds_read_b64_tr_b16 v[162:163], v219 offset:5632
    s_waitcnt lgkmcnt(7)
    s_add_u32 m0, s68, 960
    v_mfma_f32_32x32x16_bf16 v[32:47], v[184:187], v[208:211], v[32:47]
    buffer_load_dwordx4 v217, s[36:39], s69 offen offset:64 lds
    v_mfma_f32_32x32x16_bf16 v[48:63], v[184:187], v[212:215], v[48:63]
    s_waitcnt vmcnt(8)
    ds_read_b128 v[204:207], v220 offset:512
    ds_read_b64_tr_b16 v[164:165], v219 offset:6144
    ds_read_b64_tr_b16 v[166:167], v219 offset:6656
    s_waitcnt lgkmcnt(8)
    s_add_u32 m0, s68, 1920
    v_mfma_f32_32x32x16_bf16 v[64:79], v[188:191], v[208:211], v[64:79]
    buffer_load_dwordx4 v217, s[36:39], s69 offen offset:128 lds
    v_mfma_f32_32x32x16_bf16 v[80:95], v[188:191], v[212:215], v[80:95]
    s_waitcnt vmcnt(8)
    ds_read_b64_tr_b16 v[168:169], v219 offset:7168
    ds_read_b64_tr_b16 v[170:171], v219 offset:7680
    s_add_u32 s93, s93, 2080
    s_cmp_eq_u32 s93, 74880
    s_cselect_b32 s93, 0, s93
    s_waitcnt lgkmcnt(8)
    s_add_u32 m0, s68, 2880
    v_mfma_f32_32x32x16_bf16 v[96:111], v[192:195], v[208:211], v[96:111]
    buffer_load_dwordx4 v217, s[36:39], s69 offen offset:192 lds
    v_mfma_f32_32x32x16_bf16 v[112:127], v[192:195], v[212:215], v[112:127]
    s_waitcnt vmcnt(8)
    ds_read_b64_tr_b16 v[172:173], v219 offset:8192
    ds_read_b64_tr_b16 v[174:175], v219 offset:8704
    s_add_u32 s69, s69, 18432
    s_cmp_eq_u32 s69, 663552
    s_cselect_b32 s69, 0, s69
    s_waitcnt lgkmcnt(7)
    s_add_u32 m0, s68, 5120
    v_mfma_f32_32x32x16_bf16 v[0:15], v[160:163], v[200:203], v[0:15]
    buffer_load_dwordx4 v217, s[36:39], s69 offen offset:0 lds
    s_waitcnt lgkmcnt(6)
    v_mfma_f32_32x32x16_bf16 v[16:31], v[160:163], v[204:207], v[16:31]
    v_add_u32 v220, s93, v223
    s_waitcnt vmcnt(8)
    ds_read_b128 v[208:211], v220 offset:0
    ds_read_b64_tr_b16 v[180:181], v219 offset:10240
    ds_read_b64_tr_b16 v[182:183], v219 offset:10752
    s_waitcnt lgkmcnt(7)
    s_add_u32 m0, s68, 6080
    v_mfma_f32_32x32x16_bf16 v[32:47], v[164:167], v[200:203], v[32:47]
    buffer_load_dwordx4 v217, s[36:39], s69 offen offset:64 lds
    v_mfma_f32_32x32x16_bf16 v[48:63], v[164:167], v[204:207], v[48:63]
    s_waitcnt vmcnt(8)
    ds_read_b128 v[212:215], v220 offset:512
    ds_read_b64_tr_b16 v[184:185], v219 offset:11264
    ds_read_b64_tr_b16 v[186:187], v219 offset:11776
    s_waitcnt lgkmcnt(8)
    s_add_u32 m0, s68, 7040
    v_mfma_f32_32x32x16_bf16 v[64:79], v[168:171], v[200:203], v[64:79]
    buffer_load_dwordx4 v217, s[36:39], s69 offen offset:128 lds
    v_mfma_f32_32x32x16_bf16 v[80:95], v[168:171], v[204:207], v[80:95]
    s_waitcnt vmcnt(8)
    ds_read_b64_tr_b16 v[188:189], v219 offset:12288
    ds_read_b64_tr_b16 v[190:191], v219 offset:12800
    s_add_u32 s93, s93, 2080
    s_cmp_eq_u32 s93, 74880
    s_cselect_b32 s93, 0, s93
    s_waitcnt lgkmcnt(8)
    s_add_u32 m0, s68, 8000
    v_mfma_f32_32x32x16_bf16 v[96:111], v[172:175], v[200:203], v[96:111]
    buffer_load_dwordx4 v217, s[36:39], s69 offen offset:192 lds
    v_mfma_f32_32x32x16_bf16 v[112:127], v[172:175], v[204:207], v[112:127]
    s_waitcnt vmcnt(8)
    ds_read_b64_tr_b16 v[192:193], v219 offset:13312
    ds_read_b64_tr_b16 v[194:195], v219 offset:13824
    s_add_u32 s69, s69, 18432
    s_cmp_eq_u32 s69, 663552
    s_cselect_b32 s69, 0, s69
    s_waitcnt lgkmcnt(7)
    s_add_u32 m0, s68, 10240
    v_mfma_f32_32x32x16_bf16 v[0:15], v[180:183], v[208:211], v[0:15]
    buffer_load_dwordx4 v217, s[36:39], s69 offen offset:0 lds
    s_waitcnt lgkmcnt(6)
    v_mfma_f32_32x32x16_bf16 v[16:31], v[180:183], v[212:215], v[16:31]
    v_add_u32 v220, s93, v223
    s_waitcnt vmcnt(8)
    ds_read_b128 v[200:203], v220 offset:0
    ds_read_b64_tr_b16 v[160:161], v219 offset:0
    ds_read_b64_tr_b16 v[162:163], v219 offset:512
    s_waitcnt lgkmcnt(7)
    s_add_u32 m0, s68, 11200
    v_mfma_f32_32x32x16_bf16 v[32:47], v[184:187], v[208:211], v[32:47]
    buffer_load_dwordx4 v217, s[36:39], s69 offen offset:64 lds
    v_mfma_f32_32x32x16_bf16 v[48:63], v[184:187], v[212:215], v[48:63]
    s_waitcnt vmcnt(8)
    ds_read_b128 v[204:207], v220 offset:512
    ds_read_b64_tr_b16 v[164:165], v219 offset:1024
    ds_read_b64_tr_b16 v[166:167], v219 offset:1536
    s_waitcnt lgkmcnt(8)
    s_add_u32 m0, s68, 12160
    v_mfma_f32_32x32x16_bf16 v[64:79], v[188:191], v[208:211], v[64:79]
    buffer_load_dwordx4 v217, s[36:39], s69 offen offset:128 lds
    v_mfma_f32_32x32x16_bf16 v[80:95], v[188:191], v[212:215], v[80:95]
    s_waitcnt vmcnt(8)
    ds_read_b64_tr_b16 v[168:169], v219 offset:2048
    ds_read_b64_tr_b16 v[170:171], v219 offset:2560
    s_add_u32 s93, s93, 2080
    s_cmp_eq_u32 s93, 74880
    s_cselect_b32 s93, 0, s93
    s_waitcnt lgkmcnt(8)
    s_add_u32 m0, s68, 13120
    v_mfma_f32_32x32x16_bf16 v[96:111], v[192:195], v[208:211], v[96:111]
    buffer_load_dwordx4 v217, s[36:39], s69 offen offset:192 lds
    v_mfma_f32_32x32x16_bf16 v[112:127], v[192:195], v[212:215], v[112:127]
    s_waitcnt vmcnt(8)
    ds_read_b64_tr_b16 v[172:173], v219 offset:3072
    ds_read_b64_tr_b16 v[174:175], v219 offset:3584
    s_add_u32 s69, s69, 18432
    s_cmp_eq_u32 s69, 663552
    s_cselect_b32 s69, 0, s69
    s_waitcnt lgkmcnt(7)
    s_add_u32 m0, s68, 0
    v_mfma_f32_32x32x16_bf16 v[0:15], v[160:163], v[200:203], v[0:15]
    buffer_load_dwordx4 v217, s[36:39], s69 offen offset:0 lds
    s_waitcnt lgkmcnt(6)
    v_mfma_f32_32x32x16_bf16 v[16:31], v[160:163], v[204:207], v[16:31]
    v_add_u32 v220, s93, v223
    s_waitcnt vmcnt(8)
    ds_read_b128 v[208:211], v220 offset:0
    ds_read_b64_tr_b16 v[180:181], v219 offset:5120
    ds_read_b64_tr_b16 v[182:183], v219 offset:5632
    s_waitcnt lgkmcnt(7)
    s_add_u32 m0, s68, 960
    v_mfma_f32_32x32x16_bf16 v[32:47], v[164:167], v[200:203], v[32:47]
    buffer_load_dwordx4 v217, s[36:39], s69 offen offset:64 lds
    v_mfma_f32_32x32x16_bf16 v[48:63], v[164:167], v[204:207], v[48:63]
    s_waitcnt vmcnt(8)
    ds_read_b128 v[212:215], v220 offset:512
    ds_read_b64_tr_b16 v[184:185], v219 offset:6144
    ds_read_b64_tr_b16 v[186:187], v219 offset:6656
    s_waitcnt lgkmcnt(8)
    s_add_u32 m0, s68, 1920
    v_mfma_f32_32x32x16_bf16 v[64:79], v[168:171], v[200:203], v[64:79]
    buffer_load_dwordx4 v217, s[36:39], s69 offen offset:128 lds
    v_mfma_f32_32x32x16_bf16 v[80:95], v[168:171], v[204:207], v[80:95]
    s_waitcnt vmcnt(8)
    ds_read_b64_tr_b16 v[188:189], v219 offset:7168
    ds_read_b64_tr_b16 v[190:191], v219 offset:7680
    s_add_u32 s93, s93, 2080
    s_cmp_eq_u32 s93, 74880
    s_cselect_b32 s93, 0, s93
    s_waitcnt lgkmcnt(8)
    s_add_u32 m0, s68, 2880
    v_mfma_f32_32x32x16_bf16 v[96:111], v[172:175], v[200:203], v[96:111]
    buffer_load_dwordx4 v217, s[36:39], s69 offen offset:192 lds
    v_mfma_f32_32x32x16_bf16 v[112:127], v[172:175], v[204:207], v[112:127]
    s_waitcnt vmcnt(8)
    ds_read_b64_tr_b16 v[192:193], v219 offset:8192
    ds_read_b64_tr_b16 v[194:195], v219 offset:8704
    s_add_u32 s69, s69, 18432
    s_cmp_eq_u32 s69, 663552
    s_cselect_b32 s69, 0, s69
L_G2T4_1:
    s_waitcnt lgkmcnt(7)
    s_add_u32 m0, s68, 5120
    v_mfma_f32_32x32x16_bf16 v[0:15], v[180:183], v[208:211], v[0:15]
    buffer_load_dwordx4 v217, s[36:39], s69 offen offset:0 lds
    s_waitcnt lgkmcnt(6)
    v_mfma_f32_32x32x16_bf16 v[16:31], v[180:183], v[212:215], v[16:31]
    v_add_u32 v220, s93, v223
    s_waitcnt vmcnt(8)
    ds_read_b128 v[200:203], v220 offset:0
    ds_read_b64_tr_b16 v[160:161], v219 offset:10240
    ds_read_b64_tr_b16 v[162:163], v219 offset:10752
    s_waitcnt lgkmcnt(7)
    s_add_u32 m0, s68, 6080
    v_mfma_f32_32x32x16_bf16 v[32:47], v[184:187], v[208:211], v[32:47]
    buffer_load_dwordx4 v217, s[36:39], s69 offen offset:64 lds
    v_mfma_f32_32x32x16_bf16 v[48:63], v[184:187], v[212:215], v[48:63]
    s_waitcnt vmcnt(8)
    ds_read_b128 v[204:207], v220 offset:512
    ds_read_b64_tr_b16 v[164:165], v219 offset:11264
    ds_read_b64_tr_b16 v[166:167], v219 offset:11776
    s_waitcnt lgkmcnt(8)
    s_add_u32 m0, s68, 7040
    v_mfma_f32_32x32x16_bf16 v[64:79], v[188:191], v[208:211], v[64:79]
    buffer_load_dwordx4 v217, s[36:39], s69 offen offset:128 lds
    v_mfma_f32_32x32x16_bf16 v[80:95], v[188:191], v[212:215], v[80:95]
    s_waitcnt vmcnt(8)
    ds_read_b64_tr_b16 v[168:169], v219 offset:12288
    ds_read_b64_tr_b16 v[170:171], v219 offset:12800
    s_add_u32 s93, s93, 2080
    s_cmp_eq_u32 s93, 74880
    s_cselect_b32 s93, 0, s93
    s_waitcnt lgkmcnt(8)
    s_add_u32 m0, s68, 8000
    v_mfma_f32_32x32x16_bf16 v[96:111], v[192:195], v[208:211], v[96:111]
    buffer_load_dwordx4 v217, s[36:39], s69 offen offset:192 lds
    v_mfma_f32_32x32x16_bf16 v[112:127], v[192:195], v[212:215], v[112:127]
    s_waitcnt vmcnt(8)
    ds_read_b64_tr_b16 v[172:173], v219 offset:13312
    ds_read_b64_tr_b16 v[174:175], v219 offset:13824
    s_add_u32 s69, s69, 18432
    s_cmp_eq_u32 s69, 663552
    s_cselect_b32 s69, 0, s69
    s_waitcnt lgkmcnt(7)
    s_add_u32 m0, s68, 10240
    v_mfma_f32_32x32x16_bf16 v[0:15], v[160:163], v[200:203], v[0:15]
    buffer_load_dwordx4 v217, s[36:39], s69 offen offset:0 lds
    s_waitcnt lgkmcnt(6)
    v_mfma_f32_32x32x16_bf16 v[16:31], v[160:163], v[204:207], v[16:31]
    v_add_u32 v220, s93, v223
    s_waitcnt vmcnt(8)
    ds_read_b128 v[208:211], v220 offset:0
    ds_read_b64_tr_b16 v[180:181], v219 offset:0
    ds_read_b64_tr_b16 v[182:183], v219 offset:512
    s_waitcnt lgkmcnt(7)
    s_add_u32 m0, s68, 11200
    v_mfma_f32_32x32x16_bf16 v[32:47], v[164:167], v[200:203], v[32:47]
    buffer_load_dwordx4 v217, s[36:39], s69 offen offset:64 lds
    v_mfma_f32_32x32x16_bf16 v[48:63], v[164:167], v[204:207], v[48:63]
    s_waitcnt vmcnt(8)
    ds_read_b128 v[212:215], v220 offset:512
    ds_read_b64_tr_b16 v[184:185], v219 offset:1024
    ds_read_b64_tr_b16 v[186:187], v219 offset:1536
    s_waitcnt lgkmcnt(8)
    s_add_u32 m0, s68, 12160
    v_mfma_f32_32x32x16_bf16 v[64:79], v[168:171], v[200:203], v[64:79]
    buffer_load_dwordx4 v217, s[36:39], s69 offen offset:128 lds
    v_mfma_f32_32x32x16_bf16 v[80:95], v[168:171], v[204:207], v[80:95]
    s_waitcnt vmcnt(8)
    ds_read_b64_tr_b16 v[188:189], v219 offset:2048
    ds_read_b64_tr_b16 v[190:191], v219 offset:2560
    s_add_u32 s93, s93, 2080
    s_cmp_eq_u32 s93, 74880
    s_cselect_b32 s93, 0, s93
    s_waitcnt lgkmcnt(8)
    s_add_u32 m0, s68, 13120
    v_mfma_f32_32x32x16_bf16 v[96:111], v[172:175], v[200:203], v[96:111]
    buffer_load_dwordx4 v217, s[36:39], s69 offen offset:192 lds
    v_mfma_f32_32x32x16_bf16 v[112:127], v[172:175], v[204:207], v[112:127]
    s_waitcnt vmcnt(8)
    ds_read_b64_tr_b16 v[192:193], v219 offset:3072
    ds_read_b64_tr_b16 v[194:195], v219 offset:3584
    s_add_u32 s69, s69, 18432
    s_cmp_eq_u32 s69, 663552
    s_cselect_b32 s69, 0, s69
    s_add_u32 s70, s70, 1
    s_cmp_lt_u32 s70, 6
    s_cbranch_scc1 L_G2T4_3
    s_waitcnt lgkmcnt(7)
    v_mfma_f32_32x32x16_bf16 v[0:15], v[180:183], v[208:211], v[0:15]
    s_waitcnt lgkmcnt(6)
    v_mfma_f32_32x32x16_bf16 v[16:31], v[180:183], v[212:215], v[16:31]
    v_add_u32 v220, s93, v223
    s_waitcnt vmcnt(7)
    ds_read_b128 v[200:203], v220 offset:0
    ds_read_b64_tr_b16 v[160:161], v219 offset:5120
    ds_read_b64_tr_b16 v[162:163], v219 offset:5632
    s_waitcnt lgkmcnt(7)
    v_mfma_f32_32x32x16_bf16 v[32:47], v[184:187], v[208:211], v[32:47]
    v_mfma_f32_32x32x16_bf16 v[48:63], v[184:187], v[212:215], v[48:63]
    s_waitcnt vmcnt(6)
    ds_read_b128 v[204:207], v220 offset:512
    ds_read_b64_tr_b16 v[164:165], v219 offset:6144
    ds_read_b64_tr_b16 v[166:167], v219 offset:6656
    s_waitcnt lgkmcnt(8)
    v_mfma_f32_32x32x16_bf16 v[64:79], v[188:191], v[208:211], v[64:79]
    v_mfma_f32_32x32x16_bf16 v[80:95], v[188:191], v[212:215], v[80:95]
    s_waitcnt vmcnt(5)
    ds_read_b64_tr_b16 v[168:169], v219 offset:7168
    ds_read_b64_tr_b16 v[170:171], v219 offset:7680
    s_add_u32 s93, s93, 2080
    s_cmp_eq_u32 s93, 74880
    s_cselect_b32 s93, 0, s93
    s_waitcnt lgkmcnt(8)
    v_mfma_f32_32x32x16_bf16 v[96:111], v[192:195], v[208:211], v[96:111]
    v_mfma_f32_32x32x16_bf16 v[112:127], v[192:195], v[212:215], v[112:127]
    s_waitcnt vmcnt(4)
    ds_read_b64_tr_b16 v[172:173], v219 offset:8192
    ds_read_b64_tr_b16 v[174:175], v219 offset:8704
    s_waitcnt lgkmcnt(7)
    v_mfma_f32_32x32x16_bf16 v[0:15], v[160:163], v[200:203], v[0:15]
    s_waitcnt lgkmcnt(6)
    v_mfma_f32_32x32x16_bf16 v[16:31], v[160:163], v[204:207], v[16:31]
    v_add_u32 v220, s93, v223
    s_waitcnt vmcnt(3)
    ds_read_b128 v[208:211], v220 offset:0
    ds_read_b64_tr_b16 v[180:181], v219 offset:10240
    ds_read_b64_tr_b16 v[182:183], v219 offset:10752
    s_waitcnt lgkmcnt(7)
    v_mfma_f32_32x32x16_bf16 v[32:47], v[164:167], v[200:203], v[32:47]
    v_mfma_f32_32x32x16_bf16 v[48:63], v[164:167], v[204:207], v[48:63]
    s_waitcnt vmcnt(2)
    ds_read_b128 v[212:215], v220 offset:512
    ds_read_b64_tr_b16 v[184:185], v219 offset:11264
    ds_read_b64_tr_b16 v[186:187], v219 offset:11776
    s_waitcnt lgkmcnt(8)
    v_mfma_f32_32x32x16_bf16 v[64:79], v[168:171], v[200:203], v[64:79]
    v_mfma_f32_32x32x16_bf16 v[80:95], v[168:171], v[204:207], v[80:95]
    s_waitcnt vmcnt(1)
    ds_read_b64_tr_b16 v[188:189], v219 offset:12288
    ds_read_b64_tr_b16 v[190:191], v219 offset:12800
    s_waitcnt lgkmcnt(8)
    v_mfma_f32_32x32x16_bf16 v[96:111], v[172:175], v[200:203], v[96:111]
    v_mfma_f32_32x32x16_bf16 v[112:127], v[172:175], v[204:207], v[112:127]
    s_waitcnt vmcnt(0)
    ds_read_b64_tr_b16 v[192:193], v219 offset:13312
    ds_read_b64_tr_b16 v[194:195], v219 offset:13824
    s_waitcnt lgkmcnt(7)
    v_mfma_f32_32x32x16_bf16 v[0:15], v[180:183], v[208:211], v[0:15]
    s_waitcnt lgkmcnt(6)
    v_mfma_f32_32x32x16_bf16 v[16:31], v[180:183], v[212:215], v[16:31]
    s_waitcnt lgkmcnt(4)
    v_mfma_f32_32x32x16_bf16 v[32:47], v[184:187], v[208:211], v[32:47]
    v_mfma_f32_32x32x16_bf16 v[48:63], v[184:187], v[212:215], v[48:63]
    s_waitcnt lgkmcnt(2)
    v_mfma_f32_32x32x16_bf16 v[64:79], v[188:191], v[208:211], v[64:79]
    v_mfma_f32_32x32x16_bf16 v[80:95], v[188:191], v[212:215], v[80:95]
    s_waitcnt lgkmcnt(0)
    v_mfma_f32_32x32x16_bf16 v[96:111], v[192:195], v[208:211], v[96:111]
    v_mfma_f32_32x32x16_bf16 v[112:127], v[192:195], v[212:215], v[112:127]
    v_mov_b32 v252, 163584
    v_mov_b32 v253, 1
    s_mov_b64 exec, 1
    ds_add_u32 v252, v253 offset:20
    s_mov_b64 exec, -1
    s_lshl_b32 s77, s65, 13
    s_lshl_b32 s78, s66, 12
    s_add_u32 s77, s77, s78
    s_add_u32 s77, s77, s95
    s_add_u32 s77, s77, 589824
    s_lshl_b32 s78, s65, 10
    s_add_u32 s78, s78, s95
    s_add_u32 s78, s78, 655360
    v_lshlrev_b32 v168, 4, v250
    v_mov_b32 v172, -1
    v_mov_b32 v173, -1
    v_mov_b32 v174, -1
    v_mov_b32 v175, -1
    buffer_store_dwordx4 v[172:175], v168, s[52:55], s77 offen offset:0 sc1
    buffer_store_dwordx4 v[172:175], v168, s[52:55], s77 offen offset:1024 sc1
    buffer_store_dwordx4 v[172:175], v168, s[52:55], s77 offen offset:2048 sc1
    buffer_store_dwordx4 v[172:175], v168, s[52:55], s77 offen offset:3072 sc1
    buffer_store_dwordx4 v[172:175], v168, s[52:55], s78 offen sc1
    s_nop 1
    v_cvt_pk_bf16_f32 v0, v0, v1
    v_cvt_pk_bf16_f32 v1, v2, v3
    v_cvt_pk_bf16_f32 v2, v4, v5
    v_cvt_pk_bf16_f32 v3, v6, v7
    v_cvt_pk_bf16_f32 v4, v8, v9
    v_cvt_pk_bf16_f32 v5, v10, v11
    v_cvt_pk_bf16_f32 v6, v12, v13
    v_cvt_pk_bf16_f32 v7, v14, v15
    s_mov_b32 s77, 0
    s_mov_b32 s78, 16384
    v_permlane32_swap_b32 v0, v2
    v_permlane32_swap_b32 v1, v3
    v_permlane32_swap_b32 v4, v6
    v_permlane32_swap_b32 v5, v7
    buffer_store_dwordx4 v[0:3], v222, s[52:55], s77 offen offset:0 sc1
    buffer_store_dwordx4 v[4:7], v222, s[52:55], s78 offen offset:0 sc1
    s_waitcnt vmcnt(4)
    v_cvt_pk_bf16_f32 v16, v16, v17
    v_cvt_pk_bf16_f32 v17, v18, v19
    v_cvt_pk_bf16_f32 v18, v20, v21
    v_cvt_pk_bf16_f32 v19, v22, v23
    v_cvt_pk_bf16_f32 v20, v24, v25
    v_cvt_pk_bf16_f32 v21, v26, v27
    v_cvt_pk_bf16_f32 v22, v28, v29
    v_cvt_pk_bf16_f32 v23, v30, v31
    s_mov_b32 s77, 0
    s_mov_b32 s78, 16384
    v_permlane32_swap_b32 v16, v18
    v_permlane32_swap_b32 v17, v19
    v_permlane32_swap_b32 v20, v22
    v_permlane32_swap_b32 v21, v23
    buffer_store_dwordx4 v[16:19], v222, s[52:55], s77 offen offset:512 sc1
    buffer_store_dwordx4 v[20:23], v222, s[52:55], s78 offen offset:512 sc1
    s_waitcnt vmcnt(4)
    v_cvt_pk_bf16_f32 v32, v32, v33
    v_cvt_pk_bf16_f32 v33, v34, v35
    v_cvt_pk_bf16_f32 v34, v36, v37
    v_cvt_pk_bf16_f32 v35, v38, v39
    v_cvt_pk_bf16_f32 v36, v40, v41
    v_cvt_pk_bf16_f32 v37, v42, v43
    v_cvt_pk_bf16_f32 v38, v44, v45
    v_cvt_pk_bf16_f32 v39, v46, v47
    s_mov_b32 s77, 32768
    s_mov_b32 s78, 49152
    v_permlane32_swap_b32 v32, v34
    v_permlane32_swap_b32 v33, v35
    v_permlane32_swap_b32 v36, v38
    v_permlane32_swap_b32 v37, v39
    buffer_store_dwordx4 v[32:35], v222, s[52:55], s77 offen offset:0 sc1
    buffer_store_dwordx4 v[36:39], v222, s[52:55], s78 offen offset:0 sc1
    s_waitcnt vmcnt(4)
    v_cvt_pk_bf16_f32 v48, v48, v49
    v_cvt_pk_bf16_f32 v49, v50, v51
    v_cvt_pk_bf16_f32 v50, v52, v53
    v_cvt_pk_bf16_f32 v51, v54, v55
    v_cvt_pk_bf16_f32 v52, v56, v57
    v_cvt_pk_bf16_f32 v53, v58, v59
    v_cvt_pk_bf16_f32 v54, v60, v61
    v_cvt_pk_bf16_f32 v55, v62, v63
    s_mov_b32 s77, 32768
    s_mov_b32 s78, 49152
    v_permlane32_swap_b32 v48, v50
    v_permlane32_swap_b32 v49, v51
    v_permlane32_swap_b32 v52, v54
    v_permlane32_swap_b32 v53, v55
    buffer_store_dwordx4 v[48:51], v222, s[52:55], s77 offen offset:512 sc1
    buffer_store_dwordx4 v[52:55], v222, s[52:55], s78 offen offset:512 sc1
    s_waitcnt vmcnt(4)
    v_cvt_pk_bf16_f32 v64, v64, v65
    v_cvt_pk_bf16_f32 v65, v66, v67
    v_cvt_pk_bf16_f32 v66, v68, v69
    v_cvt_pk_bf16_f32 v67, v70, v71
    v_cvt_pk_bf16_f32 v68, v72, v73
    v_cvt_pk_bf16_f32 v69, v74, v75
    v_cvt_pk_bf16_f32 v70, v76, v77
    v_cvt_pk_bf16_f32 v71, v78, v79
    s_mov_b32 s77, 65536
    s_mov_b32 s78, 81920
    v_permlane32_swap_b32 v64, v66
    v_permlane32_swap_b32 v65, v67
    v_permlane32_swap_b32 v68, v70
    v_permlane32_swap_b32 v69, v71
    buffer_store_dwordx4 v[64:67], v222, s[52:55], s77 offen offset:0 sc1
    buffer_store_dwordx4 v[68:71], v222, s[52:55], s78 offen offset:0 sc1
    s_waitcnt vmcnt(4)
    v_cvt_pk_bf16_f32 v80, v80, v81
    v_cvt_pk_bf16_f32 v81, v82, v83
    v_cvt_pk_bf16_f32 v82, v84, v85
    v_cvt_pk_bf16_f32 v83, v86, v87
    v_cvt_pk_bf16_f32 v84, v88, v89
    v_cvt_pk_bf16_f32 v85, v90, v91
    v_cvt_pk_bf16_f32 v86, v92, v93
    v_cvt_pk_bf16_f32 v87, v94, v95
    s_mov_b32 s77, 65536
    s_mov_b32 s78, 81920
    v_permlane32_swap_b32 v80, v82
    v_permlane32_swap_b32 v81, v83
    v_permlane32_swap_b32 v84, v86
    v_permlane32_swap_b32 v85, v87
    buffer_store_dwordx4 v[80:83], v222, s[52:55], s77 offen offset:512 sc1
    buffer_store_dwordx4 v[84:87], v222, s[52:55], s78 offen offset:512 sc1
    s_waitcnt vmcnt(4)
    v_cvt_pk_bf16_f32 v96, v96, v97
    v_cvt_pk_bf16_f32 v97, v98, v99
    v_cvt_pk_bf16_f32 v98, v100, v101
    v_cvt_pk_bf16_f32 v99, v102, v103
    v_cvt_pk_bf16_f32 v100, v104, v105
    v_cvt_pk_bf16_f32 v101, v106, v107
    v_cvt_pk_bf16_f32 v102, v108, v109
    v_cvt_pk_bf16_f32 v103, v110, v111
    s_mov_b32 s77, 98304
    s_mov_b32 s78, 114688
    v_permlane32_swap_b32 v96, v98
    v_permlane32_swap_b32 v97, v99
    v_permlane32_swap_b32 v100, v102
    v_permlane32_swap_b32 v101, v103
    buffer_store_dwordx4 v[96:99], v222, s[52:55], s77 offen offset:0 sc1
    buffer_store_dwordx4 v[100:103], v222, s[52:55], s78 offen offset:0 sc1
    s_waitcnt vmcnt(4)
    v_cvt_pk_bf16_f32 v112, v112, v113
    v_cvt_pk_bf16_f32 v113, v114, v115
    v_cvt_pk_bf16_f32 v114, v116, v117
    v_cvt_pk_bf16_f32 v115, v118, v119
    v_cvt_pk_bf16_f32 v116, v120, v121
    v_cvt_pk_bf16_f32 v117, v122, v123
    v_cvt_pk_bf16_f32 v118, v124, v125
    v_cvt_pk_bf16_f32 v119, v126, v127
    s_mov_b32 s77, 98304
    s_mov_b32 s78, 114688
    v_permlane32_swap_b32 v112, v114
    v_permlane32_swap_b32 v113, v115
    v_permlane32_swap_b32 v116, v118
    v_permlane32_swap_b32 v117, v119
    buffer_store_dwordx4 v[112:115], v222, s[52:55], s77 offen offset:512 sc1
    buffer_store_dwordx4 v[116:119], v222, s[52:55], s78 offen offset:512 sc1
    s_waitcnt vmcnt(4)
    s_branch L_FFN_J
L_FFN_L:
    s_mul_i32 s93, s92, 2080
    v_add_u32 v220, s93, v223
    s_waitcnt vmcnt(14)
    ds_read_b64_tr_b16 v[160:161], v218 offset:9216
    ds_read_b64_tr_b16 v[162:163], v218 offset:9472
    ds_read_b128 v[164:167], v220 offset:0
    ds_read_b128 v[168:171], v220 offset:512
    s_add_u32 s93, s93, 2080
    s_cmp_eq_u32 s93, 74880
    s_cselect_b32 s93, 0, s93
    v_add_u32 v220, s93, v223
    s_waitcnt vmcnt(13)
    ds_read_b64_tr_b16 v[172:173], v218 offset:10240
    ds_read_b64_tr_b16 v[174:175], v218 offset:10496
    ds_read_b128 v[176:179], v220 offset:0
    ds_read_b128 v[180:183], v220 offset:512
    s_add_u32 s93, s93, 2080
    s_cmp_eq_u32 s93, 74880
    s_cselect_b32 s93, 0, s93
    s_waitcnt lgkmcnt(4)
    s_add_u32 m0, s68, 9216
    v_mfma_f32_32x32x16_bf16 v[128:143], v[160:163], v[164:167], 0
    buffer_load_dwordx4 v224, s[40:43], s96 offen lds
    s_add_u32 s96, s96, 18432
    s_cmp_eq_u32 s96, 663552
    s_cselect_b32 s96, 0, s96
    v_mfma_f32_32x32x16_bf16 v[144:159], v[160:163], v[168:171], 0
    v_add_u32 v220, s93, v223
    s_waitcnt vmcnt(13)
    ds_read_b64_tr_b16 v[184:185], v218 offset:11264
    ds_read_b64_tr_b16 v[186:187], v218 offset:11520
    ds_read_b128 v[188:191], v220 offset:0
    ds_read_b128 v[192:195], v220 offset:512
    s_add_u32 s93, s93, 2080
    s_cmp_eq_u32 s93, 74880
    s_cselect_b32 s93, 0, s93
    s_waitcnt lgkmcnt(4)
    s_add_u32 m0, s68, 10240
    v_mfma_f32_32x32x16_bf16 v[128:143], v[172:175], v[176:179], v[128:143]
    buffer_load_dwordx4 v224, s[40:43], s96 offen lds
    s_add_u32 s96, s96, 18432
    s_cmp_eq_u32 s96, 663552
    s_cselect_b32 s96, 0, s96
    v_mfma_f32_32x32x16_bf16 v[144:159], v[172:175], v[180:183], v[144:159]
    v_add_u32 v220, s93, v223
    s_waitcnt vmcnt(13)
    ds_read_b64_tr_b16 v[160:161], v218 offset:12288
    ds_read_b64_tr_b16 v[162:163], v218 offset:12544
    ds_read_b128 v[164:167], v220 offset:0
    ds_read_b128 v[168:171], v220 offset:512
    s_add_u32 s93, s93, 2080
    s_cmp_eq_u32 s93, 74880
    s_cselect_b32 s93, 0, s93
    s_waitcnt lgkmcnt(4)
    s_add_u32 m0, s68, 11264
    v_mfma_f32_32x32x16_bf16 v[128:143], v[184:187], v[188:191], v[128:143]
    buffer_load_dwordx4 v224, s[40:43], s96 offen lds
    s_add_u32 s96, s96, 18432
    s_cmp_eq_u32 s96, 663552
    s_cselect_b32 s96, 0, s96
    v_mfma_f32_32x32x16_bf16 v[144:159], v[184:187], v[192:195], v[144:159]
    v_add_u32 v220, s93, v223
    s_waitcnt vmcnt(13)
    ds_read_b64_tr_b16 v[172:173], v218 offset:13312
    ds_read_b64_tr_b16 v[174:175], v218 offset:13568
    ds_read_b128 v[176:179], v220 offset:0
    ds_read_b128 v[180:183], v220 offset:512
    s_add_u32 s93, s93, 2080
    s_cmp_eq_u32 s93, 74880
    s_cselect_b32 s93, 0, s93
    s_waitcnt lgkmcnt(4)
    s_add_u32 m0, s68, 12288
    v_mfma_f32_32x32x16_bf16 v[128:143], v[160:163], v[164:167], v[128:143]
    buffer_load_dwordx4 v224, s[40:43], s96 offen lds
    s_add_u32 s96, s96, 18432
    s_cmp_eq_u32 s96, 663552
    s_cselect_b32 s96, 0, s96
    v_mfma_f32_32x32x16_bf16 v[144:159], v[160:163], v[168:171], v[144:159]
    v_add_u32 v220, s93, v223
    s_waitcnt vmcnt(13)
    ds_read_b64_tr_b16 v[184:185], v218 offset:14336
    ds_read_b64_tr_b16 v[186:187], v218 offset:14592
    ds_read_b128 v[188:191], v220 offset:0
    ds_read_b128 v[192:195], v220 offset:512
    s_add_u32 s93, s93, 2080
    s_cmp_eq_u32 s93, 74880
    s_cselect_b32 s93, 0, s93
    s_waitcnt lgkmcnt(4)
    s_add_u32 m0, s68, 13312
    v_mfma_f32_32x32x16_bf16 v[128:143], v[172:175], v[176:179], v[128:143]
    buffer_load_dwordx4 v224, s[40:43], s96 offen lds
    s_add_u32 s96, s96, 18432
    s_cmp_eq_u32 s96, 663552
    s_cselect_b32 s96, 0, s96
    v_mfma_f32_32x32x16_bf16 v[144:159], v[172:175], v[180:183], v[144:159]
    v_add_u32 v220, s93, v223
    s_waitcnt vmcnt(13)
    ds_read_b64_tr_b16 v[160:161], v218 offset:0
    ds_read_b64_tr_b16 v[162:163], v218 offset:256
    ds_read_b128 v[164:167], v220 offset:0
    ds_read_b128 v[168:171], v220 offset:512
    s_add_u32 s93, s93, 2080
    s_cmp_eq_u32 s93, 74880
    s_cselect_b32 s93, 0, s93
    s_waitcnt lgkmcnt(4)
    s_add_u32 m0, s68, 14336
    v_mfma_f32_32x32x16_bf16 v[128:143], v[184:187], v[188:191], v[128:143]
    buffer_load_dwordx4 v224, s[40:43], s96 offen lds
    s_add_u32 s96, s96, 18432
    s_cmp_eq_u32 s96, 663552
    s_cselect_b32 s96, 0, s96
    v_mfma_f32_32x32x16_bf16 v[144:159], v[184:187], v[192:195], v[144:159]
    v_add_u32 v220, s93, v223
    s_waitcnt vmcnt(13)
    ds_read_b64_tr_b16 v[172:173], v218 offset:1024
    ds_read_b64_tr_b16 v[174:175], v218 offset:1280
    ds_read_b128 v[176:179], v220 offset:0
    ds_read_b128 v[180:183], v220 offset:512
    s_add_u32 s93, s93, 2080
    s_cmp_eq_u32 s93, 74880
    s_cselect_b32 s93, 0, s93
    s_waitcnt lgkmcnt(4)
    s_add_u32 m0, s68, 0
    v_mfma_f32_32x32x16_bf16 v[128:143], v[160:163], v[164:167], v[128:143]
    buffer_load_dwordx4 v224, s[40:43], s96 offen lds
    s_add_u32 s96, s96, 18432
    s_cmp_eq_u32 s96, 663552
    s_cselect_b32 s96, 0, s96
    v_mfma_f32_32x32x16_bf16 v[144:159], v[160:163], v[168:171], v[144:159]
    v_add_u32 v220, s93, v223
    s_waitcnt vmcnt(13)
    ds_read_b64_tr_b16 v[184:185], v218 offset:2048
    ds_read_b64_tr_b16 v[186:187], v218 offset:2304
    ds_read_b128 v[188:191], v220 offset:0
    ds_read_b128 v[192:195], v220 offset:512
    s_add_u32 s93, s93, 2080
    s_cmp_eq_u32 s93, 74880
    s_cselect_b32 s93, 0, s93
    s_waitcnt lgkmcnt(4)
    s_add_u32 m0, s68, 1024
    v_mfma_f32_32x32x16_bf16 v[128:143], v[172:175], v[176:179], v[128:143]
    buffer_load_dwordx4 v224, s[40:43], s96 offen lds
    s_add_u32 s96, s96, 18432
    s_cmp_eq_u32 s96, 663552
    s_cselect_b32 s96, 0, s96
    v_mfma_f32_32x32x16_bf16 v[144:159], v[172:175], v[180:183], v[144:159]
    v_add_u32 v220, s93, v223
    s_waitcnt vmcnt(13)
    ds_read_b64_tr_b16 v[160:161], v218 offset:3072
    ds_read_b64_tr_b16 v[162:163], v218 offset:3328
    ds_read_b128 v[164:167], v220 offset:0
    ds_read_b128 v[168:171], v220 offset:512
    s_add_u32 s93, s93, 2080
    s_cmp_eq_u32 s93, 74880
    s_cselect_b32 s93, 0, s93
    s_waitcnt lgkmcnt(4)
    s_add_u32 m0, s68, 2048
    v_mfma_f32_32x32x16_bf16 v[128:143], v[184:187], v[188:191], v[128:143]
    buffer_load_dwordx4 v224, s[40:43], s96 offen lds
    s_add_u32 s96, s96, 18432
    s_cmp_eq_u32 s96, 663552
    s_cselect_b32 s96, 0, s96
    v_mfma_f32_32x32x16_bf16 v[144:159], v[184:187], v[192:195], v[144:159]
    v_add_u32 v220, s93, v223
    s_waitcnt vmcnt(13)
    ds_read_b64_tr_b16 v[172:173], v218 offset:4096
    ds_read_b64_tr_b16 v[174:175], v218 offset:4352
    ds_read_b128 v[176:179], v220 offset:0
    ds_read_b128 v[180:183], v220 offset:512
    s_add_u32 s93, s93, 2080
    s_cmp_eq_u32 s93, 74880
    s_cselect_b32 s93, 0, s93
    s_waitcnt lgkmcnt(4)
    s_add_u32 m0, s68, 3072
    v_mfma_f32_32x32x16_bf16 v[128:143], v[160:163], v[164:167], v[128:143]
    buffer_load_dwordx4 v224, s[40:43], s96 offen lds
    s_add_u32 s96, s96, 18432
    s_cmp_eq_u32 s96, 663552
    s_cselect_b32 s96, 0, s96
    v_mfma_f32_32x32x16_bf16 v[144:159], v[160:163], v[168:171], v[144:159]
    v_add_u32 v220, s93, v223
    s_waitcnt vmcnt(13)
    ds_read_b64_tr_b16 v[184:185], v218 offset:5120
    ds_read_b64_tr_b16 v[186:187], v218 offset:5376
    ds_read_b128 v[188:191], v220 offset:0
    ds_read_b128 v[192:195], v220 offset:512
    s_add_u32 s93, s93, 2080
    s_cmp_eq_u32 s93, 74880
    s_cselect_b32 s93, 0, s93
    s_waitcnt lgkmcnt(4)
    s_add_u32 m0, s68, 4096
    v_mfma_f32_32x32x16_bf16 v[128:143], v[172:175], v[176:179], v[128:143]
    buffer_load_dwordx4 v224, s[40:43], s96 offen lds
    s_add_u32 s96, s96, 18432
    s_cmp_eq_u32 s96, 663552
    s_cselect_b32 s96, 0, s96
    v_mfma_f32_32x32x16_bf16 v[144:159], v[172:175], v[180:183], v[144:159]
    v_add_u32 v220, s93, v223
    s_waitcnt vmcnt(13)
    ds_read_b64_tr_b16 v[160:161], v218 offset:6144
    ds_read_b64_tr_b16 v[162:163], v218 offset:6400
    ds_read_b128 v[164:167], v220 offset:0
    ds_read_b128 v[168:171], v220 offset:512
    s_add_u32 s93, s93, 2080
    s_cmp_eq_u32 s93, 74880
    s_cselect_b32 s93, 0, s93
    s_waitcnt lgkmcnt(4)
    s_add_u32 m0, s68, 5120
    v_mfma_f32_32x32x16_bf16 v[128:143], v[184:187], v[188:191], v[128:143]
    buffer_load_dwordx4 v224, s[40:43], s96 offen lds
    s_add_u32 s96, s96, 18432
    s_cmp_eq_u32 s96, 663552
    s_cselect_b32 s96, 0, s96
    v_mfma_f32_32x32x16_bf16 v[144:159], v[184:187], v[192:195], v[144:159]
    v_add_u32 v220, s93, v223
    s_waitcnt vmcnt(13)
    ds_read_b64_tr_b16 v[172:173], v218 offset:7168
    ds_read_b64_tr_b16 v[174:175], v218 offset:7424
    ds_read_b128 v[176:179], v220 offset:0
    ds_read_b128 v[180:183], v220 offset:512
    s_add_u32 s93, s93, 2080
    s_cmp_eq_u32 s93, 74880
    s_cselect_b32 s93, 0, s93
    s_waitcnt lgkmcnt(4)
    s_add_u32 m0, s68, 6144
    v_mfma_f32_32x32x16_bf16 v[128:143], v[160:163], v[164:167], v[128:143]
    buffer_load_dwordx4 v224, s[40:43], s96 offen lds
    s_add_u32 s96, s96, 18432
    s_cmp_eq_u32 s96, 663552
    s_cselect_b32 s96, 0, s96
    v_mfma_f32_32x32x16_bf16 v[144:159], v[160:163], v[168:171], v[144:159]
    v_add_u32 v220, s93, v223
    s_waitcnt vmcnt(13)
    ds_read_b64_tr_b16 v[184:185], v218 offset:8192
    ds_read_b64_tr_b16 v[186:187], v218 offset:8448
    ds_read_b128 v[188:191], v220 offset:0
    ds_read_b128 v[192:195], v220 offset:512
    s_add_u32 s93, s93, 2080
    s_cmp_eq_u32 s93, 74880
    s_cselect_b32 s93, 0, s93
    s_waitcnt lgkmcnt(4)
    s_add_u32 m0, s68, 7168
    v_mfma_f32_32x32x16_bf16 v[128:143], v[172:175], v[176:179], v[128:143]
    buffer_load_dwordx4 v224, s[40:43], s96 offen lds
    s_add_u32 s96, s96, 18432
    s_cmp_eq_u32 s96, 663552
    s_cselect_b32 s96, 0, s96
    v_mfma_f32_32x32x16_bf16 v[144:159], v[172:175], v[180:183], v[144:159]
    v_add_u32 v220, s93, v223
    s_waitcnt vmcnt(13)
    ds_read_b64_tr_b16 v[160:161], v218 offset:9216
    ds_read_b64_tr_b16 v[162:163], v218 offset:9472
    ds_read_b128 v[164:167], v220 offset:0
    ds_read_b128 v[168:171], v220 offset:512
    s_add_u32 s93, s93, 2080
    s_cmp_eq_u32 s93, 74880
    s_cselect_b32 s93, 0, s93
    s_waitcnt lgkmcnt(4)
    s_add_u32 m0, s68, 8192
    v_mfma_f32_32x32x16_bf16 v[128:143], v[184:187], v[188:191], v[128:143]
    buffer_load_dwordx4 v224, s[40:43], s96 offen lds
    s_add_u32 s96, s96, 18432
    s_cmp_eq_u32 s96, 663552
    s_cselect_b32 s96, 0, s96
    v_mfma_f32_32x32x16_bf16 v[144:159], v[184:187], v[192:195], v[144:159]
    v_add_u32 v220, s93, v223
    s_waitcnt vmcnt(13)
    ds_read_b64_tr_b16 v[172:173], v218 offset:10240
    ds_read_b64_tr_b16 v[174:175], v218 offset:10496
    ds_read_b128 v[176:179], v220 offset:0
    ds_read_b128 v[180:183], v220 offset:512
    s_add_u32 s93, s93, 2080
    s_cmp_eq_u32 s93, 74880
    s_cselect_b32 s93, 0, s93
    s_waitcnt lgkmcnt(4)
    s_add_u32 m0, s68, 9216
    v_mfma_f32_32x32x16_bf16 v[128:143], v[160:163], v[164:167], v[128:143]
    buffer_load_dwordx4 v224, s[40:43], s96 offen lds
    s_add_u32 s96, s96, 18432
    s_cmp_eq_u32 s96, 663552
    s_cselect_b32 s96, 0, s96
    v_mfma_f32_32x32x16_bf16 v[144:159], v[160:163], v[168:171], v[144:159]
    v_add_u32 v220, s93, v223
    s_waitcnt vmcnt(13)
    ds_read_b64_tr_b16 v[184:185], v218 offset:11264
    ds_read_b64_tr_b16 v[186:187], v218 offset:11520
    ds_read_b128 v[188:191], v220 offset:0
    ds_read_b128 v[192:195], v220 offset:512
    s_add_u32 s93, s93, 2080
    s_cmp_eq_u32 s93, 74880
    s_cselect_b32 s93, 0, s93
    s_waitcnt lgkmcnt(4)
    s_add_u32 m0, s68, 10240
    v_mfma_f32_32x32x16_bf16 v[128:143], v[172:175], v[176:179], v[128:143]
    buffer_load_dwordx4 v224, s[40:43], s96 offen lds
    s_add_u32 s96, s96, 18432
    s_cmp_eq_u32 s96, 663552
    s_cselect_b32 s96, 0, s96
    v_mfma_f32_32x32x16_bf16 v[144:159], v[172:175], v[180:183], v[144:159]
    v_add_u32 v220, s93, v223
    s_waitcnt vmcnt(13)
    ds_read_b64_tr_b16 v[160:161], v218 offset:12288
    ds_read_b64_tr_b16 v[162:163], v218 offset:12544
    ds_read_b128 v[164:167], v220 offset:0
    ds_read_b128 v[168:171], v220 offset:512
    s_add_u32 s93, s93, 2080
    s_cmp_eq_u32 s93, 74880
    s_cselect_b32 s93, 0, s93
    s_waitcnt lgkmcnt(4)
    s_add_u32 m0, s68, 11264
    v_mfma_f32_32x32x16_bf16 v[128:143], v[184:187], v[188:191], v[128:143]
    buffer_load_dwordx4 v224, s[40:43], s96 offen lds
    s_add_u32 s96, s96, 18432
    s_cmp_eq_u32 s96, 663552
    s_cselect_b32 s96, 0, s96
    v_mfma_f32_32x32x16_bf16 v[144:159], v[184:187], v[192:195], v[144:159]
    v_add_u32 v220, s93, v223
    s_waitcnt vmcnt(13)
    ds_read_b64_tr_b16 v[172:173], v218 offset:13312
    ds_read_b64_tr_b16 v[174:175], v218 offset:13568
    ds_read_b128 v[176:179], v220 offset:0
    ds_read_b128 v[180:183], v220 offset:512
    s_add_u32 s93, s93, 2080
    s_cmp_eq_u32 s93, 74880
    s_cselect_b32 s93, 0, s93
    s_waitcnt lgkmcnt(4)
    s_add_u32 m0, s68, 12288
    v_mfma_f32_32x32x16_bf16 v[128:143], v[160:163], v[164:167], v[128:143]
    buffer_load_dwordx4 v224, s[40:43], s96 offen lds
    s_add_u32 s96, s96, 18432
    s_cmp_eq_u32 s96, 663552
    s_cselect_b32 s96, 0, s96
    v_mfma_f32_32x32x16_bf16 v[144:159], v[160:163], v[168:171], v[144:159]
    v_add_u32 v220, s93, v223
    s_waitcnt vmcnt(13)
    ds_read_b64_tr_b16 v[184:185], v218 offset:14336
    ds_read_b64_tr_b16 v[186:187], v218 offset:14592
    ds_read_b128 v[188:191], v220 offset:0
    ds_read_b128 v[192:195], v220 offset:512
    s_add_u32 s93, s93, 2080
    s_cmp_eq_u32 s93, 74880
    s_cselect_b32 s93, 0, s93
    s_waitcnt lgkmcnt(4)
    s_add_u32 m0, s68, 13312
    v_mfma_f32_32x32x16_bf16 v[128:143], v[172:175], v[176:179], v[128:143]
    buffer_load_dwordx4 v224, s[40:43], s96 offen lds
    s_add_u32 s96, s96, 18432
    s_cmp_eq_u32 s96, 663552
    s_cselect_b32 s96, 0, s96
    v_mfma_f32_32x32x16_bf16 v[144:159], v[172:175], v[180:183], v[144:159]
    v_add_u32 v220, s93, v223
    s_waitcnt vmcnt(13)
    ds_read_b64_tr_b16 v[160:161], v218 offset:0
    ds_read_b64_tr_b16 v[162:163], v218 offset:256
    ds_read_b128 v[164:167], v220 offset:0
    ds_read_b128 v[168:171], v220 offset:512
    s_add_u32 s93, s93, 2080
    s_cmp_eq_u32 s93, 74880
    s_cselect_b32 s93, 0, s93
    s_waitcnt lgkmcnt(4)
    s_add_u32 m0, s68, 14336
    v_mfma_f32_32x32x16_bf16 v[128:143], v[184:187], v[188:191], v[128:143]
    buffer_load_dwordx4 v224, s[40:43], s96 offen lds
    s_add_u32 s96, s96, 18432
    s_cmp_eq_u32 s96, 663552
    s_cselect_b32 s96, 0, s96
    v_mfma_f32_32x32x16_bf16 v[144:159], v[184:187], v[192:195], v[144:159]
    v_add_u32 v220, s93, v223
    s_waitcnt vmcnt(13)
    ds_read_b64_tr_b16 v[172:173], v218 offset:1024
    ds_read_b64_tr_b16 v[174:175], v218 offset:1280
    ds_read_b128 v[176:179], v220 offset:0
    ds_read_b128 v[180:183], v220 offset:512
    s_add_u32 s93, s93, 2080
    s_cmp_eq_u32 s93, 74880
    s_cselect_b32 s93, 0, s93
    s_waitcnt lgkmcnt(4)
    s_add_u32 m0, s68, 0
    v_mfma_f32_32x32x16_bf16 v[128:143], v[160:163], v[164:167], v[128:143]
    buffer_load_dwordx4 v216, s[32:35], s69 offen offset:0 lds
    v_mfma_f32_32x32x16_bf16 v[144:159], v[160:163], v[168:171], v[144:159]
    v_add_u32 v220, s93, v223
    s_waitcnt vmcnt(13)
    ds_read_b64_tr_b16 v[184:185], v218 offset:2048
    ds_read_b64_tr_b16 v[186:187], v218 offset:2304
    ds_read_b128 v[188:191], v220 offset:0
    ds_read_b128 v[192:195], v220 offset:512
    s_add_u32 s93, s93, 2080
    s_cmp_eq_u32 s93, 74880
    s_cselect_b32 s93, 0, s93
    s_waitcnt lgkmcnt(4)
    s_add_u32 m0, s68, 960
    v_mfma_f32_32x32x16_bf16 v[128:143], v[172:175], v[176:179], v[128:143]
    buffer_load_dwordx4 v216, s[32:35], s69 offen offset:64 lds
    v_mfma_f32_32x32x16_bf16 v[144:159], v[172:175], v[180:183], v[144:159]
    v_add_u32 v220, s93, v223
    s_waitcnt vmcnt(13)
    ds_read_b64_tr_b16 v[160:161], v218 offset:3072
    ds_read_b64_tr_b16 v[162:163], v218 offset:3328
    ds_read_b128 v[164:167], v220 offset:0
    ds_read_b128 v[168:171], v220 offset:512
    s_add_u32 s93, s93, 2080
    s_cmp_eq_u32 s93, 74880
    s_cselect_b32 s93, 0, s93
    s_waitcnt lgkmcnt(4)
    s_add_u32 m0, s68, 1920
    v_mfma_f32_32x32x16_bf16 v[128:143], v[184:187], v[188:191], v[128:143]
    buffer_load_dwordx4 v216, s[32:35], s69 offen offset:128 lds
    v_mfma_f32_32x32x16_bf16 v[144:159], v[184:187], v[192:195], v[144:159]
    v_add_u32 v220, s93, v223
    s_waitcnt vmcnt(13)
    ds_read_b64_tr_b16 v[172:173], v218 offset:4096
    ds_read_b64_tr_b16 v[174:175], v218 offset:4352
    ds_read_b128 v[176:179], v220 offset:0
    ds_read_b128 v[180:183], v220 offset:512
    s_add_u32 s93, s93, 2080
    s_cmp_eq_u32 s93, 74880
    s_cselect_b32 s93, 0, s93
    s_waitcnt lgkmcnt(4)
    s_add_u32 m0, s68, 2880
    v_mfma_f32_32x32x16_bf16 v[128:143], v[160:163], v[164:167], v[128:143]
    buffer_load_dwordx4 v216, s[32:35], s69 offen offset:192 lds
    s_add_u32 s69, s69, 147456
    s_cmp_eq_u32 s69, 5308416
    s_cselect_b32 s69, 0, s69
    v_mfma_f32_32x32x16_bf16 v[144:159], v[160:163], v[168:171], v[144:159]
    v_add_u32 v220, s93, v223
    s_waitcnt vmcnt(13)
    ds_read_b64_tr_b16 v[184:185], v218 offset:5120
    ds_read_b64_tr_b16 v[186:187], v218 offset:5376
    ds_read_b128 v[188:191], v220 offset:0
    ds_read_b128 v[192:195], v220 offset:512
    s_add_u32 s93, s93, 2080
    s_cmp_eq_u32 s93, 74880
    s_cselect_b32 s93, 0, s93
    s_waitcnt lgkmcnt(4)
    v_mfma_f32_32x32x16_bf16 v[128:143], v[172:175], v[176:179], v[128:143]
    v_mfma_f32_32x32x16_bf16 v[144:159], v[172:175], v[180:183], v[144:159]
    v_add_u32 v220, s93, v223
    s_waitcnt vmcnt(12)
    ds_read_b64_tr_b16 v[160:161], v218 offset:6144
    ds_read_b64_tr_b16 v[162:163], v218 offset:6400
    ds_read_b128 v[164:167], v220 offset:0
    ds_read_b128 v[168:171], v220 offset:512
    s_add_u32 s93, s93, 2080
    s_cmp_eq_u32 s93, 74880
    s_cselect_b32 s93, 0, s93
    s_waitcnt lgkmcnt(4)
    s_add_u32 m0, s68, 5120
    v_mfma_f32_32x32x16_bf16 v[128:143], v[184:187], v[188:191], v[128:143]
    buffer_load_dwordx4 v216, s[32:35], s69 offen offset:0 lds
    v_mfma_f32_32x32x16_bf16 v[144:159], v[184:187], v[192:195], v[144:159]
    v_add_u32 v220, s93, v223
    s_waitcnt vmcnt(12)
    ds_read_b64_tr_b16 v[172:173], v218 offset:7168
    ds_read_b64_tr_b16 v[174:175], v218 offset:7424
    ds_read_b128 v[176:179], v220 offset:0
    ds_read_b128 v[180:183], v220 offset:512
    s_add_u32 s93, s93, 2080
    s_cmp_eq_u32 s93, 74880
    s_cselect_b32 s93, 0, s93
    s_waitcnt lgkmcnt(4)
    s_add_u32 m0, s68, 6080
    v_mfma_f32_32x32x16_bf16 v[128:143], v[160:163], v[164:167], v[128:143]
    buffer_load_dwordx4 v216, s[32:35], s69 offen offset:64 lds
    v_mfma_f32_32x32x16_bf16 v[144:159], v[160:163], v[168:171], v[144:159]
    v_add_u32 v220, s93, v223
    s_waitcnt vmcnt(12)
    ds_read_b64_tr_b16 v[184:185], v218 offset:8192
    ds_read_b64_tr_b16 v[186:187], v218 offset:8448
    ds_read_b128 v[188:191], v220 offset:0
    ds_read_b128 v[192:195], v220 offset:512
    s_add_u32 s93, s93, 2080
    s_cmp_eq_u32 s93, 74880
    s_cselect_b32 s93, 0, s93
    s_waitcnt lgkmcnt(4)
    s_add_u32 m0, s68, 7040
    v_mfma_f32_32x32x16_bf16 v[128:143], v[172:175], v[176:179], v[128:143]
    buffer_load_dwordx4 v216, s[32:35], s69 offen offset:128 lds
    v_mfma_f32_32x32x16_bf16 v[144:159], v[172:175], v[180:183], v[144:159]
    v_add_u32 v220, s93, v223
    s_waitcnt vmcnt(12)
    ds_read_b64_tr_b16 v[160:161], v218 offset:9216
    ds_read_b64_tr_b16 v[162:163], v218 offset:9472
    ds_read_b128 v[164:167], v220 offset:0
    ds_read_b128 v[168:171], v220 offset:512
    s_add_u32 s93, s93, 2080
    s_cmp_eq_u32 s93, 74880
    s_cselect_b32 s93, 0, s93
    s_waitcnt lgkmcnt(4)
    s_add_u32 m0, s68, 8000
    v_mfma_f32_32x32x16_bf16 v[128:143], v[184:187], v[188:191], v[128:143]
    buffer_load_dwordx4 v216, s[32:35], s69 offen offset:192 lds
    s_add_u32 s69, s69, 147456
    s_cmp_eq_u32 s69, 5308416
    s_cselect_b32 s69, 0, s69
    v_mfma_f32_32x32x16_bf16 v[144:159], v[184:187], v[192:195], v[144:159]
    v_add_u32 v220, s93, v223
    s_waitcnt vmcnt(12)
    ds_read_b64_tr_b16 v[172:173], v218 offset:10240
    ds_read_b64_tr_b16 v[174:175], v218 offset:10496
    ds_read_b128 v[176:179], v220 offset:0
    ds_read_b128 v[180:183], v220 offset:512
    s_add_u32 s93, s93, 2080
    s_cmp_eq_u32 s93, 74880
    s_cselect_b32 s93, 0, s93
    s_waitcnt lgkmcnt(4)
    v_mfma_f32_32x32x16_bf16 v[128:143], v[160:163], v[164:167], v[128:143]
    v_mfma_f32_32x32x16_bf16 v[144:159], v[160:163], v[168:171], v[144:159]
    v_add_u32 v220, s93, v223
    s_waitcnt vmcnt(11)
    ds_read_b64_tr_b16 v[184:185], v218 offset:11264
    ds_read_b64_tr_b16 v[186:187], v218 offset:11520
    ds_read_b128 v[188:191], v220 offset:0
    ds_read_b128 v[192:195], v220 offset:512
    s_add_u32 s93, s93, 2080
    s_cmp_eq_u32 s93, 74880
    s_cselect_b32 s93, 0, s93
    s_waitcnt lgkmcnt(4)
    s_add_u32 m0, s68, 10240
    v_mfma_f32_32x32x16_bf16 v[128:143], v[172:175], v[176:179], v[128:143]
    buffer_load_dwordx4 v216, s[32:35], s69 offen offset:0 lds
    v_mfma_f32_32x32x16_bf16 v[144:159], v[172:175], v[180:183], v[144:159]
    v_add_u32 v220, s93, v223
    s_waitcnt vmcnt(11)
    ds_read_b64_tr_b16 v[160:161], v218 offset:12288
    ds_read_b64_tr_b16 v[162:163], v218 offset:12544
    ds_read_b128 v[164:167], v220 offset:0
    ds_read_b128 v[168:171], v220 offset:512
    s_add_u32 s93, s93, 2080
    s_cmp_eq_u32 s93, 74880
    s_cselect_b32 s93, 0, s93
    s_waitcnt lgkmcnt(4)
    s_add_u32 m0, s68, 11200
    v_mfma_f32_32x32x16_bf16 v[128:143], v[184:187], v[188:191], v[128:143]
    buffer_load_dwordx4 v216, s[32:35], s69 offen offset:64 lds
    v_mfma_f32_32x32x16_bf16 v[144:159], v[184:187], v[192:195], v[144:159]
    v_add_u32 v220, s93, v223
    s_waitcnt vmcnt(11)
    ds_read_b64_tr_b16 v[172:173], v218 offset:13312
    ds_read_b64_tr_b16 v[174:175], v218 offset:13568
    ds_read_b128 v[176:179], v220 offset:0
    ds_read_b128 v[180:183], v220 offset:512
    s_add_u32 s93, s93, 2080
    s_cmp_eq_u32 s93, 74880
    s_cselect_b32 s93, 0, s93
    s_waitcnt lgkmcnt(4)
    s_add_u32 m0, s68, 12160
    v_mfma_f32_32x32x16_bf16 v[128:143], v[160:163], v[164:167], v[128:143]
    buffer_load_dwordx4 v216, s[32:35], s69 offen offset:128 lds
    v_mfma_f32_32x32x16_bf16 v[144:159], v[160:163], v[168:171], v[144:159]
    v_add_u32 v220, s93, v223
    s_waitcnt vmcnt(11)
    ds_read_b64_tr_b16 v[184:185], v218 offset:14336
    ds_read_b64_tr_b16 v[186:187], v218 offset:14592
    ds_read_b128 v[188:191], v220 offset:0
    ds_read_b128 v[192:195], v220 offset:512
    s_add_u32 s93, s93, 2080
    s_cmp_eq_u32 s93, 74880
    s_cselect_b32 s93, 0, s93
    s_waitcnt lgkmcnt(4)
    s_add_u32 m0, s68, 13120
    v_mfma_f32_32x32x16_bf16 v[128:143], v[172:175], v[176:179], v[128:143]
    buffer_load_dwordx4 v216, s[32:35], s69 offen offset:192 lds
    s_add_u32 s69, s69, 147456
    s_cmp_eq_u32 s69, 5308416
    s_cselect_b32 s69, 0, s69
    v_mfma_f32_32x32x16_bf16 v[144:159], v[172:175], v[180:183], v[144:159]
    s_waitcnt lgkmcnt(0)
    v_mfma_f32_32x32x16_bf16 v[128:143], v[184:187], v[188:191], v[128:143]
    v_mfma_f32_32x32x16_bf16 v[144:159], v[184:187], v[192:195], v[144:159]
    s_lshl_b32 s79, s66, 5
    s_sub_u32 s79, s79, 64
    v_lshrrev_b32 v170, 5, v250
    v_lshl_add_u32 v170, v170, 2, s79
    v_and_b32 v171, 31, v250
    v_lshlrev_b32 v171, 4, v171
    v_add_u32 v171, 136320, v171
    v_add_u32 v172, 0, v170
    v_mul_u32_u24 v173, 3641, v172
    v_lshrrev_b32 v173, 16, v173
    v_mul_u32_u24 v196, 18, v173
    v_sub_u32 v172, v172, v196
    v_mul_u32_u24 v196, 3072, v173
    v_lshrrev_b32 v173, 3, v172
    v_lshl_add_u32 v196, v173, 9, v196
    v_and_b32 v172, 7, v172
    v_lshl_add_u32 v196, v172, 1, v196
    v_add_u32 v196, v171, v196
    v_add_u32 v172, 2, v170
    v_mul_u32_u24 v173, 3641, v172
    v_lshrrev_b32 v173, 16, v173
    v_mul_u32_u24 v197, 18, v173
    v_sub_u32 v172, v172, v197
    v_mul_u32_u24 v197, 3072, v173
    v_lshrrev_b32 v173, 3, v172
    v_lshl_add_u32 v197, v173, 9, v197
    v_and_b32 v172, 7, v172
    v_lshl_add_u32 v197, v172, 1, v197
    v_add_u32 v197, v171, v197
    v_add_u32 v172, 8, v170
    v_mul_u32_u24 v173, 3641, v172
    v_lshrrev_b32 v173, 16, v173
    v_mul_u32_u24 v198, 18, v173
    v_sub_u32 v172, v172, v198
    v_mul_u32_u24 v198, 3072, v173
    v_lshrrev_b32 v173, 3, v172
    v_lshl_add_u32 v198, v173, 9, v198
    v_and_b32 v172, 7, v172
    v_lshl_add_u32 v198, v172, 1, v198
    v_add_u32 v198, v171, v198
    v_add_u32 v172, 10, v170
    v_mul_u32_u24 v173, 3641, v172
    v_lshrrev_b32 v173, 16, v173
    v_mul_u32_u24 v199, 18, v173
    v_sub_u32 v172, v172, v199
    v_mul_u32_u24 v199, 3072, v173
    v_lshrrev_b32 v173, 3, v172
    v_lshl_add_u32 v199, v173, 9, v199
    v_and_b32 v172, 7, v172
    v_lshl_add_u32 v199, v172, 1, v199
    v_add_u32 v199, v171, v199
    v_add_u32 v172, 16, v170
    v_mul_u32_u24 v173, 3641, v172
    v_lshrrev_b32 v173, 16, v173
    v_mul_u32_u24 v200, 18, v173
    v_sub_u32 v172, v172, v200
    v_mul_u32_u24 v200, 3072, v173
    v_lshrrev_b32 v173, 3, v172
    v_lshl_add_u32 v200, v173, 9, v200
    v_and_b32 v172, 7, v172
    v_lshl_add_u32 v200, v172, 1, v200
    v_add_u32 v200, v171, v200
    v_add_u32 v172, 18, v170
    v_mul_u32_u24 v173, 3641, v172
    v_lshrrev_b32 v173, 16, v173
    v_mul_u32_u24 v201, 18, v173
    v_sub_u32 v172, v172, v201
    v_mul_u32_u24 v201, 3072, v173
    v_lshrrev_b32 v173, 3, v172
    v_lshl_add_u32 v201, v173, 9, v201
    v_and_b32 v172, 7, v172
    v_lshl_add_u32 v201, v172, 1, v201
    v_add_u32 v201, v171, v201
    v_add_u32 v172, 24, v170
    v_mul_u32_u24 v173, 3641, v172
    v_lshrrev_b32 v173, 16, v173
    v_mul_u32_u24 v202, 18, v173
    v_sub_u32 v172, v172, v202
    v_mul_u32_u24 v202, 3072, v173
    v_lshrrev_b32 v173, 3, v172
    v_lshl_add_u32 v202, v173, 9, v202
    v_and_b32 v172, 7, v172
    v_lshl_add_u32 v202, v172, 1, v202
    v_add_u32 v202, v171, v202
    v_add_u32 v172, 26, v170
    v_mul_u32_u24 v173, 3641, v172
    v_lshrrev_b32 v173, 16, v173
    v_mul_u32_u24 v203, 18, v173
    v_sub_u32 v172, v172, v203
    v_mul_u32_u24 v203, 3072, v173
    v_lshrrev_b32 v173, 3, v172
    v_lshl_add_u32 v203, v173, 9, v203
    v_and_b32 v172, 7, v172
    v_lshl_add_u32 v203, v172, 1, v203
    v_add_u32 v203, v171, v203
    s_mov_b32 s80, 0x3e274c22
    v_mov_b32 v252, 163584
    s_mov_b32 s72, 0
LW_9:
    ds_read_b32 v253, v252 offset:0
    s_waitcnt lgkmcnt(0)
    v_readfirstlane_b32 s77, v253
    s_add_u32 s72, s72, 1
    s_cmp_ge_u32 s77, 4
    s_cbranch_scc1 LWD_10
    s_sleep 1
    s_cmp_lt_u32 s72, 524288
    s_cbranch_scc1 LW_9
LWD_10:
    s_nop 4
    v_mov_b32 v174, s80
    v_pk_mul_f32 v[128:129], v[128:129], v[174:175] op_sel_hi:[1,0]
    v_pk_mul_f32 v[130:131], v[130:131], v[174:175] op_sel_hi:[1,0]
    v_pk_mul_f32 v[132:133], v[132:133], v[174:175] op_sel_hi:[1,0]
    v_pk_mul_f32 v[134:135], v[134:135], v[174:175] op_sel_hi:[1,0]
    v_pk_mul_f32 v[136:137], v[136:137], v[174:175] op_sel_hi:[1,0]
    v_pk_mul_f32 v[138:139], v[138:139], v[174:175] op_sel_hi:[1,0]
    v_pk_mul_f32 v[140:141], v[140:141], v[174:175] op_sel_hi:[1,0]
    v_pk_mul_f32 v[142:143], v[142:143], v[174:175] op_sel_hi:[1,0]
    v_pk_mul_f32 v[144:145], v[144:145], v[174:175] op_sel_hi:[1,0]
    v_pk_mul_f32 v[146:147], v[146:147], v[174:175] op_sel_hi:[1,0]
    v_pk_mul_f32 v[148:149], v[148:149], v[174:175] op_sel_hi:[1,0]
    v_pk_mul_f32 v[150:151], v[150:151], v[174:175] op_sel_hi:[1,0]
    v_pk_mul_f32 v[152:153], v[152:153], v[174:175] op_sel_hi:[1,0]
    v_pk_mul_f32 v[154:155], v[154:155], v[174:175] op_sel_hi:[1,0]
    v_pk_mul_f32 v[156:157], v[156:157], v[174:175] op_sel_hi:[1,0]
    v_pk_mul_f32 v[158:159], v[158:159], v[174:175] op_sel_hi:[1,0]
    v_cvt_pk_bf16_f32 v128, v128, v129
    v_cvt_pk_bf16_f32 v129, v130, v131
    v_cvt_pk_bf16_f32 v130, v132, v133
    v_cvt_pk_bf16_f32 v131, v134, v135
    v_cvt_pk_bf16_f32 v132, v136, v137
    v_cvt_pk_bf16_f32 v133, v138, v139
    v_cvt_pk_bf16_f32 v134, v140, v141
    v_cvt_pk_bf16_f32 v135, v142, v143
    v_cvt_pk_bf16_f32 v136, v144, v145
    v_cvt_pk_bf16_f32 v137, v146, v147
    v_cvt_pk_bf16_f32 v138, v148, v149
    v_cvt_pk_bf16_f32 v139, v150, v151
    v_cvt_pk_bf16_f32 v140, v152, v153
    v_cvt_pk_bf16_f32 v141, v154, v155
    v_cvt_pk_bf16_f32 v142, v156, v157
    v_cvt_pk_bf16_f32 v143, v158, v159
    ds_write_b32 v196, v128 offset:0
    ds_write_b32 v197, v129 offset:0
    ds_write_b32 v198, v130 offset:0
    ds_write_b32 v199, v131 offset:0
    ds_write_b32 v200, v132 offset:0
    ds_write_b32 v201, v133 offset:0
    ds_write_b32 v202, v134 offset:0
    ds_write_b32 v203, v135 offset:0
    ds_write_b32 v196, v136 offset:1536
    ds_write_b32 v197, v137 offset:1536
    ds_write_b32 v198, v138 offset:1536
    ds_write_b32 v199, v139 offset:1536
    ds_write_b32 v200, v140 offset:1536
    ds_write_b32 v201, v141 offset:1536
    ds_write_b32 v202, v142 offset:1536
    ds_write_b32 v203, v143 offset:1536
    s_waitcnt lgkmcnt(0)
    v_mov_b32 v252, 163584
    v_mov_b32 v253, 1
    s_mov_b64 exec, 1
    ds_add_u32 v252, v253 offset:8
    s_mov_b64 exec, -1
    s_mul_i32 s93, s92, 2080
    v_add_u32 v220, s93, v223
    s_add_u32 s93, s93, 2080
    s_cmp_eq_u32 s93, 74880
    s_cselect_b32 s93, 0, s93
    s_waitcnt vmcnt(8)
    ds_read_b128 v[200:203], v220 offset:0
    ds_read_b64_tr_b16 v[160:161], v218 offset:0
    ds_read_b64_tr_b16 v[162:163], v218 offset:256
    ds_read_b128 v[204:207], v220 offset:512
    ds_read_b64_tr_b16 v[164:165], v218 offset:1024
    ds_read_b64_tr_b16 v[166:167], v218 offset:1280
    ds_read_b64_tr_b16 v[168:169], v218 offset:2048
    ds_read_b64_tr_b16 v[170:171], v218 offset:2304
    ds_read_b64_tr_b16 v[172:173], v218 offset:3072
    ds_read_b64_tr_b16 v[174:175], v218 offset:3328
    s_waitcnt lgkmcnt(7)
    s_add_u32 m0, s68, 0
    v_mfma_f32_32x32x16_bf16 v[0:15], v[160:163], v[200:203], 0
    buffer_load_dwordx4 v216, s[32:35], s69 offen offset:0 lds
    s_waitcnt lgkmcnt(6)
    v_mfma_f32_32x32x16_bf16 v[16:31], v[160:163], v[204:207], 0
    v_add_u32 v220, s93, v223
    s_waitcnt vmcnt(8)
    ds_read_b128 v[208:211], v220 offset:0
    ds_read_b64_tr_b16 v[180:181], v218 offset:5120
    ds_read_b64_tr_b16 v[182:183], v218 offset:5376
    s_waitcnt lgkmcnt(7)
    s_add_u32 m0, s68, 960
    v_mfma_f32_32x32x16_bf16 v[32:47], v[164:167], v[200:203], 0
    buffer_load_dwordx4 v216, s[32:35], s69 offen offset:64 lds
    v_mfma_f32_32x32x16_bf16 v[48:63], v[164:167], v[204:207], 0
    s_waitcnt vmcnt(8)
    ds_read_b128 v[212:215], v220 offset:512
    ds_read_b64_tr_b16 v[184:185], v218 offset:6144
    ds_read_b64_tr_b16 v[186:187], v218 offset:6400
    s_waitcnt lgkmcnt(8)
    s_add_u32 m0, s68, 1920
    v_mfma_f32_32x32x16_bf16 v[64:79], v[168:171], v[200:203], 0
    buffer_load_dwordx4 v216, s[32:35], s69 offen offset:128 lds
    v_mfma_f32_32x32x16_bf16 v[80:95], v[168:171], v[204:207], 0
    s_waitcnt vmcnt(8)
    ds_read_b64_tr_b16 v[188:189], v218 offset:7168
    ds_read_b64_tr_b16 v[190:191], v218 offset:7424
    s_add_u32 s93, s93, 2080
    s_cmp_eq_u32 s93, 74880
    s_cselect_b32 s93, 0, s93
    s_waitcnt lgkmcnt(8)
    s_add_u32 m0, s68, 2880
    v_mfma_f32_32x32x16_bf16 v[96:111], v[172:175], v[200:203], 0
    buffer_load_dwordx4 v216, s[32:35], s69 offen offset:192 lds
    v_mfma_f32_32x32x16_bf16 v[112:127], v[172:175], v[204:207], 0
    s_waitcnt vmcnt(8)
    ds_read_b64_tr_b16 v[192:193], v218 offset:8192
    ds_read_b64_tr_b16 v[194:195], v218 offset:8448
    s_add_u32 s69, s69, 147456
    s_cmp_eq_u32 s69, 5308416
    s_cselect_b32 s69, 0, s69
    s_mov_b32 s70, 0
    s_branch L_G1T4_1
.p2align 3
L_G1T4_3:
    s_waitcnt lgkmcnt(7)
    s_add_u32 m0, s68, 0
    v_mfma_f32_32x32x16_bf16 v[0:15], v[180:183], v[208:211], v[0:15]
    buffer_load_dwordx4 v216, s[32:35], s69 offen offset:0 lds
    s_waitcnt lgkmcnt(6)
    v_mfma_f32_32x32x16_bf16 v[16:31], v[180:183], v[212:215], v[16:31]
    v_add_u32 v220, s93, v223
    s_waitcnt vmcnt(8)
    ds_read_b128 v[200:203], v220 offset:0
    ds_read_b64_tr_b16 v[160:161], v218 offset:5120
    ds_read_b64_tr_b16 v[162:163], v218 offset:5376
    s_waitcnt lgkmcnt(7)
    s_add_u32 m0, s68, 960
    v_mfma_f32_32x32x16_bf16 v[32:47], v[184:187], v[208:211], v[32:47]
    buffer_load_dwordx4 v216, s[32:35], s69 offen offset:64 lds
    v_mfma_f32_32x32x16_bf16 v[48:63], v[184:187], v[212:215], v[48:63]
    s_waitcnt vmcnt(8)
    ds_read_b128 v[204:207], v220 offset:512
    ds_read_b64_tr_b16 v[164:165], v218 offset:6144
    ds_read_b64_tr_b16 v[166:167], v218 offset:6400
    s_waitcnt lgkmcnt(8)
    s_add_u32 m0, s68, 1920
    v_mfma_f32_32x32x16_bf16 v[64:79], v[188:191], v[208:211], v[64:79]
    buffer_load_dwordx4 v216, s[32:35], s69 offen offset:128 lds
    v_mfma_f32_32x32x16_bf16 v[80:95], v[188:191], v[212:215], v[80:95]
    s_waitcnt vmcnt(8)
    ds_read_b64_tr_b16 v[168:169], v218 offset:7168
    ds_read_b64_tr_b16 v[170:171], v218 offset:7424
    s_add_u32 s93, s93, 2080
    s_cmp_eq_u32 s93, 74880
    s_cselect_b32 s93, 0, s93
    s_waitcnt lgkmcnt(8)
    s_add_u32 m0, s68, 2880
    v_mfma_f32_32x32x16_bf16 v[96:111], v[192:195], v[208:211], v[96:111]
    buffer_load_dwordx4 v216, s[32:35], s69 offen offset:192 lds
    v_mfma_f32_32x32x16_bf16 v[112:127], v[192:195], v[212:215], v[112:127]
    s_waitcnt vmcnt(8)
    ds_read_b64_tr_b16 v[172:173], v218 offset:8192
    ds_read_b64_tr_b16 v[174:175], v218 offset:8448
    s_add_u32 s69, s69, 147456
    s_cmp_eq_u32 s69, 5308416
    s_cselect_b32 s69, 0, s69
    s_waitcnt lgkmcnt(7)
    s_add_u32 m0, s68, 5120
    v_mfma_f32_32x32x16_bf16 v[0:15], v[160:163], v[200:203], v[0:15]
    buffer_load_dwordx4 v216, s[32:35], s69 offen offset:0 lds
    s_waitcnt lgkmcnt(6)
    v_mfma_f32_32x32x16_bf16 v[16:31], v[160:163], v[204:207], v[16:31]
    v_add_u32 v220, s93, v223
    s_waitcnt vmcnt(8)
    ds_read_b128 v[208:211], v220 offset:0
    ds_read_b64_tr_b16 v[180:181], v218 offset:10240
    ds_read_b64_tr_b16 v[182:183], v218 offset:10496
    s_waitcnt lgkmcnt(7)
    s_add_u32 m0, s68, 6080
    v_mfma_f32_32x32x16_bf16 v[32:47], v[164:167], v[200:203], v[32:47]
    buffer_load_dwordx4 v216, s[32:35], s69 offen offset:64 lds
    v_mfma_f32_32x32x16_bf16 v[48:63], v[164:167], v[204:207], v[48:63]
    s_waitcnt vmcnt(8)
    ds_read_b128 v[212:215], v220 offset:512
    ds_read_b64_tr_b16 v[184:185], v218 offset:11264
    ds_read_b64_tr_b16 v[186:187], v218 offset:11520
    s_waitcnt lgkmcnt(8)
    s_add_u32 m0, s68, 7040
    v_mfma_f32_32x32x16_bf16 v[64:79], v[168:171], v[200:203], v[64:79]
    buffer_load_dwordx4 v216, s[32:35], s69 offen offset:128 lds
    v_mfma_f32_32x32x16_bf16 v[80:95], v[168:171], v[204:207], v[80:95]
    s_waitcnt vmcnt(8)
    ds_read_b64_tr_b16 v[188:189], v218 offset:12288
    ds_read_b64_tr_b16 v[190:191], v218 offset:12544
    s_add_u32 s93, s93, 2080
    s_cmp_eq_u32 s93, 74880
    s_cselect_b32 s93, 0, s93
    s_waitcnt lgkmcnt(8)
    s_add_u32 m0, s68, 8000
    v_mfma_f32_32x32x16_bf16 v[96:111], v[172:175], v[200:203], v[96:111]
    buffer_load_dwordx4 v216, s[32:35], s69 offen offset:192 lds
    v_mfma_f32_32x32x16_bf16 v[112:127], v[172:175], v[204:207], v[112:127]
    s_waitcnt vmcnt(8)
    ds_read_b64_tr_b16 v[192:193], v218 offset:13312
    ds_read_b64_tr_b16 v[194:195], v218 offset:13568
    s_add_u32 s69, s69, 147456
    s_cmp_eq_u32 s69, 5308416
    s_cselect_b32 s69, 0, s69
    s_waitcnt lgkmcnt(7)
    s_add_u32 m0, s68, 10240
    v_mfma_f32_32x32x16_bf16 v[0:15], v[180:183], v[208:211], v[0:15]
    buffer_load_dwordx4 v216, s[32:35], s69 offen offset:0 lds
    s_waitcnt lgkmcnt(6)
    v_mfma_f32_32x32x16_bf16 v[16:31], v[180:183], v[212:215], v[16:31]
    v_add_u32 v220, s93, v223
    s_waitcnt vmcnt(8)
    ds_read_b128 v[200:203], v220 offset:0
    ds_read_b64_tr_b16 v[160:161], v218 offset:0
    ds_read_b64_tr_b16 v[162:163], v218 offset:256
    s_waitcnt lgkmcnt(7)
    s_add_u32 m0, s68, 11200
    v_mfma_f32_32x32x16_bf16 v[32:47], v[184:187], v[208:211], v[32:47]
    buffer_load_dwordx4 v216, s[32:35], s69 offen offset:64 lds
    v_mfma_f32_32x32x16_bf16 v[48:63], v[184:187], v[212:215], v[48:63]
    s_waitcnt vmcnt(8)
    ds_read_b128 v[204:207], v220 offset:512
    ds_read_b64_tr_b16 v[164:165], v218 offset:1024
    ds_read_b64_tr_b16 v[166:167], v218 offset:1280
    s_waitcnt lgkmcnt(8)
    s_add_u32 m0, s68, 12160
    v_mfma_f32_32x32x16_bf16 v[64:79], v[188:191], v[208:211], v[64:79]
    buffer_load_dwordx4 v216, s[32:35], s69 offen offset:128 lds
    v_mfma_f32_32x32x16_bf16 v[80:95], v[188:191], v[212:215], v[80:95]
    s_waitcnt vmcnt(8)
    ds_read_b64_tr_b16 v[168:169], v218 offset:2048
    ds_read_b64_tr_b16 v[170:171], v218 offset:2304
    s_add_u32 s93, s93, 2080
    s_cmp_eq_u32 s93, 74880
    s_cselect_b32 s93, 0, s93
    s_waitcnt lgkmcnt(8)
    s_add_u32 m0, s68, 13120
    v_mfma_f32_32x32x16_bf16 v[96:111], v[192:195], v[208:211], v[96:111]
    buffer_load_dwordx4 v216, s[32:35], s69 offen offset:192 lds
    v_mfma_f32_32x32x16_bf16 v[112:127], v[192:195], v[212:215], v[112:127]
    s_waitcnt vmcnt(8)
    ds_read_b64_tr_b16 v[172:173], v218 offset:3072
    ds_read_b64_tr_b16 v[174:175], v218 offset:3328
    s_add_u32 s69, s69, 147456
    s_cmp_eq_u32 s69, 5308416
    s_cselect_b32 s69, 0, s69
    s_waitcnt lgkmcnt(7)
    s_add_u32 m0, s68, 0
    v_mfma_f32_32x32x16_bf16 v[0:15], v[160:163], v[200:203], v[0:15]
    buffer_load_dwordx4 v216, s[32:35], s69 offen offset:0 lds
    s_waitcnt lgkmcnt(6)
    v_mfma_f32_32x32x16_bf16 v[16:31], v[160:163], v[204:207], v[16:31]
    v_add_u32 v220, s93, v223
    s_waitcnt vmcnt(8)
    ds_read_b128 v[208:211], v220 offset:0
    ds_read_b64_tr_b16 v[180:181], v218 offset:5120
    ds_read_b64_tr_b16 v[182:183], v218 offset:5376
    s_waitcnt lgkmcnt(7)
    s_add_u32 m0, s68, 960
    v_mfma_f32_32x32x16_bf16 v[32:47], v[164:167], v[200:203], v[32:47]
    buffer_load_dwordx4 v216, s[32:35], s69 offen offset:64 lds
    v_mfma_f32_32x32x16_bf16 v[48:63], v[164:167], v[204:207], v[48:63]
    s_waitcnt vmcnt(8)
    ds_read_b128 v[212:215], v220 offset:512
    ds_read_b64_tr_b16 v[184:185], v218 offset:6144
    ds_read_b64_tr_b16 v[186:187], v218 offset:6400
    s_waitcnt lgkmcnt(8)
    s_add_u32 m0, s68, 1920
    v_mfma_f32_32x32x16_bf16 v[64:79], v[168:171], v[200:203], v[64:79]
    buffer_load_dwordx4 v216, s[32:35], s69 offen offset:128 lds
    v_mfma_f32_32x32x16_bf16 v[80:95], v[168:171], v[204:207], v[80:95]
    s_waitcnt vmcnt(8)
    ds_read_b64_tr_b16 v[188:189], v218 offset:7168
    ds_read_b64_tr_b16 v[190:191], v218 offset:7424
    s_add_u32 s93, s93, 2080
    s_cmp_eq_u32 s93, 74880
    s_cselect_b32 s93, 0, s93
    s_waitcnt lgkmcnt(8)
    s_add_u32 m0, s68, 2880
    v_mfma_f32_32x32x16_bf16 v[96:111], v[172:175], v[200:203], v[96:111]
    buffer_load_dwordx4 v216, s[32:35], s69 offen offset:192 lds
    v_mfma_f32_32x32x16_bf16 v[112:127], v[172:175], v[204:207], v[112:127]
    s_waitcnt vmcnt(8)
    ds_read_b64_tr_b16 v[192:193], v218 offset:8192
    ds_read_b64_tr_b16 v[194:195], v218 offset:8448
    s_add_u32 s69, s69, 147456
    s_cmp_eq_u32 s69, 5308416
    s_cselect_b32 s69, 0, s69
L_G1T4_1:
    s_waitcnt lgkmcnt(7)
    s_add_u32 m0, s68, 5120
    v_mfma_f32_32x32x16_bf16 v[0:15], v[180:183], v[208:211], v[0:15]
    buffer_load_dwordx4 v216, s[32:35], s69 offen offset:0 lds
    s_waitcnt lgkmcnt(6)
    v_mfma_f32_32x32x16_bf16 v[16:31], v[180:183], v[212:215], v[16:31]
    v_add_u32 v220, s93, v223
    s_waitcnt vmcnt(8)
    ds_read_b128 v[200:203], v220 offset:0
    ds_read_b64_tr_b16 v[160:161], v218 offset:10240
    ds_read_b64_tr_b16 v[162:163], v218 offset:10496
    s_waitcnt lgkmcnt(7)
    s_add_u32 m0, s68, 6080
    v_mfma_f32_32x32x16_bf16 v[32:47], v[184:187], v[208:211], v[32:47]
    buffer_load_dwordx4 v216, s[32:35], s69 offen offset:64 lds
    v_mfma_f32_32x32x16_bf16 v[48:63], v[184:187], v[212:215], v[48:63]
    s_waitcnt vmcnt(8)
    ds_read_b128 v[204:207], v220 offset:512
    ds_read_b64_tr_b16 v[164:165], v218 offset:11264
    ds_read_b64_tr_b16 v[166:167], v218 offset:11520
    s_waitcnt lgkmcnt(8)
    s_add_u32 m0, s68, 7040
    v_mfma_f32_32x32x16_bf16 v[64:79], v[188:191], v[208:211], v[64:79]
    buffer_load_dwordx4 v216, s[32:35], s69 offen offset:128 lds
    v_mfma_f32_32x32x16_bf16 v[80:95], v[188:191], v[212:215], v[80:95]
    s_waitcnt vmcnt(8)
    ds_read_b64_tr_b16 v[168:169], v218 offset:12288
    ds_read_b64_tr_b16 v[170:171], v218 offset:12544
    s_add_u32 s93, s93, 2080
    s_cmp_eq_u32 s93, 74880
    s_cselect_b32 s93, 0, s93
    s_waitcnt lgkmcnt(8)
    s_add_u32 m0, s68, 8000
    v_mfma_f32_32x32x16_bf16 v[96:111], v[192:195], v[208:211], v[96:111]
    buffer_load_dwordx4 v216, s[32:35], s69 offen offset:192 lds
    v_mfma_f32_32x32x16_bf16 v[112:127], v[192:195], v[212:215], v[112:127]
    s_waitcnt vmcnt(8)
    ds_read_b64_tr_b16 v[172:173], v218 offset:13312
    ds_read_b64_tr_b16 v[174:175], v218 offset:13568
    s_add_u32 s69, s69, 147456
    s_cmp_eq_u32 s69, 5308416
    s_cselect_b32 s69, 0, s69
    s_waitcnt lgkmcnt(7)
    s_add_u32 m0, s68, 10240
    v_mfma_f32_32x32x16_bf16 v[0:15], v[160:163], v[200:203], v[0:15]
    buffer_load_dwordx4 v216, s[32:35], s69 offen offset:0 lds
    s_waitcnt lgkmcnt(6)
    v_mfma_f32_32x32x16_bf16 v[16:31], v[160:163], v[204:207], v[16:31]
    v_add_u32 v220, s93, v223
    s_waitcnt vmcnt(8)
    ds_read_b128 v[208:211], v220 offset:0
    ds_read_b64_tr_b16 v[180:181], v218 offset:0
    ds_read_b64_tr_b16 v[182:183], v218 offset:256
    s_waitcnt lgkmcnt(7)
    s_add_u32 m0, s68, 11200
    v_mfma_f32_32x32x16_bf16 v[32:47], v[164:167], v[200:203], v[32:47]
    buffer_load_dwordx4 v216, s[32:35], s69 offen offset:64 lds
    v_mfma_f32_32x32x16_bf16 v[48:63], v[164:167], v[204:207], v[48:63]
    s_waitcnt vmcnt(8)
    ds_read_b128 v[212:215], v220 offset:512
    ds_read_b64_tr_b16 v[184:185], v218 offset:1024
    ds_read_b64_tr_b16 v[186:187], v218 offset:1280
    s_waitcnt lgkmcnt(8)
    s_add_u32 m0, s68, 12160
    v_mfma_f32_32x32x16_bf16 v[64:79], v[168:171], v[200:203], v[64:79]
    buffer_load_dwordx4 v216, s[32:35], s69 offen offset:128 lds
    v_mfma_f32_32x32x16_bf16 v[80:95], v[168:171], v[204:207], v[80:95]
    s_waitcnt vmcnt(8)
    ds_read_b64_tr_b16 v[188:189], v218 offset:2048
    ds_read_b64_tr_b16 v[190:191], v218 offset:2304
    s_add_u32 s93, s93, 2080
    s_cmp_eq_u32 s93, 74880
    s_cselect_b32 s93, 0, s93
    s_waitcnt lgkmcnt(8)
    s_add_u32 m0, s68, 13120
    v_mfma_f32_32x32x16_bf16 v[96:111], v[172:175], v[200:203], v[96:111]
    buffer_load_dwordx4 v216, s[32:35], s69 offen offset:192 lds
    v_mfma_f32_32x32x16_bf16 v[112:127], v[172:175], v[204:207], v[112:127]
    s_waitcnt vmcnt(8)
    ds_read_b64_tr_b16 v[192:193], v218 offset:3072
    ds_read_b64_tr_b16 v[194:195], v218 offset:3328
    s_add_u32 s69, s69, 147456
    s_cmp_eq_u32 s69, 5308416
    s_cselect_b32 s69, 0, s69
    s_add_u32 s70, s70, 1
    s_cmp_lt_u32 s70, 6
    s_cbranch_scc1 L_G1T4_3
    s_mul_i32 s69, s92, 18432
    s_waitcnt lgkmcnt(7)
    s_add_u32 m0, s68, 0
    v_mfma_f32_32x32x16_bf16 v[0:15], v[180:183], v[208:211], v[0:15]
    buffer_load_dwordx4 v217, s[36:39], s69 offen offset:0 lds
    s_waitcnt lgkmcnt(6)
    v_mfma_f32_32x32x16_bf16 v[16:31], v[180:183], v[212:215], v[16:31]
    v_add_u32 v220, s93, v223
    s_waitcnt vmcnt(8)
    ds_read_b128 v[200:203], v220 offset:0
    ds_read_b64_tr_b16 v[160:161], v218 offset:5120
    ds_read_b64_tr_b16 v[162:163], v218 offset:5376
    s_waitcnt lgkmcnt(7)
    s_add_u32 m0, s68, 960
    v_mfma_f32_32x32x16_bf16 v[32:47], v[184:187], v[208:211], v[32:47]
    buffer_load_dwordx4 v217, s[36:39], s69 offen offset:64 lds
    v_mfma_f32_32x32x16_bf16 v[48:63], v[184:187], v[212:215], v[48:63]
    s_waitcnt vmcnt(8)
    ds_read_b128 v[204:207], v220 offset:512
    ds_read_b64_tr_b16 v[164:165], v218 offset:6144
    ds_read_b64_tr_b16 v[166:167], v218 offset:6400
    s_waitcnt lgkmcnt(8)
    s_add_u32 m0, s68, 1920
    v_mfma_f32_32x32x16_bf16 v[64:79], v[188:191], v[208:211], v[64:79]
    buffer_load_dwordx4 v217, s[36:39], s69 offen offset:128 lds
    v_mfma_f32_32x32x16_bf16 v[80:95], v[188:191], v[212:215], v[80:95]
    s_waitcnt vmcnt(8)
    ds_read_b64_tr_b16 v[168:169], v218 offset:7168
    ds_read_b64_tr_b16 v[170:171], v218 offset:7424
    s_add_u32 s93, s93, 2080
    s_cmp_eq_u32 s93, 74880
    s_cselect_b32 s93, 0, s93
    s_waitcnt lgkmcnt(8)
    s_add_u32 m0, s68, 2880
    v_mfma_f32_32x32x16_bf16 v[96:111], v[192:195], v[208:211], v[96:111]
    buffer_load_dwordx4 v217, s[36:39], s69 offen offset:192 lds
    s_add_u32 m0, s68, 3840
    s_nop 0
    buffer_load_dwordx4 v217, s[36:39], s69 offen offset:256 lds
    v_mfma_f32_32x32x16_bf16 v[112:127], v[192:195], v[212:215], v[112:127]
    s_waitcnt vmcnt(9)
    ds_read_b64_tr_b16 v[172:173], v218 offset:8192
    ds_read_b64_tr_b16 v[174:175], v218 offset:8448
    s_add_u32 s69, s69, 18432
    s_cmp_eq_u32 s69, 663552
    s_cselect_b32 s69, 0, s69
    s_waitcnt lgkmcnt(7)
    s_add_u32 m0, s68, 5120
    v_mfma_f32_32x32x16_bf16 v[0:15], v[160:163], v[200:203], v[0:15]
    buffer_load_dwordx4 v217, s[36:39], s69 offen offset:0 lds
    s_waitcnt lgkmcnt(6)
    v_mfma_f32_32x32x16_bf16 v[16:31], v[160:163], v[204:207], v[16:31]
    v_add_u32 v220, s93, v223
    s_waitcnt vmcnt(9)
    ds_read_b128 v[208:211], v220 offset:0
    ds_read_b64_tr_b16 v[180:181], v218 offset:10240
    ds_read_b64_tr_b16 v[182:183], v218 offset:10496
    s_waitcnt lgkmcnt(7)
    s_add_u32 m0, s68, 6080
    v_mfma_f32_32x32x16_bf16 v[32:47], v[164:167], v[200:203], v[32:47]
    buffer_load_dwordx4 v217, s[36:39], s69 offen offset:64 lds
    v_mfma_f32_32x32x16_bf16 v[48:63], v[164:167], v[204:207], v[48:63]
    s_waitcnt vmcnt(9)
    ds_read_b128 v[212:215], v220 offset:512
    ds_read_b64_tr_b16 v[184:185], v218 offset:11264
    ds_read_b64_tr_b16 v[186:187], v218 offset:11520
    s_waitcnt lgkmcnt(8)
    s_add_u32 m0, s68, 7040
    v_mfma_f32_32x32x16_bf16 v[64:79], v[168:171], v[200:203], v[64:79]
    buffer_load_dwordx4 v217, s[36:39], s69 offen offset:128 lds
    v_mfma_f32_32x32x16_bf16 v[80:95], v[168:171], v[204:207], v[80:95]
    s_waitcnt vmcnt(9)
    ds_read_b64_tr_b16 v[188:189], v218 offset:12288
    ds_read_b64_tr_b16 v[190:191], v218 offset:12544
    s_waitcnt lgkmcnt(8)
    s_add_u32 m0, s68, 8000
    v_mfma_f32_32x32x16_bf16 v[96:111], v[172:175], v[200:203], v[96:111]
    buffer_load_dwordx4 v217, s[36:39], s69 offen offset:192 lds
    s_add_u32 m0, s68, 8960
    s_nop 0
    buffer_load_dwordx4 v217, s[36:39], s69 offen offset:256 lds
    v_mfma_f32_32x32x16_bf16 v[112:127], v[172:175], v[204:207], v[112:127]
    s_waitcnt vmcnt(10)
    ds_read_b64_tr_b16 v[192:193], v218 offset:13312
    ds_read_b64_tr_b16 v[194:195], v218 offset:13568
    s_add_u32 s69, s69, 18432
    s_cmp_eq_u32 s69, 663552
    s_cselect_b32 s69, 0, s69
    s_waitcnt lgkmcnt(7)
    s_add_u32 m0, s68, 10240
    v_mfma_f32_32x32x16_bf16 v[0:15], v[180:183], v[208:211], v[0:15]
    buffer_load_dwordx4 v217, s[36:39], s69 offen offset:0 lds
    s_waitcnt lgkmcnt(6)
    v_mfma_f32_32x32x16_bf16 v[16:31], v[180:183], v[212:215], v[16:31]
    s_waitcnt lgkmcnt(4)
    s_add_u32 m0, s68, 11200
    v_mfma_f32_32x32x16_bf16 v[32:47], v[184:187], v[208:211], v[32:47]
    buffer_load_dwordx4 v217, s[36:39], s69 offen offset:64 lds
    v_mfma_f32_32x32x16_bf16 v[48:63], v[184:187], v[212:215], v[48:63]
    s_waitcnt lgkmcnt(2)
    s_add_u32 m0, s68, 12160
    v_mfma_f32_32x32x16_bf16 v[64:79], v[188:191], v[208:211], v[64:79]
    buffer_load_dwordx4 v217, s[36:39], s69 offen offset:128 lds
    v_mfma_f32_32x32x16_bf16 v[80:95], v[188:191], v[212:215], v[80:95]
    s_waitcnt lgkmcnt(0)
    s_add_u32 m0, s68, 13120
    v_mfma_f32_32x32x16_bf16 v[96:111], v[192:195], v[208:211], v[96:111]
    buffer_load_dwordx4 v217, s[36:39], s69 offen offset:192 lds
    s_add_u32 m0, s68, 14080
    s_nop 0
    buffer_load_dwordx4 v217, s[36:39], s69 offen offset:256 lds
    v_mfma_f32_32x32x16_bf16 v[112:127], v[192:195], v[212:215], v[112:127]
    s_add_u32 s69, s69, 18432
    s_cmp_eq_u32 s69, 663552
    s_cselect_b32 s69, 0, s69
    v_mov_b32 v252, 163584
    v_mov_b32 v253, 1
    s_mov_b64 exec, 1
    ds_add_u32 v252, v253 offset:12
    s_mov_b64 exec, -1
    s_lshl_b32 s77, s66, 6
    v_add_u32 v176, s77, v250
    v_lshrrev_b32 v177, 2, v176
    v_and_b32 v178, 3, v176
    v_mul_u32_u24 v177, 1152, v177
    v_cmp_gt_u32 vcc, 144, v176
    v_mul_u32_u24 v178, 52, v178
    v_add_u32 v177, v177, v178
    v_mov_b32 v178, 1073741824
    v_cndmask_b32 v177, v178, v177, vcc
    s_and_b32 s78, s64, 15
    s_mul_i32 s78, s78, 41472
    s_mul_i32 s77, s65, 144
    s_add_u32 s78, s78, s77
    buffer_load_dword v230, v177, s[48:51], s78 offen
    s_nop 1
    v_exp_f32 v160, v0
    v_exp_f32 v161, v1
    v_exp_f32 v162, v2
    v_exp_f32 v163, v3
    v_exp_f32 v164, v4
    v_exp_f32 v165, v5
    v_exp_f32 v166, v6
    v_exp_f32 v167, v7
    v_pk_add_f32 v[160:161], v[160:161], 1.0 op_sel_hi:[1,0]
    v_pk_add_f32 v[162:163], v[162:163], 1.0 op_sel_hi:[1,0]
    v_pk_add_f32 v[164:165], v[164:165], 1.0 op_sel_hi:[1,0]
    v_pk_add_f32 v[166:167], v[166:167], 1.0 op_sel_hi:[1,0]
    v_rcp_f32 v160, v160
    v_rcp_f32 v161, v161
    v_rcp_f32 v162, v162
    v_rcp_f32 v163, v163
    v_rcp_f32 v164, v164
    v_rcp_f32 v165, v165
    v_rcp_f32 v166, v166
    v_rcp_f32 v167, v167
    v_pk_mul_f32 v[160:161], v[0:1], v[160:161]
    v_pk_mul_f32 v[162:163], v[2:3], v[162:163]
    v_pk_mul_f32 v[164:165], v[4:5], v[164:165]
    v_pk_mul_f32 v[166:167], v[6:7], v[166:167]
    v_cvt_pk_bf16_f32 v0, v160, v161
    v_cvt_pk_bf16_f32 v1, v162, v163
    v_cvt_pk_bf16_f32 v2, v164, v165
    v_cvt_pk_bf16_f32 v3, v166, v167
    v_exp_f32 v168, v8
    v_exp_f32 v169, v9
    v_exp_f32 v170, v10
    v_exp_f32 v171, v11
    v_exp_f32 v172, v12
    v_exp_f32 v173, v13
    v_exp_f32 v174, v14
    v_exp_f32 v175, v15
    v_pk_add_f32 v[168:169], v[168:169], 1.0 op_sel_hi:[1,0]
    v_pk_add_f32 v[170:171], v[170:171], 1.0 op_sel_hi:[1,0]
    v_pk_add_f32 v[172:173], v[172:173], 1.0 op_sel_hi:[1,0]
    v_pk_add_f32 v[174:175], v[174:175], 1.0 op_sel_hi:[1,0]
    v_rcp_f32 v168, v168
    v_rcp_f32 v169, v169
    v_rcp_f32 v170, v170
    v_rcp_f32 v171, v171
    v_rcp_f32 v172, v172
    v_rcp_f32 v173, v173
    v_rcp_f32 v174, v174
    v_rcp_f32 v175, v175
    v_pk_mul_f32 v[168:169], v[8:9], v[168:169]
    v_pk_mul_f32 v[170:171], v[10:11], v[170:171]
    v_pk_mul_f32 v[172:173], v[12:13], v[172:173]
    v_pk_mul_f32 v[174:175], v[14:15], v[174:175]
    v_cvt_pk_bf16_f32 v8, v168, v169
    v_cvt_pk_bf16_f32 v9, v170, v171
    v_cvt_pk_bf16_f32 v10, v172, v173
    v_cvt_pk_bf16_f32 v11, v174, v175
    v_exp_f32 v160, v16
    v_exp_f32 v161, v17
    v_exp_f32 v162, v18
    v_exp_f32 v163, v19
    v_exp_f32 v164, v20
    v_exp_f32 v165, v21
    v_exp_f32 v166, v22
    v_exp_f32 v167, v23
    v_pk_add_f32 v[160:161], v[160:161], 1.0 op_sel_hi:[1,0]
    v_pk_add_f32 v[162:163], v[162:163], 1.0 op_sel_hi:[1,0]
    v_pk_add_f32 v[164:165], v[164:165], 1.0 op_sel_hi:[1,0]
    v_pk_add_f32 v[166:167], v[166:167], 1.0 op_sel_hi:[1,0]
    v_rcp_f32 v160, v160
    v_rcp_f32 v161, v161
    v_rcp_f32 v162, v162
    v_rcp_f32 v163, v163
    v_rcp_f32 v164, v164
    v_rcp_f32 v165, v165
    v_rcp_f32 v166, v166
    v_rcp_f32 v167, v167
    v_pk_mul_f32 v[160:161], v[16:17], v[160:161]
    v_pk_mul_f32 v[162:163], v[18:19], v[162:163]
    v_pk_mul_f32 v[164:165], v[20:21], v[164:165]
    v_pk_mul_f32 v[166:167], v[22:23], v[166:167]
    v_cvt_pk_bf16_f32 v16, v160, v161
    v_cvt_pk_bf16_f32 v17, v162, v163
    v_cvt_pk_bf16_f32 v18, v164, v165
    v_cvt_pk_bf16_f32 v19, v166, v167
    v_exp_f32 v168, v24
    v_exp_f32 v169, v25
    v_exp_f32 v170, v26
    v_exp_f32 v171, v27
    v_exp_f32 v172, v28
    v_exp_f32 v173, v29
    v_exp_f32 v174, v30
    v_exp_f32 v175, v31
    v_pk_add_f32 v[168:169], v[168:169], 1.0 op_sel_hi:[1,0]
    v_pk_add_f32 v[170:171], v[170:171], 1.0 op_sel_hi:[1,0]
    v_pk_add_f32 v[172:173], v[172:173], 1.0 op_sel_hi:[1,0]
    v_pk_add_f32 v[174:175], v[174:175], 1.0 op_sel_hi:[1,0]
    v_rcp_f32 v168, v168
    v_rcp_f32 v169, v169
    v_rcp_f32 v170, v170
    v_rcp_f32 v171, v171
    v_rcp_f32 v172, v172
    v_rcp_f32 v173, v173
    v_rcp_f32 v174, v174
    v_rcp_f32 v175, v175
    v_pk_mul_f32 v[168:169], v[24:25], v[168:169]
    v_pk_mul_f32 v[170:171], v[26:27], v[170:171]
    v_pk_mul_f32 v[172:173], v[28:29], v[172:173]
    v_pk_mul_f32 v[174:175], v[30:31], v[174:175]
    v_cvt_pk_bf16_f32 v24, v168, v169
    v_cvt_pk_bf16_f32 v25, v170, v171
    v_cvt_pk_bf16_f32 v26, v172, v173
    v_cvt_pk_bf16_f32 v27, v174, v175
    v_exp_f32 v160, v32
    v_exp_f32 v161, v33
    v_exp_f32 v162, v34
    v_exp_f32 v163, v35
    v_exp_f32 v164, v36
    v_exp_f32 v165, v37
    v_exp_f32 v166, v38
    v_exp_f32 v167, v39
    v_pk_add_f32 v[160:161], v[160:161], 1.0 op_sel_hi:[1,0]
    v_pk_add_f32 v[162:163], v[162:163], 1.0 op_sel_hi:[1,0]
    v_pk_add_f32 v[164:165], v[164:165], 1.0 op_sel_hi:[1,0]
    v_pk_add_f32 v[166:167], v[166:167], 1.0 op_sel_hi:[1,0]
    v_rcp_f32 v160, v160
    v_rcp_f32 v161, v161
    v_rcp_f32 v162, v162
    v_rcp_f32 v163, v163
    v_rcp_f32 v164, v164
    v_rcp_f32 v165, v165
    v_rcp_f32 v166, v166
    v_rcp_f32 v167, v167
    v_pk_mul_f32 v[160:161], v[32:33], v[160:161]
    v_pk_mul_f32 v[162:163], v[34:35], v[162:163]
    v_pk_mul_f32 v[164:165], v[36:37], v[164:165]
    v_pk_mul_f32 v[166:167], v[38:39], v[166:167]
    v_cvt_pk_bf16_f32 v32, v160, v161
    v_cvt_pk_bf16_f32 v33, v162, v163
    v_cvt_pk_bf16_f32 v34, v164, v165
    v_cvt_pk_bf16_f32 v35, v166, v167
    v_exp_f32 v168, v40
    v_exp_f32 v169, v41
    v_exp_f32 v170, v42
    v_exp_f32 v171, v43
    v_exp_f32 v172, v44
    v_exp_f32 v173, v45
    v_exp_f32 v174, v46
    v_exp_f32 v175, v47
    v_pk_add_f32 v[168:169], v[168:169], 1.0 op_sel_hi:[1,0]
    v_pk_add_f32 v[170:171], v[170:171], 1.0 op_sel_hi:[1,0]
    v_pk_add_f32 v[172:173], v[172:173], 1.0 op_sel_hi:[1,0]
    v_pk_add_f32 v[174:175], v[174:175], 1.0 op_sel_hi:[1,0]
    v_rcp_f32 v168, v168
    v_rcp_f32 v169, v169
    v_rcp_f32 v170, v170
    v_rcp_f32 v171, v171
    v_rcp_f32 v172, v172
    v_rcp_f32 v173, v173
    v_rcp_f32 v174, v174
    v_rcp_f32 v175, v175
    v_pk_mul_f32 v[168:169], v[40:41], v[168:169]
    v_pk_mul_f32 v[170:171], v[42:43], v[170:171]
    v_pk_mul_f32 v[172:173], v[44:45], v[172:173]
    v_pk_mul_f32 v[174:175], v[46:47], v[174:175]
    v_cvt_pk_bf16_f32 v40, v168, v169
    v_cvt_pk_bf16_f32 v41, v170, v171
    v_cvt_pk_bf16_f32 v42, v172, v173
    v_cvt_pk_bf16_f32 v43, v174, v175
    v_exp_f32 v160, v48
    v_exp_f32 v161, v49
    v_exp_f32 v162, v50
    v_exp_f32 v163, v51
    v_exp_f32 v164, v52
    v_exp_f32 v165, v53
    v_exp_f32 v166, v54
    v_exp_f32 v167, v55
    v_pk_add_f32 v[160:161], v[160:161], 1.0 op_sel_hi:[1,0]
    v_pk_add_f32 v[162:163], v[162:163], 1.0 op_sel_hi:[1,0]
    v_pk_add_f32 v[164:165], v[164:165], 1.0 op_sel_hi:[1,0]
    v_pk_add_f32 v[166:167], v[166:167], 1.0 op_sel_hi:[1,0]
    v_rcp_f32 v160, v160
    v_rcp_f32 v161, v161
    v_rcp_f32 v162, v162
    v_rcp_f32 v163, v163
    v_rcp_f32 v164, v164
    v_rcp_f32 v165, v165
    v_rcp_f32 v166, v166
    v_rcp_f32 v167, v167
    v_pk_mul_f32 v[160:161], v[48:49], v[160:161]
    v_pk_mul_f32 v[162:163], v[50:51], v[162:163]
    v_pk_mul_f32 v[164:165], v[52:53], v[164:165]
    v_pk_mul_f32 v[166:167], v[54:55], v[166:167]
    v_cvt_pk_bf16_f32 v48, v160, v161
    v_cvt_pk_bf16_f32 v49, v162, v163
    v_cvt_pk_bf16_f32 v50, v164, v165
    v_cvt_pk_bf16_f32 v51, v166, v167
    v_exp_f32 v168, v56
    v_exp_f32 v169, v57
    v_exp_f32 v170, v58
    v_exp_f32 v171, v59
    v_exp_f32 v172, v60
    v_exp_f32 v173, v61
    v_exp_f32 v174, v62
    v_exp_f32 v175, v63
    v_pk_add_f32 v[168:169], v[168:169], 1.0 op_sel_hi:[1,0]
    v_pk_add_f32 v[170:171], v[170:171], 1.0 op_sel_hi:[1,0]
    v_pk_add_f32 v[172:173], v[172:173], 1.0 op_sel_hi:[1,0]
    v_pk_add_f32 v[174:175], v[174:175], 1.0 op_sel_hi:[1,0]
    v_rcp_f32 v168, v168
    v_rcp_f32 v169, v169
    v_rcp_f32 v170, v170
    v_rcp_f32 v171, v171
    v_rcp_f32 v172, v172
    v_rcp_f32 v173, v173
    v_rcp_f32 v174, v174
    v_rcp_f32 v175, v175
    v_pk_mul_f32 v[168:169], v[56:57], v[168:169]
    v_pk_mul_f32 v[170:171], v[58:59], v[170:171]
    v_pk_mul_f32 v[172:173], v[60:61], v[172:173]
    v_pk_mul_f32 v[174:175], v[62:63], v[174:175]
    v_cvt_pk_bf16_f32 v56, v168, v169
    v_cvt_pk_bf16_f32 v57, v170, v171
    v_cvt_pk_bf16_f32 v58, v172, v173
    v_cvt_pk_bf16_f32 v59, v174, v175
    v_exp_f32 v160, v64
    v_exp_f32 v161, v65
    v_exp_f32 v162, v66
    v_exp_f32 v163, v67
    v_exp_f32 v164, v68
    v_exp_f32 v165, v69
    v_exp_f32 v166, v70
    v_exp_f32 v167, v71
    v_pk_add_f32 v[160:161], v[160:161], 1.0 op_sel_hi:[1,0]
    v_pk_add_f32 v[162:163], v[162:163], 1.0 op_sel_hi:[1,0]
    v_pk_add_f32 v[164:165], v[164:165], 1.0 op_sel_hi:[1,0]
    v_pk_add_f32 v[166:167], v[166:167], 1.0 op_sel_hi:[1,0]
    v_rcp_f32 v160, v160
    v_rcp_f32 v161, v161
    v_rcp_f32 v162, v162
    v_rcp_f32 v163, v163
    v_rcp_f32 v164, v164
    v_rcp_f32 v165, v165
    v_rcp_f32 v166, v166
    v_rcp_f32 v167, v167
    v_pk_mul_f32 v[160:161], v[64:65], v[160:161]
    v_pk_mul_f32 v[162:163], v[66:67], v[162:163]
    v_pk_mul_f32 v[164:165], v[68:69], v[164:165]
    v_pk_mul_f32 v[166:167], v[70:71], v[166:167]
    v_cvt_pk_bf16_f32 v64, v160, v161
    v_cvt_pk_bf16_f32 v65, v162, v163
    v_cvt_pk_bf16_f32 v66, v164, v165
    v_cvt_pk_bf16_f32 v67, v166, v167
    v_exp_f32 v168, v72
    v_exp_f32 v169, v73
    v_exp_f32 v170, v74
    v_exp_f32 v171, v75
    v_exp_f32 v172, v76
    v_exp_f32 v173, v77
    v_exp_f32 v174, v78
    v_exp_f32 v175, v79
    v_pk_add_f32 v[168:169], v[168:169], 1.0 op_sel_hi:[1,0]
    v_pk_add_f32 v[170:171], v[170:171], 1.0 op_sel_hi:[1,0]
    v_pk_add_f32 v[172:173], v[172:173], 1.0 op_sel_hi:[1,0]
    v_pk_add_f32 v[174:175], v[174:175], 1.0 op_sel_hi:[1,0]
    v_rcp_f32 v168, v168
    v_rcp_f32 v169, v169
    v_rcp_f32 v170, v170
    v_rcp_f32 v171, v171
    v_rcp_f32 v172, v172
    v_rcp_f32 v173, v173
    v_rcp_f32 v174, v174
    v_rcp_f32 v175, v175
    v_pk_mul_f32 v[168:169], v[72:73], v[168:169]
    v_pk_mul_f32 v[170:171], v[74:75], v[170:171]
    v_pk_mul_f32 v[172:173], v[76:77], v[172:173]
    v_pk_mul_f32 v[174:175], v[78:79], v[174:175]
    v_cvt_pk_bf16_f32 v72, v168, v169
    v_cvt_pk_bf16_f32 v73, v170, v171
    v_cvt_pk_bf16_f32 v74, v172, v173
    v_cvt_pk_bf16_f32 v75, v174, v175
    v_exp_f32 v160, v80
    v_exp_f32 v161, v81
    v_exp_f32 v162, v82
    v_exp_f32 v163, v83
    v_exp_f32 v164, v84
    v_exp_f32 v165, v85
    v_exp_f32 v166, v86
    v_exp_f32 v167, v87
    v_pk_add_f32 v[160:161], v[160:161], 1.0 op_sel_hi:[1,0]
    v_pk_add_f32 v[162:163], v[162:163], 1.0 op_sel_hi:[1,0]
    v_pk_add_f32 v[164:165], v[164:165], 1.0 op_sel_hi:[1,0]
    v_pk_add_f32 v[166:167], v[166:167], 1.0 op_sel_hi:[1,0]
    v_rcp_f32 v160, v160
    v_rcp_f32 v161, v161
    v_rcp_f32 v162, v162
    v_rcp_f32 v163, v163
    v_rcp_f32 v164, v164
    v_rcp_f32 v165, v165
    v_rcp_f32 v166, v166
    v_rcp_f32 v167, v167
    v_pk_mul_f32 v[160:161], v[80:81], v[160:161]
    v_pk_mul_f32 v[162:163], v[82:83], v[162:163]
    v_pk_mul_f32 v[164:165], v[84:85], v[164:165]
    v_pk_mul_f32 v[166:167], v[86:87], v[166:167]
    v_cvt_pk_bf16_f32 v80, v160, v161
    v_cvt_pk_bf16_f32 v81, v162, v163
    v_cvt_pk_bf16_f32 v82, v164, v165
    v_cvt_pk_bf16_f32 v83, v166, v167
    v_exp_f32 v168, v88
    v_exp_f32 v169, v89
    v_exp_f32 v170, v90
    v_exp_f32 v171, v91
    v_exp_f32 v172, v92
    v_exp_f32 v173, v93
    v_exp_f32 v174, v94
    v_exp_f32 v175, v95
    v_pk_add_f32 v[168:169], v[168:169], 1.0 op_sel_hi:[1,0]
    v_pk_add_f32 v[170:171], v[170:171], 1.0 op_sel_hi:[1,0]
    v_pk_add_f32 v[172:173], v[172:173], 1.0 op_sel_hi:[1,0]
    v_pk_add_f32 v[174:175], v[174:175], 1.0 op_sel_hi:[1,0]
    v_rcp_f32 v168, v168
    v_rcp_f32 v169, v169
    v_rcp_f32 v170, v170
    v_rcp_f32 v171, v171
    v_rcp_f32 v172, v172
    v_rcp_f32 v173, v173
    v_rcp_f32 v174, v174
    v_rcp_f32 v175, v175
    v_pk_mul_f32 v[168:169], v[88:89], v[168:169]
    v_pk_mul_f32 v[170:171], v[90:91], v[170:171]
    v_pk_mul_f32 v[172:173], v[92:93], v[172:173]
    v_pk_mul_f32 v[174:175], v[94:95], v[174:175]
    v_cvt_pk_bf16_f32 v88, v168, v169
    v_cvt_pk_bf16_f32 v89, v170, v171
    v_cvt_pk_bf16_f32 v90, v172, v173
    v_cvt_pk_bf16_f32 v91, v174, v175
    v_exp_f32 v160, v96
    v_exp_f32 v161, v97
    v_exp_f32 v162, v98
    v_exp_f32 v163, v99
    v_exp_f32 v164, v100
    v_exp_f32 v165, v101
    v_exp_f32 v166, v102
    v_exp_f32 v167, v103
    v_pk_add_f32 v[160:161], v[160:161], 1.0 op_sel_hi:[1,0]
    v_pk_add_f32 v[162:163], v[162:163], 1.0 op_sel_hi:[1,0]
    v_pk_add_f32 v[164:165], v[164:165], 1.0 op_sel_hi:[1,0]
    v_pk_add_f32 v[166:167], v[166:167], 1.0 op_sel_hi:[1,0]
    v_rcp_f32 v160, v160
    v_rcp_f32 v161, v161
    v_rcp_f32 v162, v162
    v_rcp_f32 v163, v163
    v_rcp_f32 v164, v164
    v_rcp_f32 v165, v165
    v_rcp_f32 v166, v166
    v_rcp_f32 v167, v167
    v_pk_mul_f32 v[160:161], v[96:97], v[160:161]
    v_pk_mul_f32 v[162:163], v[98:99], v[162:163]
    v_pk_mul_f32 v[164:165], v[100:101], v[164:165]
    v_pk_mul_f32 v[166:167], v[102:103], v[166:167]
    v_cvt_pk_bf16_f32 v96, v160, v161
    v_cvt_pk_bf16_f32 v97, v162, v163
    v_cvt_pk_bf16_f32 v98, v164, v165
    v_cvt_pk_bf16_f32 v99, v166, v167
    v_exp_f32 v168, v104
    v_exp_f32 v169, v105
    v_exp_f32 v170, v106
    v_exp_f32 v171, v107
    v_exp_f32 v172, v108
    v_exp_f32 v173, v109
    v_exp_f32 v174, v110
    v_exp_f32 v175, v111
    v_pk_add_f32 v[168:169], v[168:169], 1.0 op_sel_hi:[1,0]
    v_pk_add_f32 v[170:171], v[170:171], 1.0 op_sel_hi:[1,0]
    v_pk_add_f32 v[172:173], v[172:173], 1.0 op_sel_hi:[1,0]
    v_pk_add_f32 v[174:175], v[174:175], 1.0 op_sel_hi:[1,0]
    v_rcp_f32 v168, v168
    v_rcp_f32 v169, v169
    v_rcp_f32 v170, v170
    v_rcp_f32 v171, v171
    v_rcp_f32 v172, v172
    v_rcp_f32 v173, v173
    v_rcp_f32 v174, v174
    v_rcp_f32 v175, v175
    v_pk_mul_f32 v[168:169], v[104:105], v[168:169]
    v_pk_mul_f32 v[170:171], v[106:107], v[170:171]
    v_pk_mul_f32 v[172:173], v[108:109], v[172:173]
    v_pk_mul_f32 v[174:175], v[110:111], v[174:175]
    v_cvt_pk_bf16_f32 v104, v168, v169
    v_cvt_pk_bf16_f32 v105, v170, v171
    v_cvt_pk_bf16_f32 v106, v172, v173
    v_cvt_pk_bf16_f32 v107, v174, v175
    v_exp_f32 v160, v112
    v_exp_f32 v161, v113
    v_exp_f32 v162, v114
    v_exp_f32 v163, v115
    v_exp_f32 v164, v116
    v_exp_f32 v165, v117
    v_exp_f32 v166, v118
    v_exp_f32 v167, v119
    v_pk_add_f32 v[160:161], v[160:161], 1.0 op_sel_hi:[1,0]
    v_pk_add_f32 v[162:163], v[162:163], 1.0 op_sel_hi:[1,0]
    v_pk_add_f32 v[164:165], v[164:165], 1.0 op_sel_hi:[1,0]
    v_pk_add_f32 v[166:167], v[166:167], 1.0 op_sel_hi:[1,0]
    v_rcp_f32 v160, v160
    v_rcp_f32 v161, v161
    v_rcp_f32 v162, v162
    v_rcp_f32 v163, v163
    v_rcp_f32 v164, v164
    v_rcp_f32 v165, v165
    v_rcp_f32 v166, v166
    v_rcp_f32 v167, v167
    v_pk_mul_f32 v[160:161], v[112:113], v[160:161]
    v_pk_mul_f32 v[162:163], v[114:115], v[162:163]
    v_pk_mul_f32 v[164:165], v[116:117], v[164:165]
    v_pk_mul_f32 v[166:167], v[118:119], v[166:167]
    v_cvt_pk_bf16_f32 v112, v160, v161
    v_cvt_pk_bf16_f32 v113, v162, v163
    v_cvt_pk_bf16_f32 v114, v164, v165
    v_cvt_pk_bf16_f32 v115, v166, v167
    v_exp_f32 v168, v120
    v_exp_f32 v169, v121
    v_exp_f32 v170, v122
    v_exp_f32 v171, v123
    v_exp_f32 v172, v124
    v_exp_f32 v173, v125
    v_exp_f32 v174, v126
    v_exp_f32 v175, v127
    v_pk_add_f32 v[168:169], v[168:169], 1.0 op_sel_hi:[1,0]
    v_pk_add_f32 v[170:171], v[170:171], 1.0 op_sel_hi:[1,0]
    v_pk_add_f32 v[172:173], v[172:173], 1.0 op_sel_hi:[1,0]
    v_pk_add_f32 v[174:175], v[174:175], 1.0 op_sel_hi:[1,0]
    v_rcp_f32 v168, v168
    v_rcp_f32 v169, v169
    v_rcp_f32 v170, v170
    v_rcp_f32 v171, v171
    v_rcp_f32 v172, v172
    v_rcp_f32 v173, v173
    v_rcp_f32 v174, v174
    v_rcp_f32 v175, v175
    v_pk_mul_f32 v[168:169], v[120:121], v[168:169]
    v_pk_mul_f32 v[170:171], v[122:123], v[170:171]
    v_pk_mul_f32 v[172:173], v[124:125], v[172:173]
    v_pk_mul_f32 v[174:175], v[126:127], v[174:175]
    v_cvt_pk_bf16_f32 v120, v168, v169
    v_cvt_pk_bf16_f32 v121, v170, v171
    v_cvt_pk_bf16_f32 v122, v172, v173
    v_cvt_pk_bf16_f32 v123, v174, v175
    v_mov_b32 v252, 163584
    s_mov_b32 s72, 0
LW_11:
    ds_read_b32 v253, v252 offset:12
    s_waitcnt lgkmcnt(0)
    v_readfirstlane_b32 s77, v253
    s_add_u32 s72, s72, 1
    s_cmp_ge_u32 s77, 8
    s_cbranch_scc1 LWD_12
    s_sleep 1
    s_cmp_lt_u32 s72, 524288
    s_cbranch_scc1 LW_11
LWD_12:
    ds_write_b128 v221, v[0:3] offset:0
    ds_write_b128 v221, v[8:11] offset:2080
    ds_write_b128 v221, v[16:19] offset:512
    ds_write_b128 v221, v[24:27] offset:2592
    ds_write_b128 v221, v[32:35] offset:4160
    ds_write_b128 v221, v[40:43] offset:6240
    ds_write_b128 v221, v[48:51] offset:4672
    ds_write_b128 v221, v[56:59] offset:6752
    ds_write_b128 v221, v[64:67] offset:8320
    ds_write_b128 v221, v[72:75] offset:10400
    ds_write_b128 v221, v[80:83] offset:8832
    ds_write_b128 v221, v[88:91] offset:10912
    ds_write_b128 v221, v[96:99] offset:12480
    ds_write_b128 v221, v[104:107] offset:14560
    ds_write_b128 v221, v[112:115] offset:12992
    ds_write_b128 v221, v[120:123] offset:15072
    s_waitcnt lgkmcnt(0)
    v_mov_b32 v252, 163584
    v_mov_b32 v253, 1
    s_mov_b64 exec, 1
    ds_add_u32 v252, v253 offset:16
    s_mov_b64 exec, -1
    v_mov_b32 v252, 163584
    s_mov_b32 s72, 0
LW_13:
    ds_read_b32 v253, v252 offset:16
    s_waitcnt lgkmcnt(0)
    v_readfirstlane_b32 s77, v253
    s_add_u32 s72, s72, 1
    s_cmp_ge_u32 s77, 4
    s_cbranch_scc1 LWD_14
    s_sleep 1
    s_cmp_lt_u32 s72, 524288
    s_cbranch_scc1 LW_13
LWD_14:
    s_mul_i32 s93, s92, 2080
    v_add_u32 v220, s93, v223
    s_add_u32 s93, s93, 2080
    s_cmp_eq_u32 s93, 74880
    s_cselect_b32 s93, 0, s93
    s_waitcnt vmcnt(10)
    ds_read_b128 v[200:203], v220 offset:0
    ds_read_b64_tr_b16 v[160:161], v219 offset:0
    ds_read_b64_tr_b16 v[162:163], v219 offset:512
    ds_read_b128 v[204:207], v220 offset:512
    ds_read_b64_tr_b16 v[164:165], v219 offset:1024
    ds_read_b64_tr_b16 v[166:167], v219 offset:1536
    ds_read_b64_tr_b16 v[168:169], v219 offset:2048
    ds_read_b64_tr_b16 v[170:171], v219 offset:2560
    ds_read_b64_tr_b16 v[172:173], v219 offset:3072
    ds_read_b64_tr_b16 v[174:175], v219 offset:3584
    ds_read_b64_tr_b16 v[176:177], v219 offset:4096
    ds_read_b64_tr_b16 v[178:179], v219 offset:4608
    s_waitcnt lgkmcnt(9)
    s_add_u32 m0, s68, 0
    v_mfma_f32_32x32x16_bf16 v[0:15], v[160:163], v[200:203], 0
    buffer_load_dwordx4 v217, s[36:39], s69 offen offset:0 lds
    s_waitcnt lgkmcnt(8)
    v_mfma_f32_32x32x16_bf16 v[16:31], v[160:163], v[204:207], 0
    v_add_u32 v220, s93, v223
    s_waitcnt vmcnt(10)
    ds_read_b128 v[208:211], v220 offset:0
    ds_read_b64_tr_b16 v[180:181], v219 offset:5120
    ds_read_b64_tr_b16 v[182:183], v219 offset:5632
    s_waitcnt lgkmcnt(9)
    s_add_u32 m0, s68, 960
    v_mfma_f32_32x32x16_bf16 v[32:47], v[164:167], v[200:203], 0
    buffer_load_dwordx4 v217, s[36:39], s69 offen offset:64 lds
    v_mfma_f32_32x32x16_bf16 v[48:63], v[164:167], v[204:207], 0
    s_waitcnt vmcnt(10)
    ds_read_b128 v[212:215], v220 offset:512
    ds_read_b64_tr_b16 v[184:185], v219 offset:6144
    ds_read_b64_tr_b16 v[186:187], v219 offset:6656
    s_waitcnt lgkmcnt(10)
    s_add_u32 m0, s68, 1920
    v_mfma_f32_32x32x16_bf16 v[64:79], v[168:171], v[200:203], 0
    buffer_load_dwordx4 v217, s[36:39], s69 offen offset:128 lds
    v_mfma_f32_32x32x16_bf16 v[80:95], v[168:171], v[204:207], 0
    s_waitcnt vmcnt(10)
    ds_read_b64_tr_b16 v[188:189], v219 offset:7168
    ds_read_b64_tr_b16 v[190:191], v219 offset:7680
    s_waitcnt lgkmcnt(10)
    s_add_u32 m0, s68, 2880
    v_mfma_f32_32x32x16_bf16 v[96:111], v[172:175], v[200:203], 0
    buffer_load_dwordx4 v217, s[36:39], s69 offen offset:192 lds
    v_mfma_f32_32x32x16_bf16 v[112:127], v[172:175], v[204:207], 0
    s_waitcnt vmcnt(10)
    ds_read_b64_tr_b16 v[192:193], v219 offset:8192
    ds_read_b64_tr_b16 v[194:195], v219 offset:8704
    s_add_u32 s93, s93, 2080
    s_cmp_eq_u32 s93, 74880
    s_cselect_b32 s93, 0, s93
    s_waitcnt lgkmcnt(10)
    s_add_u32 m0, s68, 3840
    v_mfma_f32_32x32x16_bf16 v[128:143], v[176:179], v[200:203], 0
    buffer_load_dwordx4 v217, s[36:39], s69 offen offset:256 lds
    v_mfma_f32_32x32x16_bf16 v[144:159], v[176:179], v[204:207], 0
    s_waitcnt vmcnt(10)
    ds_read_b64_tr_b16 v[196:197], v219 offset:9216
    ds_read_b64_tr_b16 v[198:199], v219 offset:9728
    s_add_u32 s69, s69, 18432
    s_cmp_eq_u32 s69, 663552
    s_cselect_b32 s69, 0, s69
    s_mov_b32 s70, 0
    s_branch L_G2T5_1
.p2align 3
L_G2T5_3:
    s_waitcnt lgkmcnt(9)
    s_add_u32 m0, s68, 0
    v_mfma_f32_32x32x16_bf16 v[0:15], v[180:183], v[208:211], v[0:15]
    buffer_load_dwordx4 v217, s[36:39], s69 offen offset:0 lds
    s_waitcnt lgkmcnt(8)
    v_mfma_f32_32x32x16_bf16 v[16:31], v[180:183], v[212:215], v[16:31]
    v_add_u32 v220, s93, v223
    s_waitcnt vmcnt(10)
    ds_read_b128 v[200:203], v220 offset:0
    ds_read_b64_tr_b16 v[160:161], v219 offset:5120
    ds_read_b64_tr_b16 v[162:163], v219 offset:5632
    s_waitcnt lgkmcnt(9)
    s_add_u32 m0, s68, 960
    v_mfma_f32_32x32x16_bf16 v[32:47], v[184:187], v[208:211], v[32:47]
    buffer_load_dwordx4 v217, s[36:39], s69 offen offset:64 lds
    v_mfma_f32_32x32x16_bf16 v[48:63], v[184:187], v[212:215], v[48:63]
    s_waitcnt vmcnt(10)
    ds_read_b128 v[204:207], v220 offset:512
    ds_read_b64_tr_b16 v[164:165], v219 offset:6144
    ds_read_b64_tr_b16 v[166:167], v219 offset:6656
    s_waitcnt lgkmcnt(10)
    s_add_u32 m0, s68, 1920
    v_mfma_f32_32x32x16_bf16 v[64:79], v[188:191], v[208:211], v[64:79]
    buffer_load_dwordx4 v217, s[36:39], s69 offen offset:128 lds
    v_mfma_f32_32x32x16_bf16 v[80:95], v[188:191], v[212:215], v[80:95]
    s_waitcnt vmcnt(10)
    ds_read_b64_tr_b16 v[168:169], v219 offset:7168
    ds_read_b64_tr_b16 v[170:171], v219 offset:7680
    s_waitcnt lgkmcnt(10)
    s_add_u32 m0, s68, 2880
    v_mfma_f32_32x32x16_bf16 v[96:111], v[192:195], v[208:211], v[96:111]
    buffer_load_dwordx4 v217, s[36:39], s69 offen offset:192 lds
    v_mfma_f32_32x32x16_bf16 v[112:127], v[192:195], v[212:215], v[112:127]
    s_waitcnt vmcnt(10)
    ds_read_b64_tr_b16 v[172:173], v219 offset:8192
    ds_read_b64_tr_b16 v[174:175], v219 offset:8704
    s_add_u32 s93, s93, 2080
    s_cmp_eq_u32 s93, 74880
    s_cselect_b32 s93, 0, s93
    s_waitcnt lgkmcnt(10)
    s_add_u32 m0, s68, 3840
    v_mfma_f32_32x32x16_bf16 v[128:143], v[196:199], v[208:211], v[128:143]
    buffer_load_dwordx4 v217, s[36:39], s69 offen offset:256 lds
    v_mfma_f32_32x32x16_bf16 v[144:159], v[196:199], v[212:215], v[144:159]
    s_waitcnt vmcnt(10)
    ds_read_b64_tr_b16 v[176:177], v219 offset:9216
    ds_read_b64_tr_b16 v[178:179], v219 offset:9728
    s_add_u32 s69, s69, 18432
    s_cmp_eq_u32 s69, 663552
    s_cselect_b32 s69, 0, s69
    s_waitcnt lgkmcnt(9)
    s_add_u32 m0, s68, 5120
    v_mfma_f32_32x32x16_bf16 v[0:15], v[160:163], v[200:203], v[0:15]
    buffer_load_dwordx4 v217, s[36:39], s69 offen offset:0 lds
    s_waitcnt lgkmcnt(8)
    v_mfma_f32_32x32x16_bf16 v[16:31], v[160:163], v[204:207], v[16:31]
    v_add_u32 v220, s93, v223
    s_waitcnt vmcnt(10)
    ds_read_b128 v[208:211], v220 offset:0
    ds_read_b64_tr_b16 v[180:181], v219 offset:10240
    ds_read_b64_tr_b16 v[182:183], v219 offset:10752
    s_waitcnt lgkmcnt(9)
    s_add_u32 m0, s68, 6080
    v_mfma_f32_32x32x16_bf16 v[32:47], v[164:167], v[200:203], v[32:47]
    buffer_load_dwordx4 v217, s[36:39], s69 offen offset:64 lds
    v_mfma_f32_32x32x16_bf16 v[48:63], v[164:167], v[204:207], v[48:63]
    s_waitcnt vmcnt(10)
    ds_read_b128 v[212:215], v220 offset:512
    ds_read_b64_tr_b16 v[184:185], v219 offset:11264
    ds_read_b64_tr_b16 v[186:187], v219 offset:11776
    s_waitcnt lgkmcnt(10)
    s_add_u32 m0, s68, 7040
    v_mfma_f32_32x32x16_bf16 v[64:79], v[168:171], v[200:203], v[64:79]
    buffer_load_dwordx4 v217, s[36:39], s69 offen offset:128 lds
    v_mfma_f32_32x32x16_bf16 v[80:95], v[168:171], v[204:207], v[80:95]
    s_waitcnt vmcnt(10)
    ds_read_b64_tr_b16 v[188:189], v219 offset:12288
    ds_read_b64_tr_b16 v[190:191], v219 offset:12800
    s_waitcnt lgkmcnt(10)
    s_add_u32 m0, s68, 8000
    v_mfma_f32_32x32x16_bf16 v[96:111], v[172:175], v[200:203], v[96:111]
    buffer_load_dwordx4 v217, s[36:39], s69 offen offset:192 lds
    v_mfma_f32_32x32x16_bf16 v[112:127], v[172:175], v[204:207], v[112:127]
    s_waitcnt vmcnt(10)
    ds_read_b64_tr_b16 v[192:193], v219 offset:13312
    ds_read_b64_tr_b16 v[194:195], v219 offset:13824
    s_add_u32 s93, s93, 2080
    s_cmp_eq_u32 s93, 74880
    s_cselect_b32 s93, 0, s93
    s_waitcnt lgkmcnt(10)
    s_add_u32 m0, s68, 8960
    v_mfma_f32_32x32x16_bf16 v[128:143], v[176:179], v[200:203], v[128:143]
    buffer_load_dwordx4 v217, s[36:39], s69 offen offset:256 lds
    v_mfma_f32_32x32x16_bf16 v[144:159], v[176:179], v[204:207], v[144:159]
    s_waitcnt vmcnt(10)
    ds_read_b64_tr_b16 v[196:197], v219 offset:14336
    ds_read_b64_tr_b16 v[198:199], v219 offset:14848
    s_add_u32 s69, s69, 18432
    s_cmp_eq_u32 s69, 663552
    s_cselect_b32 s69, 0, s69
    s_waitcnt lgkmcnt(9)
    s_add_u32 m0, s68, 10240
    v_mfma_f32_32x32x16_bf16 v[0:15], v[180:183], v[208:211], v[0:15]
    buffer_load_dwordx4 v217, s[36:39], s69 offen offset:0 lds
    s_waitcnt lgkmcnt(8)
    v_mfma_f32_32x32x16_bf16 v[16:31], v[180:183], v[212:215], v[16:31]
    v_add_u32 v220, s93, v223
    s_waitcnt vmcnt(10)
    ds_read_b128 v[200:203], v220 offset:0
    ds_read_b64_tr_b16 v[160:161], v219 offset:0
    ds_read_b64_tr_b16 v[162:163], v219 offset:512
    s_waitcnt lgkmcnt(9)
    s_add_u32 m0, s68, 11200
    v_mfma_f32_32x32x16_bf16 v[32:47], v[184:187], v[208:211], v[32:47]
    buffer_load_dwordx4 v217, s[36:39], s69 offen offset:64 lds
    v_mfma_f32_32x32x16_bf16 v[48:63], v[184:187], v[212:215], v[48:63]
    s_waitcnt vmcnt(10)
    ds_read_b128 v[204:207], v220 offset:512
    ds_read_b64_tr_b16 v[164:165], v219 offset:1024
    ds_read_b64_tr_b16 v[166:167], v219 offset:1536
    s_waitcnt lgkmcnt(10)
    s_add_u32 m0, s68, 12160
    v_mfma_f32_32x32x16_bf16 v[64:79], v[188:191], v[208:211], v[64:79]
    buffer_load_dwordx4 v217, s[36:39], s69 offen offset:128 lds
    v_mfma_f32_32x32x16_bf16 v[80:95], v[188:191], v[212:215], v[80:95]
    s_waitcnt vmcnt(10)
    ds_read_b64_tr_b16 v[168:169], v219 offset:2048
    ds_read_b64_tr_b16 v[170:171], v219 offset:2560
    s_waitcnt lgkmcnt(10)
    s_add_u32 m0, s68, 13120
    v_mfma_f32_32x32x16_bf16 v[96:111], v[192:195], v[208:211], v[96:111]
    buffer_load_dwordx4 v217, s[36:39], s69 offen offset:192 lds
    v_mfma_f32_32x32x16_bf16 v[112:127], v[192:195], v[212:215], v[112:127]
    s_waitcnt vmcnt(10)
    ds_read_b64_tr_b16 v[172:173], v219 offset:3072
    ds_read_b64_tr_b16 v[174:175], v219 offset:3584
    s_add_u32 s93, s93, 2080
    s_cmp_eq_u32 s93, 74880
    s_cselect_b32 s93, 0, s93
    s_waitcnt lgkmcnt(10)
    s_add_u32 m0, s68, 14080
    v_mfma_f32_32x32x16_bf16 v[128:143], v[196:199], v[208:211], v[128:143]
    buffer_load_dwordx4 v217, s[36:39], s69 offen offset:256 lds
    v_mfma_f32_32x32x16_bf16 v[144:159], v[196:199], v[212:215], v[144:159]
    s_waitcnt vmcnt(10)
    ds_read_b64_tr_b16 v[176:177], v219 offset:4096
    ds_read_b64_tr_b16 v[178:179], v219 offset:4608
    s_add_u32 s69, s69, 18432
    s_cmp_eq_u32 s69, 663552
    s_cselect_b32 s69, 0, s69
    s_waitcnt lgkmcnt(9)
    s_add_u32 m0, s68, 0
    v_mfma_f32_32x32x16_bf16 v[0:15], v[160:163], v[200:203], v[0:15]
    buffer_load_dwordx4 v217, s[36:39], s69 offen offset:0 lds
    s_waitcnt lgkmcnt(8)
    v_mfma_f32_32x32x16_bf16 v[16:31], v[160:163], v[204:207], v[16:31]
    v_add_u32 v220, s93, v223
    s_waitcnt vmcnt(10)
    ds_read_b128 v[208:211], v220 offset:0
    ds_read_b64_tr_b16 v[180:181], v219 offset:5120
    ds_read_b64_tr_b16 v[182:183], v219 offset:5632
    s_waitcnt lgkmcnt(9)
    s_add_u32 m0, s68, 960
    v_mfma_f32_32x32x16_bf16 v[32:47], v[164:167], v[200:203], v[32:47]
    buffer_load_dwordx4 v217, s[36:39], s69 offen offset:64 lds
    v_mfma_f32_32x32x16_bf16 v[48:63], v[164:167], v[204:207], v[48:63]
    s_waitcnt vmcnt(10)
    ds_read_b128 v[212:215], v220 offset:512
    ds_read_b64_tr_b16 v[184:185], v219 offset:6144
    ds_read_b64_tr_b16 v[186:187], v219 offset:6656
    s_waitcnt lgkmcnt(10)
    s_add_u32 m0, s68, 1920
    v_mfma_f32_32x32x16_bf16 v[64:79], v[168:171], v[200:203], v[64:79]
    buffer_load_dwordx4 v217, s[36:39], s69 offen offset:128 lds
    v_mfma_f32_32x32x16_bf16 v[80:95], v[168:171], v[204:207], v[80:95]
    s_waitcnt vmcnt(10)
    ds_read_b64_tr_b16 v[188:189], v219 offset:7168
    ds_read_b64_tr_b16 v[190:191], v219 offset:7680
    s_waitcnt lgkmcnt(10)
    s_add_u32 m0, s68, 2880
    v_mfma_f32_32x32x16_bf16 v[96:111], v[172:175], v[200:203], v[96:111]
    buffer_load_dwordx4 v217, s[36:39], s69 offen offset:192 lds
    v_mfma_f32_32x32x16_bf16 v[112:127], v[172:175], v[204:207], v[112:127]
    s_waitcnt vmcnt(10)
    ds_read_b64_tr_b16 v[192:193], v219 offset:8192
    ds_read_b64_tr_b16 v[194:195], v219 offset:8704
    s_add_u32 s93, s93, 2080
    s_cmp_eq_u32 s93, 74880
    s_cselect_b32 s93, 0, s93
    s_waitcnt lgkmcnt(10)
    s_add_u32 m0, s68, 3840
    v_mfma_f32_32x32x16_bf16 v[128:143], v[176:179], v[200:203], v[128:143]
    buffer_load_dwordx4 v217, s[36:39], s69 offen offset:256 lds
    v_mfma_f32_32x32x16_bf16 v[144:159], v[176:179], v[204:207], v[144:159]
    s_waitcnt vmcnt(10)
    ds_read_b64_tr_b16 v[196:197], v219 offset:9216
    ds_read_b64_tr_b16 v[198:199], v219 offset:9728
    s_add_u32 s69, s69, 18432
    s_cmp_eq_u32 s69, 663552
    s_cselect_b32 s69, 0, s69
L_G2T5_1:
    s_waitcnt lgkmcnt(9)
    s_add_u32 m0, s68, 5120
    v_mfma_f32_32x32x16_bf16 v[0:15], v[180:183], v[208:211], v[0:15]
    buffer_load_dwordx4 v217, s[36:39], s69 offen offset:0 lds
    s_waitcnt lgkmcnt(8)
    v_mfma_f32_32x32x16_bf16 v[16:31], v[180:183], v[212:215], v[16:31]
    v_add_u32 v220, s93, v223
    s_waitcnt vmcnt(10)
    ds_read_b128 v[200:203], v220 offset:0
    ds_read_b64_tr_b16 v[160:161], v219 offset:10240
    ds_read_b64_tr_b16 v[162:163], v219 offset:10752
    s_waitcnt lgkmcnt(9)
    s_add_u32 m0, s68, 6080
    v_mfma_f32_32x32x16_bf16 v[32:47], v[184:187], v[208:211], v[32:47]
    buffer_load_dwordx4 v217, s[36:39], s69 offen offset:64 lds
    v_mfma_f32_32x32x16_bf16 v[48:63], v[184:187], v[212:215], v[48:63]
    s_waitcnt vmcnt(10)
    ds_read_b128 v[204:207], v220 offset:512
    ds_read_b64_tr_b16 v[164:165], v219 offset:11264
    ds_read_b64_tr_b16 v[166:167], v219 offset:11776
    s_waitcnt lgkmcnt(10)
    s_add_u32 m0, s68, 7040
    v_mfma_f32_32x32x16_bf16 v[64:79], v[188:191], v[208:211], v[64:79]
    buffer_load_dwordx4 v217, s[36:39], s69 offen offset:128 lds
    v_mfma_f32_32x32x16_bf16 v[80:95], v[188:191], v[212:215], v[80:95]
    s_waitcnt vmcnt(10)
    ds_read_b64_tr_b16 v[168:169], v219 offset:12288
    ds_read_b64_tr_b16 v[170:171], v219 offset:12800
    s_waitcnt lgkmcnt(10)
    s_add_u32 m0, s68, 8000
    v_mfma_f32_32x32x16_bf16 v[96:111], v[192:195], v[208:211], v[96:111]
    buffer_load_dwordx4 v217, s[36:39], s69 offen offset:192 lds
    v_mfma_f32_32x32x16_bf16 v[112:127], v[192:195], v[212:215], v[112:127]
    s_waitcnt vmcnt(10)
    ds_read_b64_tr_b16 v[172:173], v219 offset:13312
    ds_read_b64_tr_b16 v[174:175], v219 offset:13824
    s_add_u32 s93, s93, 2080
    s_cmp_eq_u32 s93, 74880
    s_cselect_b32 s93, 0, s93
    s_waitcnt lgkmcnt(10)
    s_add_u32 m0, s68, 8960
    v_mfma_f32_32x32x16_bf16 v[128:143], v[196:199], v[208:211], v[128:143]
    buffer_load_dwordx4 v217, s[36:39], s69 offen offset:256 lds
    v_mfma_f32_32x32x16_bf16 v[144:159], v[196:199], v[212:215], v[144:159]
    s_waitcnt vmcnt(10)
    ds_read_b64_tr_b16 v[176:177], v219 offset:14336
    ds_read_b64_tr_b16 v[178:179], v219 offset:14848
    s_add_u32 s69, s69, 18432
    s_cmp_eq_u32 s69, 663552
    s_cselect_b32 s69, 0, s69
    s_waitcnt lgkmcnt(9)
    s_add_u32 m0, s68, 10240
    v_mfma_f32_32x32x16_bf16 v[0:15], v[160:163], v[200:203], v[0:15]
    buffer_load_dwordx4 v217, s[36:39], s69 offen offset:0 lds
    s_waitcnt lgkmcnt(8)
    v_mfma_f32_32x32x16_bf16 v[16:31], v[160:163], v[204:207], v[16:31]
    v_add_u32 v220, s93, v223
    s_waitcnt vmcnt(10)
    ds_read_b128 v[208:211], v220 offset:0
    ds_read_b64_tr_b16 v[180:181], v219 offset:0
    ds_read_b64_tr_b16 v[182:183], v219 offset:512
    s_waitcnt lgkmcnt(9)
    s_add_u32 m0, s68, 11200
    v_mfma_f32_32x32x16_bf16 v[32:47], v[164:167], v[200:203], v[32:47]
    buffer_load_dwordx4 v217, s[36:39], s69 offen offset:64 lds
    v_mfma_f32_32x32x16_bf16 v[48:63], v[164:167], v[204:207], v[48:63]
    s_waitcnt vmcnt(10)
    ds_read_b128 v[212:215], v220 offset:512
    ds_read_b64_tr_b16 v[184:185], v219 offset:1024
    ds_read_b64_tr_b16 v[186:187], v219 offset:1536
    s_waitcnt lgkmcnt(10)
    s_add_u32 m0, s68, 12160
    v_mfma_f32_32x32x16_bf16 v[64:79], v[168:171], v[200:203], v[64:79]
    buffer_load_dwordx4 v217, s[36:39], s69 offen offset:128 lds
    v_mfma_f32_32x32x16_bf16 v[80:95], v[168:171], v[204:207], v[80:95]
    s_waitcnt vmcnt(10)
    ds_read_b64_tr_b16 v[188:189], v219 offset:2048
    ds_read_b64_tr_b16 v[190:191], v219 offset:2560
    s_waitcnt lgkmcnt(10)
    s_add_u32 m0, s68, 13120
    v_mfma_f32_32x32x16_bf16 v[96:111], v[172:175], v[200:203], v[96:111]
    buffer_load_dwordx4 v217, s[36:39], s69 offen offset:192 lds
    v_mfma_f32_32x32x16_bf16 v[112:127], v[172:175], v[204:207], v[112:127]
    s_waitcnt vmcnt(10)
    ds_read_b64_tr_b16 v[192:193], v219 offset:3072
    ds_read_b64_tr_b16 v[194:195], v219 offset:3584
    s_add_u32 s93, s93, 2080
    s_cmp_eq_u32 s93, 74880
    s_cselect_b32 s93, 0, s93
    s_waitcnt lgkmcnt(10)
    s_add_u32 m0, s68, 14080
    v_mfma_f32_32x32x16_bf16 v[128:143], v[176:179], v[200:203], v[128:143]
    buffer_load_dwordx4 v217, s[36:39], s69 offen offset:256 lds
    v_mfma_f32_32x32x16_bf16 v[144:159], v[176:179], v[204:207], v[144:159]
    s_waitcnt vmcnt(10)
    ds_read_b64_tr_b16 v[196:197], v219 offset:4096
    ds_read_b64_tr_b16 v[198:199], v219 offset:4608
    s_add_u32 s69, s69, 18432
    s_cmp_eq_u32 s69, 663552
    s_cselect_b32 s69, 0, s69
    s_add_u32 s70, s70, 1
    s_cmp_lt_u32 s70, 6
    s_cbranch_scc1 L_G2T5_3
    s_waitcnt lgkmcnt(9)
    v_mfma_f32_32x32x16_bf16 v[0:15], v[180:183], v[208:211], v[0:15]
    s_waitcnt lgkmcnt(8)
    v_mfma_f32_32x32x16_bf16 v[16:31], v[180:183], v[212:215], v[16:31]
    v_add_u32 v220, s93, v223
    s_waitcnt vmcnt(9)
    ds_read_b128 v[200:203], v220 offset:0
    ds_read_b64_tr_b16 v[160:161], v219 offset:5120
    ds_read_b64_tr_b16 v[162:163], v219 offset:5632
    s_waitcnt lgkmcnt(9)
    v_mfma_f32_32x32x16_bf16 v[32:47], v[184:187], v[208:211], v[32:47]
    v_mfma_f32_32x32x16_bf16 v[48:63], v[184:187], v[212:215], v[48:63]
    s_waitcnt vmcnt(8)
    ds_read_b128 v[204:207], v220 offset:512
    ds_read_b64_tr_b16 v[164:165], v219 offset:6144
    ds_read_b64_tr_b16 v[166:167], v219 offset:6656
    s_waitcnt lgkmcnt(10)
    v_mfma_f32_32x32x16_bf16 v[64:79], v[188:191], v[208:211], v[64:79]
    v_mfma_f32_32x32x16_bf16 v[80:95], v[188:191], v[212:215], v[80:95]
    s_waitcnt vmcnt(7)
    ds_read_b64_tr_b16 v[168:169], v219 offset:7168
    ds_read_b64_tr_b16 v[170:171], v219 offset:7680
    s_waitcnt lgkmcnt(10)
    v_mfma_f32_32x32x16_bf16 v[96:111], v[192:195], v[208:211], v[96:111]
    v_mfma_f32_32x32x16_bf16 v[112:127], v[192:195], v[212:215], v[112:127]
    s_waitcnt vmcnt(6)
    ds_read_b64_tr_b16 v[172:173], v219 offset:8192
    ds_read_b64_tr_b16 v[174:175], v219 offset:8704
    s_add_u32 s93, s93, 2080
    s_cmp_eq_u32 s93, 74880
    s_cselect_b32 s93, 0, s93
    s_waitcnt lgkmcnt(10)
    v_mfma_f32_32x32x16_bf16 v[128:143], v[196:199], v[208:211], v[128:143]
    v_mfma_f32_32x32x16_bf16 v[144:159], v[196:199], v[212:215], v[144:159]
    s_waitcnt vmcnt(5)
    ds_read_b64_tr_b16 v[176:177], v219 offset:9216
    ds_read_b64_tr_b16 v[178:179], v219 offset:9728
    s_waitcnt lgkmcnt(9)
    v_mfma_f32_32x32x16_bf16 v[0:15], v[160:163], v[200:203], v[0:15]
    s_waitcnt lgkmcnt(8)
    v_mfma_f32_32x32x16_bf16 v[16:31], v[160:163], v[204:207], v[16:31]
    v_add_u32 v220, s93, v223
    s_waitcnt vmcnt(4)
    ds_read_b128 v[208:211], v220 offset:0
    ds_read_b64_tr_b16 v[180:181], v219 offset:10240
    ds_read_b64_tr_b16 v[182:183], v219 offset:10752
    s_waitcnt lgkmcnt(9)
    v_mfma_f32_32x32x16_bf16 v[32:47], v[164:167], v[200:203], v[32:47]
    v_mfma_f32_32x32x16_bf16 v[48:63], v[164:167], v[204:207], v[48:63]
    s_waitcnt vmcnt(3)
    ds_read_b128 v[212:215], v220 offset:512
    ds_read_b64_tr_b16 v[184:185], v219 offset:11264
    ds_read_b64_tr_b16 v[186:187], v219 offset:11776
    s_waitcnt lgkmcnt(10)
    v_mfma_f32_32x32x16_bf16 v[64:79], v[168:171], v[200:203], v[64:79]
    v_mfma_f32_32x32x16_bf16 v[80:95], v[168:171], v[204:207], v[80:95]
    s_waitcnt vmcnt(2)
    ds_read_b64_tr_b16 v[188:189], v219 offset:12288
    ds_read_b64_tr_b16 v[190:191], v219 offset:12800
    s_waitcnt lgkmcnt(10)
    v_mfma_f32_32x32x16_bf16 v[96:111], v[172:175], v[200:203], v[96:111]
    v_mfma_f32_32x32x16_bf16 v[112:127], v[172:175], v[204:207], v[112:127]
    s_waitcnt vmcnt(1)
    ds_read_b64_tr_b16 v[192:193], v219 offset:13312
    ds_read_b64_tr_b16 v[194:195], v219 offset:13824
    s_waitcnt lgkmcnt(10)
    v_mfma_f32_32x32x16_bf16 v[128:143], v[176:179], v[200:203], v[128:143]
    v_mfma_f32_32x32x16_bf16 v[144:159], v[176:179], v[204:207], v[144:159]
    s_waitcnt vmcnt(0)
    ds_read_b64_tr_b16 v[196:197], v219 offset:14336
    ds_read_b64_tr_b16 v[198:199], v219 offset:14848
    s_waitcnt lgkmcnt(9)
    v_mfma_f32_32x32x16_bf16 v[0:15], v[180:183], v[208:211], v[0:15]
    s_waitcnt lgkmcnt(8)
    v_mfma_f32_32x32x16_bf16 v[16:31], v[180:183], v[212:215], v[16:31]
    s_waitcnt lgkmcnt(6)
    v_mfma_f32_32x32x16_bf16 v[32:47], v[184:187], v[208:211], v[32:47]
    v_mfma_f32_32x32x16_bf16 v[48:63], v[184:187], v[212:215], v[48:63]
    s_waitcnt lgkmcnt(4)
    v_mfma_f32_32x32x16_bf16 v[64:79], v[188:191], v[208:211], v[64:79]
    v_mfma_f32_32x32x16_bf16 v[80:95], v[188:191], v[212:215], v[80:95]
    s_waitcnt lgkmcnt(2)
    v_mfma_f32_32x32x16_bf16 v[96:111], v[192:195], v[208:211], v[96:111]
    v_mfma_f32_32x32x16_bf16 v[112:127], v[192:195], v[212:215], v[112:127]
    s_waitcnt lgkmcnt(0)
    v_mfma_f32_32x32x16_bf16 v[128:143], v[196:199], v[208:211], v[128:143]
    v_mfma_f32_32x32x16_bf16 v[144:159], v[196:199], v[212:215], v[144:159]
    v_mov_b32 v252, 163584
    v_mov_b32 v253, 1
    s_mov_b64 exec, 1
    ds_add_u32 v252, v253 offset:20
    s_mov_b64 exec, -1
    s_nop 1
    v_cvt_pk_bf16_f32 v0, v0, v1
    v_cvt_pk_bf16_f32 v1, v2, v3
    v_cvt_pk_bf16_f32 v2, v4, v5
    v_cvt_pk_bf16_f32 v3, v6, v7
    v_cvt_pk_bf16_f32 v4, v8, v9
    v_cvt_pk_bf16_f32 v5, v10, v11
    v_cvt_pk_bf16_f32 v6, v12, v13
    v_cvt_pk_bf16_f32 v7, v14, v15
    s_mov_b32 s77, 0
    s_mov_b32 s78, 16384
    v_permlane32_swap_b32 v0, v2
    v_permlane32_swap_b32 v1, v3
    v_permlane32_swap_b32 v4, v6
    v_permlane32_swap_b32 v5, v7
    buffer_store_dwordx4 v[0:3], v222, s[52:55], s77 offen offset:0 sc1
    buffer_store_dwordx4 v[4:7], v222, s[52:55], s78 offen offset:0 sc1
    s_waitcnt vmcnt(4)
    v_cvt_pk_bf16_f32 v16, v16, v17
    v_cvt_pk_bf16_f32 v17, v18, v19
    v_cvt_pk_bf16_f32 v18, v20, v21
    v_cvt_pk_bf16_f32 v19, v22, v23
    v_cvt_pk_bf16_f32 v20, v24, v25
    v_cvt_pk_bf16_f32 v21, v26, v27
    v_cvt_pk_bf16_f32 v22, v28, v29
    v_cvt_pk_bf16_f32 v23, v30, v31
    s_mov_b32 s77, 0
    s_mov_b32 s78, 16384
    v_permlane32_swap_b32 v16, v18
    v_permlane32_swap_b32 v17, v19
    v_permlane32_swap_b32 v20, v22
    v_permlane32_swap_b32 v21, v23
    buffer_store_dwordx4 v[16:19], v222, s[52:55], s77 offen offset:512 sc1
    buffer_store_dwordx4 v[20:23], v222, s[52:55], s78 offen offset:512 sc1
    s_waitcnt vmcnt(4)
    v_cvt_pk_bf16_f32 v32, v32, v33
    v_cvt_pk_bf16_f32 v33, v34, v35
    v_cvt_pk_bf16_f32 v34, v36, v37
    v_cvt_pk_bf16_f32 v35, v38, v39
    v_cvt_pk_bf16_f32 v36, v40, v41
    v_cvt_pk_bf16_f32 v37, v42, v43
    v_cvt_pk_bf16_f32 v38, v44, v45
    v_cvt_pk_bf16_f32 v39, v46, v47
    s_mov_b32 s77, 32768
    s_mov_b32 s78, 49152
    v_permlane32_swap_b32 v32, v34
    v_permlane32_swap_b32 v33, v35
    v_permlane32_swap_b32 v36, v38
    v_permlane32_swap_b32 v37, v39
    buffer_store_dwordx4 v[32:35], v222, s[52:55], s77 offen offset:0 sc1
    buffer_store_dwordx4 v[36:39], v222, s[52:55], s78 offen offset:0 sc1
    s_waitcnt vmcnt(4)
    v_cvt_pk_bf16_f32 v48, v48, v49
    v_cvt_pk_bf16_f32 v49, v50, v51
    v_cvt_pk_bf16_f32 v50, v52, v53
    v_cvt_pk_bf16_f32 v51, v54, v55
    v_cvt_pk_bf16_f32 v52, v56, v57
    v_cvt_pk_bf16_f32 v53, v58, v59
    v_cvt_pk_bf16_f32 v54, v60, v61
    v_cvt_pk_bf16_f32 v55, v62, v63
    s_mov_b32 s77, 32768
    s_mov_b32 s78, 49152
    v_permlane32_swap_b32 v48, v50
    v_permlane32_swap_b32 v49, v51
    v_permlane32_swap_b32 v52, v54
    v_permlane32_swap_b32 v53, v55
    buffer_store_dwordx4 v[48:51], v222, s[52:55], s77 offen offset:512 sc1
    buffer_store_dwordx4 v[52:55], v222, s[52:55], s78 offen offset:512 sc1
    s_waitcnt vmcnt(4)
    v_cvt_pk_bf16_f32 v64, v64, v65
    v_cvt_pk_bf16_f32 v65, v66, v67
    v_cvt_pk_bf16_f32 v66, v68, v69
    v_cvt_pk_bf16_f32 v67, v70, v71
    v_cvt_pk_bf16_f32 v68, v72, v73
    v_cvt_pk_bf16_f32 v69, v74, v75
    v_cvt_pk_bf16_f32 v70, v76, v77
    v_cvt_pk_bf16_f32 v71, v78, v79
    s_mov_b32 s77, 65536
    s_mov_b32 s78, 81920
    v_permlane32_swap_b32 v64, v66
    v_permlane32_swap_b32 v65, v67
    v_permlane32_swap_b32 v68, v70
    v_permlane32_swap_b32 v69, v71
    buffer_store_dwordx4 v[64:67], v222, s[52:55], s77 offen offset:0 sc1
    buffer_store_dwordx4 v[68:71], v222, s[52:55], s78 offen offset:0 sc1
    s_waitcnt vmcnt(4)
    v_cvt_pk_bf16_f32 v80, v80, v81
    v_cvt_pk_bf16_f32 v81, v82, v83
    v_cvt_pk_bf16_f32 v82, v84, v85
    v_cvt_pk_bf16_f32 v83, v86, v87
    v_cvt_pk_bf16_f32 v84, v88, v89
    v_cvt_pk_bf16_f32 v85, v90, v91
    v_cvt_pk_bf16_f32 v86, v92, v93
    v_cvt_pk_bf16_f32 v87, v94, v95
    s_mov_b32 s77, 65536
    s_mov_b32 s78, 81920
    v_permlane32_swap_b32 v80, v82
    v_permlane32_swap_b32 v81, v83
    v_permlane32_swap_b32 v84, v86
    v_permlane32_swap_b32 v85, v87
    buffer_store_dwordx4 v[80:83], v222, s[52:55], s77 offen offset:512 sc1
    buffer_store_dwordx4 v[84:87], v222, s[52:55], s78 offen offset:512 sc1
    s_waitcnt vmcnt(4)
    v_cvt_pk_bf16_f32 v96, v96, v97
    v_cvt_pk_bf16_f32 v97, v98, v99
    v_cvt_pk_bf16_f32 v98, v100, v101
    v_cvt_pk_bf16_f32 v99, v102, v103
    v_cvt_pk_bf16_f32 v100, v104, v105
    v_cvt_pk_bf16_f32 v101, v106, v107
    v_cvt_pk_bf16_f32 v102, v108, v109
    v_cvt_pk_bf16_f32 v103, v110, v111
    s_mov_b32 s77, 98304
    s_mov_b32 s78, 114688
    v_permlane32_swap_b32 v96, v98
    v_permlane32_swap_b32 v97, v99
    v_permlane32_swap_b32 v100, v102
    v_permlane32_swap_b32 v101, v103
    buffer_store_dwordx4 v[96:99], v222, s[52:55], s77 offen offset:0 sc1
    buffer_store_dwordx4 v[100:103], v222, s[52:55], s78 offen offset:0 sc1
    s_waitcnt vmcnt(4)
    v_cvt_pk_bf16_f32 v112, v112, v113
    v_cvt_pk_bf16_f32 v113, v114, v115
    v_cvt_pk_bf16_f32 v114, v116, v117
    v_cvt_pk_bf16_f32 v115, v118, v119
    v_cvt_pk_bf16_f32 v116, v120, v121
    v_cvt_pk_bf16_f32 v117, v122, v123
    v_cvt_pk_bf16_f32 v118, v124, v125
    v_cvt_pk_bf16_f32 v119, v126, v127
    s_mov_b32 s77, 98304
    s_mov_b32 s78, 114688
    v_permlane32_swap_b32 v112, v114
    v_permlane32_swap_b32 v113, v115
    v_permlane32_swap_b32 v116, v118
    v_permlane32_swap_b32 v117, v119
    buffer_store_dwordx4 v[112:115], v222, s[52:55], s77 offen offset:512 sc1
    buffer_store_dwordx4 v[116:119], v222, s[52:55], s78 offen offset:512 sc1
    s_waitcnt vmcnt(4)
    v_cvt_pk_bf16_f32 v128, v128, v129
    v_cvt_pk_bf16_f32 v129, v130, v131
    v_cvt_pk_bf16_f32 v130, v132, v133
    v_cvt_pk_bf16_f32 v131, v134, v135
    v_cvt_pk_bf16_f32 v132, v136, v137
    v_cvt_pk_bf16_f32 v133, v138, v139
    v_cvt_pk_bf16_f32 v134, v140, v141
    v_cvt_pk_bf16_f32 v135, v142, v143
    s_mov_b32 s77, 131072
    s_mov_b32 s78, 147456
    v_permlane32_swap_b32 v128, v130
    v_permlane32_swap_b32 v129, v131
    v_permlane32_swap_b32 v132, v134
    v_permlane32_swap_b32 v133, v135
    buffer_store_dwordx4 v[128:131], v222, s[52:55], s77 offen offset:0 sc1
    buffer_store_dwordx4 v[132:135], v222, s[52:55], s78 offen offset:0 sc1
    s_waitcnt vmcnt(4)
    v_cvt_pk_bf16_f32 v144, v144, v145
    v_cvt_pk_bf16_f32 v145, v146, v147
    v_cvt_pk_bf16_f32 v146, v148, v149
    v_cvt_pk_bf16_f32 v147, v150, v151
    v_cvt_pk_bf16_f32 v148, v152, v153
    v_cvt_pk_bf16_f32 v149, v154, v155
    v_cvt_pk_bf16_f32 v150, v156, v157
    v_cvt_pk_bf16_f32 v151, v158, v159
    s_mov_b32 s77, 131072
    s_mov_b32 s78, 147456
    v_permlane32_swap_b32 v144, v146
    v_permlane32_swap_b32 v145, v147
    v_permlane32_swap_b32 v148, v150
    v_permlane32_swap_b32 v149, v151
    buffer_store_dwordx4 v[144:147], v222, s[52:55], s77 offen offset:512 sc1
    buffer_store_dwordx4 v[148:151], v222, s[52:55], s78 offen offset:512 sc1
    s_waitcnt vmcnt(4)
L_FFN_J:
    s_setprio 0
    v_add_u32 v160, 0, v250
    v_mul_u32_u24 v161, 6554, v160
    v_lshrrev_b32 v161, 16, v161
    v_mul_u32_u24 v162, 10, v161
    v_sub_u32 v162, v160, v162
    v_mul_u32_u24 v161, 1152, v161
    v_lshl_add_u32 v225, v162, 4, v161
    v_add_u32 v160, 64, v250
    v_mul_u32_u24 v161, 6554, v160
    v_lshrrev_b32 v161, 16, v161
    v_mul_u32_u24 v162, 10, v161
    v_sub_u32 v162, v160, v162
    v_mul_u32_u24 v161, 1152, v161
    v_lshl_add_u32 v226, v162, 4, v161
    v_add_u32 v160, 128, v250
    v_mul_u32_u24 v161, 6554, v160
    v_lshrrev_b32 v161, 16, v161
    v_mul_u32_u24 v162, 10, v161
    v_sub_u32 v162, v160, v162
    v_mul_u32_u24 v161, 1152, v161
    v_lshl_add_u32 v227, v162, 4, v161
    v_add_u32 v160, 192, v250
    v_mul_u32_u24 v161, 6554, v160
    v_lshrrev_b32 v161, 16, v161
    v_mul_u32_u24 v162, 10, v161
    v_sub_u32 v162, v160, v162
    v_mul_u32_u24 v161, 1152, v161
    v_lshl_add_u32 v228, v162, 4, v161
    v_add_u32 v160, 256, v250
    v_mul_u32_u24 v161, 6554, v160
    v_lshrrev_b32 v161, 16, v161
    v_mul_u32_u24 v162, 10, v161
    v_sub_u32 v162, v160, v162
    v_mul_u32_u24 v161, 1152, v161
    v_lshl_add_u32 v229, v162, 4, v161
    v_and_b32 v160, 15, v250
    v_lshrrev_b32 v161, 4, v250
    s_lshl_b32 s77, s66, 4
    v_add_u32 v162, s77, v160
    v_and_b32 v163, 1, v161
    v_lshrrev_b32 v164, 1, v161
    s_mul_i32 s78, s65, 73728
    s_add_u32 s77, s95, s78
    v_lshl_add_u32 v165, v162, 4, s77
    v_lshl_add_u32 v240, v163, 13, v165
    v_lshl_add_u32 v240, v164, 10, v240
    v_lshl_add_u32 v241, v161, 10, v165
    s_lshl_b32 s77, s64, 6
    v_add_u32 v165, s77, v162
    v_mul_u32_u24 v165, 1152, v165
    s_mul_i32 s77, s65, 144
    v_add_u32 v165, s77, v165
    v_lshl_add_u32 v242, v161, 4, v165
    v_mov_b32 v166, 1073741824
    v_cmp_gt_u32 vcc, 2, v161
    s_nop 1
    v_cndmask_b32 v242, v166, v242, vcc
    v_cmp_eq_u32 vcc, 0, v161
    s_nop 1
    v_cndmask_b32 v243, v166, v165, vcc
    v_lshl_add_u32 v244, v163, 5, v165
    v_lshl_add_u32 v244, v164, 4, v244
    v_lshl_add_u32 v245, v161, 3, v165
    v_cmp_gt_u32 vcc, 2, v161
    s_nop 1
    v_cndmask_b32 v245, v166, v245, vcc
    v_lshlrev_b32 v166, 3, v163
    v_sub_u32 v166, v160, v166
    v_mov_b32 v167, 0x3f80
    v_mov_b32 v168, 0x3f800000
    v_cmp_eq_u32 vcc, 0, v166
    v_cmp_eq_u32 s[86:87], 1, v166
    s_nop 0
    v_cndmask_b32 v232, 0, v167, vcc
    v_cndmask_b32 v232, v232, v168, s[86:87]
    v_cmp_eq_u32 vcc, 2, v166
    v_cmp_eq_u32 s[86:87], 3, v166
    s_nop 0
    v_cndmask_b32 v233, 0, v167, vcc
    v_cndmask_b32 v233, v233, v168, s[86:87]
    v_cmp_eq_u32 vcc, 4, v166
    v_cmp_eq_u32 s[86:87], 5, v166
    s_nop 0
    v_cndmask_b32 v234, 0, v167, vcc
    v_cndmask_b32 v234, v234, v168, s[86:87]
    v_cmp_eq_u32 vcc, 6, v166
    v_cmp_eq_u32 s[86:87], 7, v166
    s_nop 0
    v_cndmask_b32 v235, 0, v167, vcc
    v_cndmask_b32 v235, v235, v168, s[86:87]
    v_cmp_eq_u32 vcc, 0, v160
    v_cmp_eq_u32 s[86:87], 1, v160
    s_nop 0
    v_cndmask_b32 v236, 0, v167, vcc
    v_cndmask_b32 v236, v236, v168, s[86:87]
    v_cmp_eq_u32 vcc, 2, v160
    v_cmp_eq_u32 s[86:87], 3, v160
    s_nop 0
    v_cndmask_b32 v237, 0, v167, vcc
    v_cndmask_b32 v237, v237, v168, s[86:87]
    v_cmp_eq_u32 vcc, 4, v160
    v_cmp_eq_u32 s[86:87], 5, v160
    s_nop 0
    v_cndmask_b32 v238, 0, v167, vcc
    v_cndmask_b32 v238, v238, v168, s[86:87]
    v_cmp_eq_u32 vcc, 6, v160
    v_cmp_eq_u32 s[86:87], 7, v160
    s_nop 0
    v_cndmask_b32 v239, 0, v167, vcc
    v_cndmask_b32 v239, v239, v168, s[86:87]
    s_add_u32 s77, s95, 589824
    v_lshl_add_u32 v246, v162, 4, s77
    v_lshl_add_u32 v246, v161, 10, v246
    s_add_u32 s77, s95, 655360
    v_lshl_add_u32 v247, v162, 4, s77
    v_lshl_add_u32 v247, v161, 10, v247
    v_bfe_u32 v166, v250, 2, 2
    v_and_b32 v167, 3, v250
    v_mul_u32_u24 v168, 18, v164
    v_lshl_add_u32 v168, v163, 2, v168
    v_add_u32 v168, v168, v166
    v_mul_u32_u24 v168, 160, v168
    v_lshl_add_u32 v248, v167, 3, v168
    v_mul_u32_u24 v168, 72, v161
    v_lshrrev_b32 v169, 1, v166
    v_mul_u32_u24 v169, 18, v169
    v_and_b32 v166, 1, v166
    v_add3_u32 v168, v168, v169, v166
    v_add_u32 v168, 16, v168
    v_mul_u32_u24 v168, 160, v168
    v_lshl_add_u32 v251, v167, 3, v168
    v_mov_b32 v166, 1073741824
    v_cmp_gt_u32 vcc, 32, v250
    s_nop 1
    v_cndmask_b32 v241, v166, v241, vcc
    s_mul_i32 s79, s66, 6
    s_cmp_eq_u32 s66, 3
    s_cselect_b32 s79, 15, s79
    s_mul_i32 s80, s79, 5120
    s_mul_i32 s79, s79, 36864
    s_mul_i32 s81, s65, 144
    s_add_u32 s79, s79, s81
    s_waitcnt vmcnt(0)
    v_mov_b32 v252, 163584
    v_mov_b32 v253, 1
    s_mov_b64 exec, 1
    ds_add_rtn_u32 v253, v252, v253 offset:24
    s_waitcnt lgkmcnt(0)
    v_readfirstlane_b32 s81, v253
    s_mov_b64 exec, -1
    s_nop 0
    v_mov_b32 v231, 163712
    ds_read_b64 v[252:253], v231
    s_waitcnt lgkmcnt(0)
    v_readfirstlane_b32 s98, v252
    v_readfirstlane_b32 s99, v253
    s_nop 1
    s_cmp_lg_u32 s81, 3
    s_cbranch_scc1 L_NOPF
    s_lshl_b32 s78, s65, 3
    s_add_u32 s77, s95, s78
    s_add_u32 s77, s77, 663552
    v_mov_b32 v231, 0
    v_mov_b32 v252, s98
    v_mov_b32 v253, s99
    s_mov_b64 exec, 1
    buffer_store_dwordx2 v[252:253], v231, s[52:55], s77 offen sc1
    s_mov_b64 exec, -1
L_NOPF:
    v_mov_b32 v252, 163584
    s_mov_b32 s72, 0
LW_15:
    ds_read_b32 v253, v252 offset:20
    s_waitcnt lgkmcnt(0)
    v_readfirstlane_b32 s77, v253
    s_add_u32 s72, s72, 1
    s_cmp_ge_u32 s77, 4
    s_cbranch_scc1 LWD_16
    s_sleep 1
    s_cmp_lt_u32 s72, 524288
    s_cbranch_scc1 LW_15
LWD_16:
    s_cmp_ge_u32 s66, 2
    s_cselect_b32 s70, 3, 6
L_WO_L:
    s_add_u32 m0, s80, 0
    s_nop 0
    buffer_load_dwordx4 v225, s[48:51], s79 offen lds
    s_add_u32 m0, s80, 1024
    s_nop 0
    buffer_load_dwordx4 v226, s[48:51], s79 offen lds
    s_add_u32 m0, s80, 2048
    s_nop 0
    buffer_load_dwordx4 v227, s[48:51], s79 offen lds
    s_add_u32 m0, s80, 3072
    s_nop 0
    buffer_load_dwordx4 v228, s[48:51], s79 offen lds
    s_add_u32 m0, s80, 4096
    s_nop 0
    buffer_load_dwordx4 v229, s[48:51], s79 offen lds
    s_add_u32 s80, s80, 5120
    s_add_u32 s79, s79, 36864
    s_waitcnt vmcnt(3)
    s_sub_u32 s70, s70, 1
    s_cmp_lg_u32 s70, 0
    s_cbranch_scc1 L_WO_L
L_WO_D:
    buffer_load_dwordx4 v[60:63], v242, s[28:31], 0 offen offset:0
    buffer_load_dwordx4 v[64:67], v242, s[28:31], 0 offen offset:32
    buffer_load_dwordx4 v[68:71], v242, s[28:31], 0 offen offset:64
    buffer_load_dwordx4 v[72:75], v242, s[28:31], 0 offen offset:96
    buffer_load_dwordx4 v[76:79], v243, s[28:31], 0 offen offset:128
    s_waitcnt vmcnt(0)
    v_mov_b32 v252, 163584
    v_mov_b32 v253, 1
    s_mov_b64 exec, 1
    ds_add_u32 v252, v253 offset:28
    s_mov_b64 exec, -1
    v_mov_b32 v0, 0
    v_mov_b32 v1, 0
    v_mov_b32 v2, 0
    v_mov_b32 v3, 0
    v_mov_b32 v4, 0
    v_mov_b32 v5, 0
    v_mov_b32 v6, 0
    v_mov_b32 v7, 0
    v_mov_b32 v8, 0
    v_mov_b32 v9, 0
    v_mov_b32 v10, 0
    v_mov_b32 v11, 0
    v_mov_b32 v12, 0
    v_mov_b32 v13, 0
    v_mov_b32 v14, 0
    v_mov_b32 v15, 0
    v_mov_b32 v16, 0
    v_mov_b32 v17, 0
    v_mov_b32 v18, 0
    v_mov_b32 v19, 0
    s_add_u32 s80, s95, 663552
    s_mov_b32 s81, 0x55
    v_and_b32 v231, 7, v250
    v_lshlrev_b32 v231, 3, v231
    s_mov_b32 s72, 0
L_PD_POLL:
    buffer_load_dwordx2 v[252:253], v231, s[52:55], s80 offen sc1
    s_waitcnt vmcnt(0)
    v_xor_b32 v252, s98, v252
    v_xor_b32 v253, s99, v253
    v_or_b32 v252, v252, v253
    v_cmp_eq_u32 vcc, 0, v252
    s_add_u32 s72, s72, 1
    s_nop 1
    s_lshr_b32 s79, vcc_lo, 1
    s_and_b32 s79, s79, vcc_lo
    s_cmp_ge_u32 s72, 524288
    s_cselect_b32 s79, -1, s79
    s_and_b32 s79, s79, s81
    s_cbranch_scc1 L_PD_GO
    s_sleep 4
    s_branch L_PD_POLL
L_PD_GO:
    s_ff1_i32_b32 s78, s79
    s_bitset0_b32 s79, s78
    s_bitset0_b32 s81, s78
    s_lshl_b32 s78, s78, 10
    s_add_u32 s77, s78, 0
    buffer_load_dwordx4 v[20:23], v240, s[52:55], s77 offen sc1
    s_add_u32 s77, s78, 16384
    buffer_load_dwordx4 v[24:27], v240, s[52:55], s77 offen sc1
    s_add_u32 s77, s78, 32768
    buffer_load_dwordx4 v[28:31], v240, s[52:55], s77 offen sc1
    s_add_u32 s77, s78, 49152
    buffer_load_dwordx4 v[32:35], v240, s[52:55], s77 offen sc1
    s_add_u32 s77, s78, 65536
    buffer_load_dwordx4 v[36:39], v241, s[52:55], s77 offen sc1
    s_cmp_eq_u32 s79, 0
    s_cbranch_scc1 L_PD_ONE
    s_ff1_i32_b32 s78, s79
    s_bitset0_b32 s79, s78
    s_bitset0_b32 s81, s78
    s_lshl_b32 s78, s78, 10
    s_add_u32 s77, s78, 0
    buffer_load_dwordx4 v[40:43], v240, s[52:55], s77 offen sc1
    s_add_u32 s77, s78, 16384
    buffer_load_dwordx4 v[44:47], v240, s[52:55], s77 offen sc1
    s_add_u32 s77, s78, 32768
    buffer_load_dwordx4 v[48:51], v240, s[52:55], s77 offen sc1
    s_add_u32 s77, s78, 49152
    buffer_load_dwordx4 v[52:55], v240, s[52:55], s77 offen sc1
    s_add_u32 s77, s78, 65536
    buffer_load_dwordx4 v[56:59], v241, s[52:55], s77 offen sc1
    s_waitcnt vmcnt(9)
    v_mfma_f32_16x16x32_bf16 v[0:3], v[232:235], v[20:23], v[0:3]
    s_waitcnt vmcnt(8)
    v_mfma_f32_16x16x32_bf16 v[4:7], v[232:235], v[24:27], v[4:7]
    s_waitcnt vmcnt(7)
    v_mfma_f32_16x16x32_bf16 v[8:11], v[232:235], v[28:31], v[8:11]
    s_waitcnt vmcnt(6)
    v_mfma_f32_16x16x32_bf16 v[12:15], v[232:235], v[32:35], v[12:15]
    s_waitcnt vmcnt(5)
    v_mfma_f32_16x16x32_bf16 v[16:19], v[236:239], v[36:39], v[16:19]
    s_waitcnt vmcnt(4)
    v_mfma_f32_16x16x32_bf16 v[0:3], v[232:235], v[40:43], v[0:3]
    s_waitcnt vmcnt(3)
    v_mfma_f32_16x16x32_bf16 v[4:7], v[232:235], v[44:47], v[4:7]
    s_waitcnt vmcnt(2)
    v_mfma_f32_16x16x32_bf16 v[8:11], v[232:235], v[48:51], v[8:11]
    s_waitcnt vmcnt(1)
    v_mfma_f32_16x16x32_bf16 v[12:15], v[232:235], v[52:55], v[12:15]
    s_waitcnt vmcnt(0)
    v_mfma_f32_16x16x32_bf16 v[16:19], v[236:239], v[56:59], v[16:19]
    s_branch L_PD_J
L_PD_ONE:
    s_waitcnt vmcnt(4)
    v_mfma_f32_16x16x32_bf16 v[0:3], v[232:235], v[20:23], v[0:3]
    s_waitcnt vmcnt(3)
    v_mfma_f32_16x16x32_bf16 v[4:7], v[232:235], v[24:27], v[4:7]
    s_waitcnt vmcnt(2)
    v_mfma_f32_16x16x32_bf16 v[8:11], v[232:235], v[28:31], v[8:11]
    s_waitcnt vmcnt(1)
    v_mfma_f32_16x16x32_bf16 v[12:15], v[232:235], v[32:35], v[12:15]
    s_waitcnt vmcnt(0)
    v_mfma_f32_16x16x32_bf16 v[16:19], v[236:239], v[36:39], v[16:19]
L_PD_J:
    s_cmp_lg_u32 s79, 0
    s_cbranch_scc1 L_PD_GO
    s_cmp_lg_u32 s81, 0
    s_cbranch_scc1 L_PD_POLL
    s_mov_b32 s77, 0xbf317218
    s_nop 5
    v_mul_f32 v0, s77, v0
    v_mul_f32 v1, s77, v1
    v_mul_f32 v2, s77, v2
    v_mul_f32 v3, s77, v3
    v_mul_f32 v4, s77, v4
    v_mul_f32 v5, s77, v5
    v_mul_f32 v6, s77, v6
    v_mul_f32 v7, s77, v7
    v_mul_f32 v8, s77, v8
    v_mul_f32 v9, s77, v9
    v_mul_f32 v10, s77, v10
    v_mul_f32 v11, s77, v11
    v_mul_f32 v12, s77, v12
    v_mul_f32 v13, s77, v13
    v_mul_f32 v14, s77, v14
    v_mul_f32 v15, s77, v15
    v_mul_f32 v16, s77, v16
    v_mul_f32 v17, s77, v17
    v_mul_f32 v18, s77, v18
    v_mul_f32 v19, s77, v19
    v_mfma_f32_16x16x32_bf16 v[0:3], v[232:235], v[60:63], v[0:3]
    v_mfma_f32_16x16x32_bf16 v[4:7], v[232:235], v[64:67], v[4:7]
    v_mfma_f32_16x16x32_bf16 v[8:11], v[232:235], v[68:71], v[8:11]
    v_mfma_f32_16x16x32_bf16 v[12:15], v[232:235], v[72:75], v[12:15]
    v_mfma_f32_16x16x32_bf16 v[16:19], v[236:239], v[76:79], v[16:19]
    s_lshr_b32 s77, s65, 1
    s_add_u32 s77, s77, 1
    s_and_b32 s77, s77, 3
    s_lshl_b32 s74, s77, 14
    s_mul_i32 s77, s77, 23040
    v_add_u32 v225, s77, v248
    s_lshr_b32 s77, s65, 1
    s_add_u32 s77, s77, 2
    s_and_b32 s77, s77, 3
    s_lshl_b32 s75, s77, 14
    s_mul_i32 s77, s77, 23040
    v_add_u32 v226, s77, v248
    s_lshr_b32 s77, s65, 1
    s_add_u32 s77, s77, 3
    s_and_b32 s77, s77, 3
    s_lshl_b32 s76, s77, 14
    s_mul_i32 s77, s77, 23040
    v_add_u32 v227, s77, v248
    s_lshr_b32 s77, s65, 1
    s_add_u32 s77, s77, 4
    s_and_b32 s77, s77, 3
    s_lshl_b32 s97, s77, 14
    s_mul_i32 s77, s77, 23040
    v_add_u32 v228, s77, v248
    v_mov_b32 v252, 163584
    s_mov_b32 s72, 0
LW_17:
    ds_read_b32 v253, v252 offset:28
    s_waitcnt lgkmcnt(0)
    v_readfirstlane_b32 s77, v253
    s_add_u32 s72, s72, 1
    s_cmp_ge_u32 s77, 4
    s_cbranch_scc1 LWD_18
    s_sleep 1
    s_cmp_lt_u32 s72, 524288
    s_cbranch_scc1 LW_17
LWD_18:
    ds_read_b64_tr_b16 v[92:93], v225 offset:0
    ds_read_b64_tr_b16 v[94:95], v225 offset:1280
    ds_read_b64_tr_b16 v[96:97], v225 offset:32
    ds_read_b64_tr_b16 v[98:99], v225 offset:1312
    ds_read_b64_tr_b16 v[100:101], v225 offset:64
    ds_read_b64_tr_b16 v[102:103], v225 offset:1344
    ds_read_b64_tr_b16 v[104:105], v225 offset:96
    ds_read_b64_tr_b16 v[106:107], v225 offset:1376
    ds_read_b64_tr_b16 v[108:109], v225 offset:128
    ds_read_b64_tr_b16 v[110:111], v225 offset:1408
    ds_read_b64_tr_b16 v[112:113], v225 offset:5760
    ds_read_b64_tr_b16 v[114:115], v225 offset:7040
    ds_read_b64_tr_b16 v[116:117], v225 offset:5792
    ds_read_b64_tr_b16 v[118:119], v225 offset:7072
    ds_read_b64_tr_b16 v[120:121], v225 offset:5824
    ds_read_b64_tr_b16 v[122:123], v225 offset:7104
    ds_read_b64_tr_b16 v[124:125], v225 offset:5856
    ds_read_b64_tr_b16 v[126:127], v225 offset:7136
    ds_read_b64_tr_b16 v[128:129], v225 offset:5888
    ds_read_b64_tr_b16 v[130:131], v225 offset:7168
    ds_read_b64_tr_b16 v[132:133], v225 offset:11520
    ds_read_b64_tr_b16 v[134:135], v225 offset:12800
    ds_read_b64_tr_b16 v[136:137], v225 offset:11552
    ds_read_b64_tr_b16 v[138:139], v225 offset:12832
    ds_read_b64_tr_b16 v[140:141], v225 offset:11584
    ds_read_b64_tr_b16 v[142:143], v225 offset:12864
    ds_read_b64_tr_b16 v[144:145], v225 offset:11616
    ds_read_b64_tr_b16 v[146:147], v225 offset:12896
    ds_read_b64_tr_b16 v[148:149], v225 offset:11648
    ds_read_b64_tr_b16 v[150:151], v225 offset:12928
    ds_read_b64_tr_b16 v[152:153], v225 offset:17280
    ds_read_b64_tr_b16 v[154:155], v225 offset:18560
    ds_read_b64_tr_b16 v[156:157], v225 offset:17312
    ds_read_b64_tr_b16 v[158:159], v225 offset:18592
    ds_read_b64_tr_b16 v[160:161], v225 offset:17344
    ds_read_b64_tr_b16 v[162:163], v225 offset:18624
    ds_read_b64_tr_b16 v[164:165], v225 offset:17376
    ds_read_b64_tr_b16 v[166:167], v225 offset:18656
    ds_read_b64_tr_b16 v[168:169], v225 offset:17408
    ds_read_b64_tr_b16 v[170:171], v225 offset:18688
    ds_read_b64_tr_b16 v[172:173], v226 offset:0
    ds_read_b64_tr_b16 v[174:175], v226 offset:1280
    ds_read_b64_tr_b16 v[176:177], v226 offset:32
    ds_read_b64_tr_b16 v[178:179], v226 offset:1312
    ds_read_b64_tr_b16 v[180:181], v226 offset:64
    ds_read_b64_tr_b16 v[182:183], v226 offset:1344
    ds_read_b64_tr_b16 v[184:185], v226 offset:96
    ds_read_b64_tr_b16 v[186:187], v226 offset:1376
    ds_read_b64_tr_b16 v[188:189], v226 offset:128
    ds_read_b64_tr_b16 v[190:191], v226 offset:1408
    ds_read_b64_tr_b16 v[192:193], v226 offset:5760
    ds_read_b64_tr_b16 v[194:195], v226 offset:7040
    ds_read_b64_tr_b16 v[196:197], v226 offset:5792
    ds_read_b64_tr_b16 v[198:199], v226 offset:7072
    ds_read_b64_tr_b16 v[200:201], v226 offset:5824
    ds_read_b64_tr_b16 v[202:203], v226 offset:7104
    ds_read_b64_tr_b16 v[204:205], v226 offset:5856
    ds_read_b64_tr_b16 v[206:207], v226 offset:7136
    ds_read_b64_tr_b16 v[208:209], v226 offset:5888
    ds_read_b64_tr_b16 v[210:211], v226 offset:7168
    ds_read_b64_tr_b16 v[212:213], v226 offset:11520
    ds_read_b64_tr_b16 v[214:215], v226 offset:12800
    ds_read_b64_tr_b16 v[216:217], v226 offset:11552
    ds_read_b64_tr_b16 v[218:219], v226 offset:12832
    ds_read_b64_tr_b16 v[220:221], v226 offset:11584
    ds_read_b64_tr_b16 v[222:223], v226 offset:12864
    s_waitcnt lgkmcnt(0)
    v_bfe_u32 v241, v250, 2, 3
    v_lshlrev_b32 v241, 10, v241
    v_and_b32 v252, 3, v250
    v_lshl_add_u32 v241, v252, 2, v241
    s_add_u32 s79, s95, 656368
    v_mov_b32 v252, 163584
    s_mov_b32 s72, 0
LW_19:
    ds_read_b32 v253, v252 offset:36
    s_waitcnt lgkmcnt(0)
    v_readfirstlane_b32 s77, v253
    s_add_u32 s72, s72, 1
    s_cmp_ge_u32 s77, 4
    s_cbranch_scc1 LWD_20
    s_sleep 2
    s_cmp_lt_u32 s72, 524288
    s_cbranch_scc1 LW_19
LWD_20:
    s_mov_b32 s72, 0
    s_add_u32 s77, s74, 0
    buffer_load_dwordx4 v[20:23], v246, s[52:55], s77 offen sc1
    s_add_u32 s77, s74, 4096
    buffer_load_dwordx4 v[24:27], v246, s[52:55], s77 offen sc1
    s_add_u32 s77, s74, 8192
    buffer_load_dwordx4 v[28:31], v246, s[52:55], s77 offen sc1
    s_add_u32 s77, s74, 12288
    buffer_load_dwordx4 v[32:35], v246, s[52:55], s77 offen sc1
    s_add_u32 s77, s75, 0
    buffer_load_dwordx4 v[36:39], v246, s[52:55], s77 offen sc1
    s_add_u32 s77, s75, 4096
    buffer_load_dwordx4 v[40:43], v246, s[52:55], s77 offen sc1
    s_add_u32 s77, s75, 8192
    buffer_load_dwordx4 v[44:47], v246, s[52:55], s77 offen sc1
    s_add_u32 s77, s75, 12288
    buffer_load_dwordx4 v[48:51], v246, s[52:55], s77 offen sc1
    s_add_u32 s77, s76, 0
    buffer_load_dwordx4 v[52:55], v246, s[52:55], s77 offen sc1
    s_add_u32 s77, s76, 4096
    buffer_load_dwordx4 v[56:59], v246, s[52:55], s77 offen sc1
    s_add_u32 s77, s76, 8192
    buffer_load_dwordx4 v[60:63], v246, s[52:55], s77 offen sc1
    s_add_u32 s77, s76, 12288
    buffer_load_dwordx4 v[64:67], v246, s[52:55], s77 offen sc1
    s_add_u32 s77, s97, 0
    buffer_load_dwordx4 v[68:71], v246, s[52:55], s77 offen sc1
    s_add_u32 s77, s97, 4096
    buffer_load_dwordx4 v[72:75], v246, s[52:55], s77 offen sc1
    s_add_u32 s77, s97, 8192
    buffer_load_dwordx4 v[76:79], v246, s[52:55], s77 offen sc1
    s_add_u32 s77, s97, 12288
    buffer_load_dwordx4 v[80:83], v246, s[52:55], s77 offen sc1
    s_mov_b32 s77, 0
    buffer_load_dwordx4 v[84:87], v247, s[52:55], s77 offen sc1
    s_mov_b32 s77, 4096
    buffer_load_dwordx4 v[88:91], v247, s[52:55], s77 offen sc1
    s_waitcnt vmcnt(17)
    v_max3_u32 v252, v20, v21, v22
    v_max_u32 v252, v252, v23
    v_cmp_eq_u32 vcc, -1, v252
    s_nop 4
    s_cbranch_vccnz L_OS_0
L_OR_0:
    v_mfma_f32_16x16x32_bf16 v[0:3], v[92:95], v[20:23], v[0:3]
    s_waitcnt vmcnt(16)
    v_max3_u32 v252, v24, v25, v26
    v_mfma_f32_16x16x32_bf16 v[4:7], v[96:99], v[20:23], v[4:7]
    ds_read_b64_tr_b16 v[92:93], v226 offset:11616
    ds_read_b64_tr_b16 v[94:95], v226 offset:12896
    v_max_u32 v252, v252, v27
    v_mfma_f32_16x16x32_bf16 v[8:11], v[100:103], v[20:23], v[8:11]
    ds_read_b64_tr_b16 v[96:97], v226 offset:11648
    ds_read_b64_tr_b16 v[98:99], v226 offset:12928
    v_cmp_eq_u32 vcc, -1, v252
    v_mfma_f32_16x16x32_bf16 v[12:15], v[104:107], v[20:23], v[12:15]
    ds_read_b64_tr_b16 v[100:101], v226 offset:17280
    ds_read_b64_tr_b16 v[102:103], v226 offset:18560
    v_mfma_f32_16x16x32_bf16 v[16:19], v[108:111], v[20:23], v[16:19]
    ds_read_b64_tr_b16 v[104:105], v226 offset:17312
    ds_read_b64_tr_b16 v[106:107], v226 offset:18592
    s_cbranch_vccnz L_OS_1
L_OR_1:
    v_mfma_f32_16x16x32_bf16 v[0:3], v[112:115], v[24:27], v[0:3]
    ds_read_b64_tr_b16 v[108:109], v226 offset:17344
    ds_read_b64_tr_b16 v[110:111], v226 offset:18624
    s_waitcnt vmcnt(15)
    v_max3_u32 v252, v28, v29, v30
    v_mfma_f32_16x16x32_bf16 v[4:7], v[116:119], v[24:27], v[4:7]
    ds_read_b64_tr_b16 v[112:113], v226 offset:17376
    ds_read_b64_tr_b16 v[114:115], v226 offset:18656
    v_max_u32 v252, v252, v31
    v_mfma_f32_16x16x32_bf16 v[8:11], v[120:123], v[24:27], v[8:11]
    ds_read_b64_tr_b16 v[116:117], v226 offset:17408
    ds_read_b64_tr_b16 v[118:119], v226 offset:18688
    v_cmp_eq_u32 vcc, -1, v252
    v_mfma_f32_16x16x32_bf16 v[12:15], v[124:127], v[24:27], v[12:15]
    ds_read_b64_tr_b16 v[120:121], v227 offset:0
    ds_read_b64_tr_b16 v[122:123], v227 offset:1280
    v_mfma_f32_16x16x32_bf16 v[16:19], v[128:131], v[24:27], v[16:19]
    ds_read_b64_tr_b16 v[124:125], v227 offset:32
    ds_read_b64_tr_b16 v[126:127], v227 offset:1312
    s_cbranch_vccnz L_OS_2
L_OR_2:
    v_mfma_f32_16x16x32_bf16 v[0:3], v[132:135], v[28:31], v[0:3]
    ds_read_b64_tr_b16 v[128:129], v227 offset:64
    ds_read_b64_tr_b16 v[130:131], v227 offset:1344
    s_waitcnt vmcnt(14)
    v_max3_u32 v252, v32, v33, v34
    v_mfma_f32_16x16x32_bf16 v[4:7], v[136:139], v[28:31], v[4:7]
    ds_read_b64_tr_b16 v[132:133], v227 offset:96
    ds_read_b64_tr_b16 v[134:135], v227 offset:1376
    v_max_u32 v252, v252, v35
    v_mfma_f32_16x16x32_bf16 v[8:11], v[140:143], v[28:31], v[8:11]
    ds_read_b64_tr_b16 v[136:137], v227 offset:128
    ds_read_b64_tr_b16 v[138:139], v227 offset:1408
    v_cmp_eq_u32 vcc, -1, v252
    v_mfma_f32_16x16x32_bf16 v[12:15], v[144:147], v[28:31], v[12:15]
    ds_read_b64_tr_b16 v[140:141], v227 offset:5760
    ds_read_b64_tr_b16 v[142:143], v227 offset:7040
    v_mfma_f32_16x16x32_bf16 v[16:19], v[148:151], v[28:31], v[16:19]
    ds_read_b64_tr_b16 v[144:145], v227 offset:5792
    ds_read_b64_tr_b16 v[146:147], v227 offset:7072
    s_cbranch_vccnz L_OS_3
L_OR_3:
    v_mfma_f32_16x16x32_bf16 v[0:3], v[152:155], v[32:35], v[0:3]
    ds_read_b64_tr_b16 v[148:149], v227 offset:5824
    ds_read_b64_tr_b16 v[150:151], v227 offset:7104
    s_waitcnt vmcnt(13)
    v_max3_u32 v252, v36, v37, v38
    v_mfma_f32_16x16x32_bf16 v[4:7], v[156:159], v[32:35], v[4:7]
    ds_read_b64_tr_b16 v[152:153], v227 offset:5856
    ds_read_b64_tr_b16 v[154:155], v227 offset:7136
    v_max_u32 v252, v252, v39
    v_mfma_f32_16x16x32_bf16 v[8:11], v[160:163], v[32:35], v[8:11]
    ds_read_b64_tr_b16 v[156:157], v227 offset:5888
    ds_read_b64_tr_b16 v[158:159], v227 offset:7168
    v_cmp_eq_u32 vcc, -1, v252
    v_mfma_f32_16x16x32_bf16 v[12:15], v[164:167], v[32:35], v[12:15]
    ds_read_b64_tr_b16 v[160:161], v227 offset:11520
    ds_read_b64_tr_b16 v[162:163], v227 offset:12800
    v_mfma_f32_16x16x32_bf16 v[16:19], v[168:171], v[32:35], v[16:19]
    ds_read_b64_tr_b16 v[164:165], v227 offset:11552
    ds_read_b64_tr_b16 v[166:167], v227 offset:12832
    s_cbranch_vccnz L_OS_4
L_OR_4:
    v_mfma_f32_16x16x32_bf16 v[0:3], v[172:175], v[36:39], v[0:3]
    ds_read_b64_tr_b16 v[168:169], v227 offset:11584
    ds_read_b64_tr_b16 v[170:171], v227 offset:12864
    s_waitcnt vmcnt(12)
    v_max3_u32 v252, v40, v41, v42
    v_mfma_f32_16x16x32_bf16 v[4:7], v[176:179], v[36:39], v[4:7]
    ds_read_b64_tr_b16 v[172:173], v227 offset:11616
    ds_read_b64_tr_b16 v[174:175], v227 offset:12896
    v_max_u32 v252, v252, v43
    v_mfma_f32_16x16x32_bf16 v[8:11], v[180:183], v[36:39], v[8:11]
    ds_read_b64_tr_b16 v[176:177], v227 offset:11648
    ds_read_b64_tr_b16 v[178:179], v227 offset:12928
    v_cmp_eq_u32 vcc, -1, v252
    v_mfma_f32_16x16x32_bf16 v[12:15], v[184:187], v[36:39], v[12:15]
    ds_read_b64_tr_b16 v[180:181], v227 offset:17280
    ds_read_b64_tr_b16 v[182:183], v227 offset:18560
    v_mfma_f32_16x16x32_bf16 v[16:19], v[188:191], v[36:39], v[16:19]
    ds_read_b64_tr_b16 v[184:185], v227 offset:17312
    ds_read_b64_tr_b16 v[186:187], v227 offset:18592
    s_cbranch_vccnz L_OS_5
L_OR_5:
    v_mfma_f32_16x16x32_bf16 v[0:3], v[192:195], v[40:43], v[0:3]
    ds_read_b64_tr_b16 v[188:189], v227 offset:17344
    ds_read_b64_tr_b16 v[190:191], v227 offset:18624
    s_waitcnt vmcnt(11)
    v_max3_u32 v252, v44, v45, v46
    v_mfma_f32_16x16x32_bf16 v[4:7], v[196:199], v[40:43], v[4:7]
    ds_read_b64_tr_b16 v[192:193], v227 offset:17376
    ds_read_b64_tr_b16 v[194:195], v227 offset:18656
    v_max_u32 v252, v252, v47
    v_mfma_f32_16x16x32_bf16 v[8:11], v[200:203], v[40:43], v[8:11]
    ds_read_b64_tr_b16 v[196:197], v227 offset:17408
    ds_read_b64_tr_b16 v[198:199], v227 offset:18688
    v_cmp_eq_u32 vcc, -1, v252
    v_mfma_f32_16x16x32_bf16 v[12:15], v[204:207], v[40:43], v[12:15]
    ds_read_b64_tr_b16 v[200:201], v228 offset:0
    ds_read_b64_tr_b16 v[202:203], v228 offset:1280
    v_mfma_f32_16x16x32_bf16 v[16:19], v[208:211], v[40:43], v[16:19]
    ds_read_b64_tr_b16 v[204:205], v228 offset:32
    ds_read_b64_tr_b16 v[206:207], v228 offset:1312
    s_cbranch_vccnz L_OS_6
L_OR_6:
    v_mfma_f32_16x16x32_bf16 v[0:3], v[212:215], v[44:47], v[0:3]
    ds_read_b64_tr_b16 v[208:209], v228 offset:64
    ds_read_b64_tr_b16 v[210:211], v228 offset:1344
    s_waitcnt vmcnt(10)
    v_max3_u32 v252, v48, v49, v50
    v_mfma_f32_16x16x32_bf16 v[4:7], v[216:219], v[44:47], v[4:7]
    ds_read_b64_tr_b16 v[212:213], v228 offset:96
    ds_read_b64_tr_b16 v[214:215], v228 offset:1376
    v_max_u32 v252, v252, v51
    v_mfma_f32_16x16x32_bf16 v[8:11], v[220:223], v[44:47], v[8:11]
    ds_read_b64_tr_b16 v[216:217], v228 offset:128
    ds_read_b64_tr_b16 v[218:219], v228 offset:1408
    v_cmp_eq_u32 vcc, -1, v252
    s_waitcnt lgkmcnt(15)
    v_mfma_f32_16x16x32_bf16 v[12:15], v[92:95], v[44:47], v[12:15]
    ds_read_b64_tr_b16 v[220:221], v228 offset:5760
    ds_read_b64_tr_b16 v[222:223], v228 offset:7040
    v_mfma_f32_16x16x32_bf16 v[16:19], v[96:99], v[44:47], v[16:19]
    ds_read_b64_tr_b16 v[92:93], v228 offset:5792
    ds_read_b64_tr_b16 v[94:95], v228 offset:7072
    s_cbranch_vccnz L_OS_7
L_OR_7:
    v_mfma_f32_16x16x32_bf16 v[0:3], v[100:103], v[48:51], v[0:3]
    ds_read_b64_tr_b16 v[96:97], v228 offset:5824
    ds_read_b64_tr_b16 v[98:99], v228 offset:7104
    s_waitcnt vmcnt(9)
    v_max3_u32 v252, v52, v53, v54
    v_mfma_f32_16x16x32_bf16 v[4:7], v[104:107], v[48:51], v[4:7]
    ds_read_b64_tr_b16 v[100:101], v228 offset:5856
    ds_read_b64_tr_b16 v[102:103], v228 offset:7136
    v_max_u32 v252, v252, v55
    v_mfma_f32_16x16x32_bf16 v[8:11], v[108:111], v[48:51], v[8:11]
    ds_read_b64_tr_b16 v[104:105], v228 offset:5888
    ds_read_b64_tr_b16 v[106:107], v228 offset:7168
    v_cmp_eq_u32 vcc, -1, v252
    v_mfma_f32_16x16x32_bf16 v[12:15], v[112:115], v[48:51], v[12:15]
    ds_read_b64_tr_b16 v[108:109], v228 offset:11520
    ds_read_b64_tr_b16 v[110:111], v228 offset:12800
    v_mfma_f32_16x16x32_bf16 v[16:19], v[116:119], v[48:51], v[16:19]
    ds_read_b64_tr_b16 v[112:113], v228 offset:11552
    ds_read_b64_tr_b16 v[114:115], v228 offset:12832
    s_cbranch_vccnz L_OS_8
L_OR_8:
    v_mfma_f32_16x16x32_bf16 v[0:3], v[120:123], v[52:55], v[0:3]
    ds_read_b64_tr_b16 v[116:117], v228 offset:11584
    ds_read_b64_tr_b16 v[118:119], v228 offset:12864
    s_waitcnt vmcnt(8)
    v_max3_u32 v252, v56, v57, v58
    v_mfma_f32_16x16x32_bf16 v[4:7], v[124:127], v[52:55], v[4:7]
    ds_read_b64_tr_b16 v[120:121], v228 offset:11616
    ds_read_b64_tr_b16 v[122:123], v228 offset:12896
    v_max_u32 v252, v252, v59
    v_mfma_f32_16x16x32_bf16 v[8:11], v[128:131], v[52:55], v[8:11]
    ds_read_b64_tr_b16 v[124:125], v228 offset:11648
    ds_read_b64_tr_b16 v[126:127], v228 offset:12928
    v_cmp_eq_u32 vcc, -1, v252
    v_mfma_f32_16x16x32_bf16 v[12:15], v[132:135], v[52:55], v[12:15]
    ds_read_b64_tr_b16 v[128:129], v228 offset:17280
    ds_read_b64_tr_b16 v[130:131], v228 offset:18560
    v_mfma_f32_16x16x32_bf16 v[16:19], v[136:139], v[52:55], v[16:19]
    ds_read_b64_tr_b16 v[132:133], v228 offset:17312
    ds_read_b64_tr_b16 v[134:135], v228 offset:18592
    s_cbranch_vccnz L_OS_9
L_OR_9:
    v_mfma_f32_16x16x32_bf16 v[0:3], v[140:143], v[56:59], v[0:3]
    ds_read_b64_tr_b16 v[136:137], v228 offset:17344
    ds_read_b64_tr_b16 v[138:139], v228 offset:18624
    s_waitcnt vmcnt(7)
    v_max3_u32 v252, v60, v61, v62
    v_mfma_f32_16x16x32_bf16 v[4:7], v[144:147], v[56:59], v[4:7]
    ds_read_b64_tr_b16 v[140:141], v228 offset:17376
    ds_read_b64_tr_b16 v[142:143], v228 offset:18656
    v_max_u32 v252, v252, v63
    v_mfma_f32_16x16x32_bf16 v[8:11], v[148:151], v[56:59], v[8:11]
    ds_read_b64_tr_b16 v[144:145], v228 offset:17408
    ds_read_b64_tr_b16 v[146:147], v228 offset:18688
    v_cmp_eq_u32 vcc, -1, v252
    v_mfma_f32_16x16x32_bf16 v[12:15], v[152:155], v[56:59], v[12:15]
    ds_read_b64_tr_b16 v[148:149], v251 offset:0
    ds_read_b64_tr_b16 v[150:151], v251 offset:5760
    v_mfma_f32_16x16x32_bf16 v[16:19], v[156:159], v[56:59], v[16:19]
    ds_read_b64_tr_b16 v[152:153], v251 offset:32
    ds_read_b64_tr_b16 v[154:155], v251 offset:5792
    s_cbranch_vccnz L_OS_10
L_OR_10:
    v_mfma_f32_16x16x32_bf16 v[0:3], v[160:163], v[60:63], v[0:3]
    ds_read_b64_tr_b16 v[156:157], v251 offset:64
    ds_read_b64_tr_b16 v[158:159], v251 offset:5824
    s_waitcnt vmcnt(6)
    v_max3_u32 v252, v64, v65, v66
    v_mfma_f32_16x16x32_bf16 v[4:7], v[164:167], v[60:63], v[4:7]
    ds_read_b64_tr_b16 v[160:161], v251 offset:96
    ds_read_b64_tr_b16 v[162:163], v251 offset:5856
    v_max_u32 v252, v252, v67
    v_mfma_f32_16x16x32_bf16 v[8:11], v[168:171], v[60:63], v[8:11]
    ds_read_b64_tr_b16 v[164:165], v251 offset:128
    ds_read_b64_tr_b16 v[166:167], v251 offset:5888
    v_cmp_eq_u32 vcc, -1, v252
    v_mfma_f32_16x16x32_bf16 v[12:15], v[172:175], v[60:63], v[12:15]
    ds_read_b64_tr_b16 v[168:169], v251 offset:46080
    ds_read_b64_tr_b16 v[170:171], v251 offset:51840
    v_mfma_f32_16x16x32_bf16 v[16:19], v[176:179], v[60:63], v[16:19]
    ds_read_b64_tr_b16 v[172:173], v251 offset:46112
    ds_read_b64_tr_b16 v[174:175], v251 offset:51872
    s_cbranch_vccnz L_OS_11
L_OR_11:
    v_mfma_f32_16x16x32_bf16 v[0:3], v[180:183], v[64:67], v[0:3]
    ds_read_b64_tr_b16 v[176:177], v251 offset:46144
    ds_read_b64_tr_b16 v[178:179], v251 offset:51904
    s_waitcnt vmcnt(5)
    v_max3_u32 v252, v68, v69, v70
    v_mfma_f32_16x16x32_bf16 v[4:7], v[184:187], v[64:67], v[4:7]
    ds_read_b64_tr_b16 v[180:181], v251 offset:46176
    ds_read_b64_tr_b16 v[182:183], v251 offset:51936
    v_max_u32 v252, v252, v71
    s_waitcnt lgkmcnt(15)
    v_mfma_f32_16x16x32_bf16 v[8:11], v[188:191], v[64:67], v[8:11]
    ds_read_b64_tr_b16 v[184:185], v251 offset:46208
    ds_read_b64_tr_b16 v[186:187], v251 offset:51968
    v_cmp_eq_u32 vcc, -1, v252
    v_mfma_f32_16x16x32_bf16 v[12:15], v[192:195], v[64:67], v[12:15]
    v_mfma_f32_16x16x32_bf16 v[16:19], v[196:199], v[64:67], v[16:19]
    s_cbranch_vccnz L_OS_12
L_OR_12:
    v_mfma_f32_16x16x32_bf16 v[0:3], v[200:203], v[68:71], v[0:3]
    s_waitcnt vmcnt(4)
    v_max3_u32 v252, v72, v73, v74
    v_mfma_f32_16x16x32_bf16 v[4:7], v[204:207], v[68:71], v[4:7]
    v_max_u32 v252, v252, v75
    v_mfma_f32_16x16x32_bf16 v[8:11], v[208:211], v[68:71], v[8:11]
    v_cmp_eq_u32 vcc, -1, v252
    v_mfma_f32_16x16x32_bf16 v[12:15], v[212:215], v[68:71], v[12:15]
    v_mfma_f32_16x16x32_bf16 v[16:19], v[216:219], v[68:71], v[16:19]
    s_cbranch_vccnz L_OS_13
L_OR_13:
    v_mfma_f32_16x16x32_bf16 v[0:3], v[220:223], v[72:75], v[0:3]
    s_waitcnt vmcnt(3)
    v_max3_u32 v252, v76, v77, v78
    v_mfma_f32_16x16x32_bf16 v[4:7], v[92:95], v[72:75], v[4:7]
    v_max_u32 v252, v252, v79
    v_mfma_f32_16x16x32_bf16 v[8:11], v[96:99], v[72:75], v[8:11]
    v_cmp_eq_u32 vcc, -1, v252
    v_mfma_f32_16x16x32_bf16 v[12:15], v[100:103], v[72:75], v[12:15]
    v_mfma_f32_16x16x32_bf16 v[16:19], v[104:107], v[72:75], v[16:19]
    s_cbranch_vccnz L_OS_14
L_OR_14:
    v_mfma_f32_16x16x32_bf16 v[0:3], v[108:111], v[76:79], v[0:3]
    s_waitcnt vmcnt(2)
    v_max3_u32 v252, v80, v81, v82
    v_mfma_f32_16x16x32_bf16 v[4:7], v[112:115], v[76:79], v[4:7]
    v_max_u32 v252, v252, v83
    v_mfma_f32_16x16x32_bf16 v[8:11], v[116:119], v[76:79], v[8:11]
    v_cmp_eq_u32 vcc, -1, v252
    v_mfma_f32_16x16x32_bf16 v[12:15], v[120:123], v[76:79], v[12:15]
    v_mfma_f32_16x16x32_bf16 v[16:19], v[124:127], v[76:79], v[16:19]
    s_cbranch_vccnz L_OS_15
L_OR_15:
    v_mfma_f32_16x16x32_bf16 v[0:3], v[128:131], v[80:83], v[0:3]
    s_waitcnt vmcnt(1)
    v_max3_u32 v252, v84, v85, v86
    v_mfma_f32_16x16x32_bf16 v[4:7], v[132:135], v[80:83], v[4:7]
    v_max_u32 v252, v252, v87
    v_mfma_f32_16x16x32_bf16 v[8:11], v[136:139], v[80:83], v[8:11]
    v_cmp_eq_u32 vcc, -1, v252
    v_mfma_f32_16x16x32_bf16 v[12:15], v[140:143], v[80:83], v[12:15]
    v_mfma_f32_16x16x32_bf16 v[16:19], v[144:147], v[80:83], v[16:19]
    s_cbranch_vccnz L_OS_16
L_OR_16:
    v_mfma_f32_16x16x32_bf16 v[0:3], v[148:151], v[84:87], v[0:3]
    s_waitcnt vmcnt(0)
    v_max3_u32 v252, v88, v89, v90
    s_waitcnt lgkmcnt(15)
    v_mfma_f32_16x16x32_bf16 v[4:7], v[152:155], v[84:87], v[4:7]
    v_max_u32 v252, v252, v91
    s_waitcnt lgkmcnt(14)
    v_mfma_f32_16x16x32_bf16 v[8:11], v[156:159], v[84:87], v[8:11]
    v_cmp_eq_u32 vcc, -1, v252
    s_waitcnt lgkmcnt(12)
    v_mfma_f32_16x16x32_bf16 v[12:15], v[160:163], v[84:87], v[12:15]
    s_waitcnt lgkmcnt(10)
    v_mfma_f32_16x16x32_bf16 v[16:19], v[164:167], v[84:87], v[16:19]
    s_cbranch_vccnz L_OS_17
L_OR_17:
    s_waitcnt lgkmcnt(8)
    v_mfma_f32_16x16x32_bf16 v[0:3], v[168:171], v[88:91], v[0:3]
    s_waitcnt lgkmcnt(6)
    v_mfma_f32_16x16x32_bf16 v[4:7], v[172:175], v[88:91], v[4:7]
    s_waitcnt lgkmcnt(4)
    v_mfma_f32_16x16x32_bf16 v[8:11], v[176:179], v[88:91], v[8:11]
    s_waitcnt lgkmcnt(2)
    v_mfma_f32_16x16x32_bf16 v[12:15], v[180:183], v[88:91], v[12:15]
    s_waitcnt lgkmcnt(0)
    v_mfma_f32_16x16x32_bf16 v[16:19], v[184:187], v[88:91], v[16:19]
    s_nop 7
    v_cvt_pk_bf16_f32 v20, v0, v1
    v_cvt_pk_bf16_f32 v21, v2, v3
    v_cvt_pk_bf16_f32 v22, v4, v5
    v_cvt_pk_bf16_f32 v23, v6, v7
    v_cvt_pk_bf16_f32 v24, v8, v9
    v_cvt_pk_bf16_f32 v25, v10, v11
    v_cvt_pk_bf16_f32 v26, v12, v13
    v_cvt_pk_bf16_f32 v27, v14, v15
    v_cvt_pk_bf16_f32 v28, v16, v17
    v_cvt_pk_bf16_f32 v29, v18, v19
    v_permlane16_swap_b32 v20, v22
    v_permlane16_swap_b32 v21, v23
    v_permlane16_swap_b32 v24, v26
    v_permlane16_swap_b32 v25, v27
    buffer_store_dwordx4 v[20:23], v244, s[60:63], 0 offen nt
    buffer_store_dwordx4 v[24:27], v244, s[60:63], 0 offen offset:64 nt
    buffer_store_dwordx2 v[28:29], v245, s[60:63], 0 offen offset:128 nt
    s_branch L_FIN
L_OS_0:
    s_add_u32 s77, s74, 0
    buffer_load_dwordx4 v[20:23], v246, s[52:55], s77 offen sc1
    s_add_u32 s77, s74, 4096
    buffer_load_dwordx4 v[24:27], v246, s[52:55], s77 offen sc1
    s_add_u32 s77, s74, 8192
    buffer_load_dwordx4 v[28:31], v246, s[52:55], s77 offen sc1
    s_add_u32 s77, s74, 12288
    buffer_load_dwordx4 v[32:35], v246, s[52:55], s77 offen sc1
    s_add_u32 s77, s75, 0
    buffer_load_dwordx4 v[36:39], v246, s[52:55], s77 offen sc1
    s_add_u32 s77, s75, 4096
    buffer_load_dwordx4 v[40:43], v246, s[52:55], s77 offen sc1
    s_add_u32 s77, s75, 8192
    buffer_load_dwordx4 v[44:47], v246, s[52:55], s77 offen sc1
    s_add_u32 s77, s75, 12288
    buffer_load_dwordx4 v[48:51], v246, s[52:55], s77 offen sc1
    s_add_u32 s77, s76, 0
    buffer_load_dwordx4 v[52:55], v246, s[52:55], s77 offen sc1
    s_add_u32 s77, s76, 4096
    buffer_load_dwordx4 v[56:59], v246, s[52:55], s77 offen sc1
    s_add_u32 s77, s76, 8192
    buffer_load_dwordx4 v[60:63], v246, s[52:55], s77 offen sc1
    s_add_u32 s77, s76, 12288
    buffer_load_dwordx4 v[64:67], v246, s[52:55], s77 offen sc1
    s_add_u32 s77, s97, 0
    buffer_load_dwordx4 v[68:71], v246, s[52:55], s77 offen sc1
    s_add_u32 s77, s97, 4096
    buffer_load_dwordx4 v[72:75], v246, s[52:55], s77 offen sc1
    s_add_u32 s77, s97, 8192
    buffer_load_dwordx4 v[76:79], v246, s[52:55], s77 offen sc1
    s_add_u32 s77, s97, 12288
    buffer_load_dwordx4 v[80:83], v246, s[52:55], s77 offen sc1
    s_mov_b32 s77, 0
    buffer_load_dwordx4 v[84:87], v247, s[52:55], s77 offen sc1
    s_mov_b32 s77, 4096
    buffer_load_dwordx4 v[88:91], v247, s[52:55], s77 offen sc1
    s_add_u32 s72, s72, 1
    s_waitcnt vmcnt(17)
    v_max3_u32 v252, v20, v21, v22
    v_max_u32 v252, v252, v23
    v_cmp_eq_u32 vcc, -1, v252
    s_cmp_ge_u32 s72, 524288
    s_nop 3
    s_cbranch_scc1 L_OR_0
    s_cbranch_vccnz L_OS_0
    s_branch L_OR_0
L_OS_1:
    s_add_u32 s77, s74, 4096
    buffer_load_dwordx4 v[24:27], v246, s[52:55], s77 offen sc1
    s_add_u32 s77, s74, 8192
    buffer_load_dwordx4 v[28:31], v246, s[52:55], s77 offen sc1
    s_add_u32 s77, s74, 12288
    buffer_load_dwordx4 v[32:35], v246, s[52:55], s77 offen sc1
    s_add_u32 s77, s75, 0
    buffer_load_dwordx4 v[36:39], v246, s[52:55], s77 offen sc1
    s_add_u32 s77, s75, 4096
    buffer_load_dwordx4 v[40:43], v246, s[52:55], s77 offen sc1
    s_add_u32 s77, s75, 8192
    buffer_load_dwordx4 v[44:47], v246, s[52:55], s77 offen sc1
    s_add_u32 s77, s75, 12288
    buffer_load_dwordx4 v[48:51], v246, s[52:55], s77 offen sc1
    s_add_u32 s77, s76, 0
    buffer_load_dwordx4 v[52:55], v246, s[52:55], s77 offen sc1
    s_add_u32 s77, s76, 4096
    buffer_load_dwordx4 v[56:59], v246, s[52:55], s77 offen sc1
    s_add_u32 s77, s76, 8192
    buffer_load_dwordx4 v[60:63], v246, s[52:55], s77 offen sc1
    s_add_u32 s77, s76, 12288
    buffer_load_dwordx4 v[64:67], v246, s[52:55], s77 offen sc1
    s_add_u32 s77, s97, 0
    buffer_load_dwordx4 v[68:71], v246, s[52:55], s77 offen sc1
    s_add_u32 s77, s97, 4096
    buffer_load_dwordx4 v[72:75], v246, s[52:55], s77 offen sc1
    s_add_u32 s77, s97, 8192
    buffer_load_dwordx4 v[76:79], v246, s[52:55], s77 offen sc1
    s_add_u32 s77, s97, 12288
    buffer_load_dwordx4 v[80:83], v246, s[52:55], s77 offen sc1
    s_mov_b32 s77, 0
    buffer_load_dwordx4 v[84:87], v247, s[52:55], s77 offen sc1
    s_mov_b32 s77, 4096
    buffer_load_dwordx4 v[88:91], v247, s[52:55], s77 offen sc1
    s_add_u32 s72, s72, 1
    s_waitcnt vmcnt(16)
    v_max3_u32 v252, v24, v25, v26
    v_max_u32 v252, v252, v27
    v_cmp_eq_u32 vcc, -1, v252
    s_cmp_ge_u32 s72, 524288
    s_nop 3
    s_cbranch_scc1 L_OR_1
    s_cbranch_vccnz L_OS_1
    s_branch L_OR_1
L_OS_2:
    s_add_u32 s77, s74, 8192
    buffer_load_dwordx4 v[28:31], v246, s[52:55], s77 offen sc1
    s_add_u32 s77, s74, 12288
    buffer_load_dwordx4 v[32:35], v246, s[52:55], s77 offen sc1
    s_add_u32 s77, s75, 0
    buffer_load_dwordx4 v[36:39], v246, s[52:55], s77 offen sc1
    s_add_u32 s77, s75, 4096
    buffer_load_dwordx4 v[40:43], v246, s[52:55], s77 offen sc1
    s_add_u32 s77, s75, 8192
    buffer_load_dwordx4 v[44:47], v246, s[52:55], s77 offen sc1
    s_add_u32 s77, s75, 12288
    buffer_load_dwordx4 v[48:51], v246, s[52:55], s77 offen sc1
    s_add_u32 s77, s76, 0
    buffer_load_dwordx4 v[52:55], v246, s[52:55], s77 offen sc1
    s_add_u32 s77, s76, 4096
    buffer_load_dwordx4 v[56:59], v246, s[52:55], s77 offen sc1
    s_add_u32 s77, s76, 8192
    buffer_load_dwordx4 v[60:63], v246, s[52:55], s77 offen sc1
    s_add_u32 s77, s76, 12288
    buffer_load_dwordx4 v[64:67], v246, s[52:55], s77 offen sc1
    s_add_u32 s77, s97, 0
    buffer_load_dwordx4 v[68:71], v246, s[52:55], s77 offen sc1
    s_add_u32 s77, s97, 4096
    buffer_load_dwordx4 v[72:75], v246, s[52:55], s77 offen sc1
    s_add_u32 s77, s97, 8192
    buffer_load_dwordx4 v[76:79], v246, s[52:55], s77 offen sc1
    s_add_u32 s77, s97, 12288
    buffer_load_dwordx4 v[80:83], v246, s[52:55], s77 offen sc1
    s_mov_b32 s77, 0
    buffer_load_dwordx4 v[84:87], v247, s[52:55], s77 offen sc1
    s_mov_b32 s77, 4096
    buffer_load_dwordx4 v[88:91], v247, s[52:55], s77 offen sc1
    s_add_u32 s72, s72, 1
    s_waitcnt vmcnt(15)
    v_max3_u32 v252, v28, v29, v30
    v_max_u32 v252, v252, v31
    v_cmp_eq_u32 vcc, -1, v252
    s_cmp_ge_u32 s72, 524288
    s_nop 3
    s_cbranch_scc1 L_OR_2
    s_cbranch_vccnz L_OS_2
    s_branch L_OR_2
L_OS_3:
    s_add_u32 s77, s74, 12288
    buffer_load_dwordx4 v[32:35], v246, s[52:55], s77 offen sc1
    s_add_u32 s77, s75, 0
    buffer_load_dwordx4 v[36:39], v246, s[52:55], s77 offen sc1
    s_add_u32 s77, s75, 4096
    buffer_load_dwordx4 v[40:43], v246, s[52:55], s77 offen sc1
    s_add_u32 s77, s75, 8192
    buffer_load_dwordx4 v[44:47], v246, s[52:55], s77 offen sc1
    s_add_u32 s77, s75, 12288
    buffer_load_dwordx4 v[48:51], v246, s[52:55], s77 offen sc1
    s_add_u32 s77, s76, 0
    buffer_load_dwordx4 v[52:55], v246, s[52:55], s77 offen sc1
    s_add_u32 s77, s76, 4096
    buffer_load_dwordx4 v[56:59], v246, s[52:55], s77 offen sc1
    s_add_u32 s77, s76, 8192
    buffer_load_dwordx4 v[60:63], v246, s[52:55], s77 offen sc1
    s_add_u32 s77, s76, 12288
    buffer_load_dwordx4 v[64:67], v246, s[52:55], s77 offen sc1
    s_add_u32 s77, s97, 0
    buffer_load_dwordx4 v[68:71], v246, s[52:55], s77 offen sc1
    s_add_u32 s77, s97, 4096
    buffer_load_dwordx4 v[72:75], v246, s[52:55], s77 offen sc1
    s_add_u32 s77, s97, 8192
    buffer_load_dwordx4 v[76:79], v246, s[52:55], s77 offen sc1
    s_add_u32 s77, s97, 12288
    buffer_load_dwordx4 v[80:83], v246, s[52:55], s77 offen sc1
    s_mov_b32 s77, 0
    buffer_load_dwordx4 v[84:87], v247, s[52:55], s77 offen sc1
    s_mov_b32 s77, 4096
    buffer_load_dwordx4 v[88:91], v247, s[52:55], s77 offen sc1
    s_add_u32 s72, s72, 1
    s_waitcnt vmcnt(14)
    v_max3_u32 v252, v32, v33, v34
    v_max_u32 v252, v252, v35
    v_cmp_eq_u32 vcc, -1, v252
    s_cmp_ge_u32 s72, 524288
    s_nop 3
    s_cbranch_scc1 L_OR_3
    s_cbranch_vccnz L_OS_3
    s_branch L_OR_3
L_OS_4:
    s_add_u32 s77, s75, 0
    buffer_load_dwordx4 v[36:39], v246, s[52:55], s77 offen sc1
    s_add_u32 s77, s75, 4096
    buffer_load_dwordx4 v[40:43], v246, s[52:55], s77 offen sc1
    s_add_u32 s77, s75, 8192
    buffer_load_dwordx4 v[44:47], v246, s[52:55], s77 offen sc1
    s_add_u32 s77, s75, 12288
    buffer_load_dwordx4 v[48:51], v246, s[52:55], s77 offen sc1
    s_add_u32 s77, s76, 0
    buffer_load_dwordx4 v[52:55], v246, s[52:55], s77 offen sc1
    s_add_u32 s77, s76, 4096
    buffer_load_dwordx4 v[56:59], v246, s[52:55], s77 offen sc1
    s_add_u32 s77, s76, 8192
    buffer_load_dwordx4 v[60:63], v246, s[52:55], s77 offen sc1
    s_add_u32 s77, s76, 12288
    buffer_load_dwordx4 v[64:67], v246, s[52:55], s77 offen sc1
    s_add_u32 s77, s97, 0
    buffer_load_dwordx4 v[68:71], v246, s[52:55], s77 offen sc1
    s_add_u32 s77, s97, 4096
    buffer_load_dwordx4 v[72:75], v246, s[52:55], s77 offen sc1
    s_add_u32 s77, s97, 8192
    buffer_load_dwordx4 v[76:79], v246, s[52:55], s77 offen sc1
    s_add_u32 s77, s97, 12288
    buffer_load_dwordx4 v[80:83], v246, s[52:55], s77 offen sc1
    s_mov_b32 s77, 0
    buffer_load_dwordx4 v[84:87], v247, s[52:55], s77 offen sc1
    s_mov_b32 s77, 4096
    buffer_load_dwordx4 v[88:91], v247, s[52:55], s77 offen sc1
    s_add_u32 s72, s72, 1
    s_waitcnt vmcnt(13)
    v_max3_u32 v252, v36, v37, v38
    v_max_u32 v252, v252, v39
    v_cmp_eq_u32 vcc, -1, v252
    s_cmp_ge_u32 s72, 524288
    s_nop 3
    s_cbranch_scc1 L_OR_4
    s_cbranch_vccnz L_OS_4
    s_branch L_OR_4
L_OS_5:
    s_add_u32 s77, s75, 4096
    buffer_load_dwordx4 v[40:43], v246, s[52:55], s77 offen sc1
    s_add_u32 s77, s75, 8192
    buffer_load_dwordx4 v[44:47], v246, s[52:55], s77 offen sc1
    s_add_u32 s77, s75, 12288
    buffer_load_dwordx4 v[48:51], v246, s[52:55], s77 offen sc1
    s_add_u32 s77, s76, 0
    buffer_load_dwordx4 v[52:55], v246, s[52:55], s77 offen sc1
    s_add_u32 s77, s76, 4096
    buffer_load_dwordx4 v[56:59], v246, s[52:55], s77 offen sc1
    s_add_u32 s77, s76, 8192
    buffer_load_dwordx4 v[60:63], v246, s[52:55], s77 offen sc1
    s_add_u32 s77, s76, 12288
    buffer_load_dwordx4 v[64:67], v246, s[52:55], s77 offen sc1
    s_add_u32 s77, s97, 0
    buffer_load_dwordx4 v[68:71], v246, s[52:55], s77 offen sc1
    s_add_u32 s77, s97, 4096
    buffer_load_dwordx4 v[72:75], v246, s[52:55], s77 offen sc1
    s_add_u32 s77, s97, 8192
    buffer_load_dwordx4 v[76:79], v246, s[52:55], s77 offen sc1
    s_add_u32 s77, s97, 12288
    buffer_load_dwordx4 v[80:83], v246, s[52:55], s77 offen sc1
    s_mov_b32 s77, 0
    buffer_load_dwordx4 v[84:87], v247, s[52:55], s77 offen sc1
    s_mov_b32 s77, 4096
    buffer_load_dwordx4 v[88:91], v247, s[52:55], s77 offen sc1
    s_add_u32 s72, s72, 1
    s_waitcnt vmcnt(12)
    v_max3_u32 v252, v40, v41, v42
    v_max_u32 v252, v252, v43
    v_cmp_eq_u32 vcc, -1, v252
    s_cmp_ge_u32 s72, 524288
    s_nop 3
    s_cbranch_scc1 L_OR_5
    s_cbranch_vccnz L_OS_5
    s_branch L_OR_5
L_OS_6:
    s_add_u32 s77, s75, 8192
    buffer_load_dwordx4 v[44:47], v246, s[52:55], s77 offen sc1
    s_add_u32 s77, s75, 12288
    buffer_load_dwordx4 v[48:51], v246, s[52:55], s77 offen sc1
    s_add_u32 s77, s76, 0
    buffer_load_dwordx4 v[52:55], v246, s[52:55], s77 offen sc1
    s_add_u32 s77, s76, 4096
    buffer_load_dwordx4 v[56:59], v246, s[52:55], s77 offen sc1
    s_add_u32 s77, s76, 8192
    buffer_load_dwordx4 v[60:63], v246, s[52:55], s77 offen sc1
    s_add_u32 s77, s76, 12288
    buffer_load_dwordx4 v[64:67], v246, s[52:55], s77 offen sc1
    s_add_u32 s77, s97, 0
    buffer_load_dwordx4 v[68:71], v246, s[52:55], s77 offen sc1
    s_add_u32 s77, s97, 4096
    buffer_load_dwordx4 v[72:75], v246, s[52:55], s77 offen sc1
    s_add_u32 s77, s97, 8192
    buffer_load_dwordx4 v[76:79], v246, s[52:55], s77 offen sc1
    s_add_u32 s77, s97, 12288
    buffer_load_dwordx4 v[80:83], v246, s[52:55], s77 offen sc1
    s_mov_b32 s77, 0
    buffer_load_dwordx4 v[84:87], v247, s[52:55], s77 offen sc1
    s_mov_b32 s77, 4096
    buffer_load_dwordx4 v[88:91], v247, s[52:55], s77 offen sc1
    s_add_u32 s72, s72, 1
    s_waitcnt vmcnt(11)
    v_max3_u32 v252, v44, v45, v46
    v_max_u32 v252, v252, v47
    v_cmp_eq_u32 vcc, -1, v252
    s_cmp_ge_u32 s72, 524288
    s_nop 3
    s_cbranch_scc1 L_OR_6
    s_cbranch_vccnz L_OS_6
    s_branch L_OR_6
L_OS_7:
    s_add_u32 s77, s75, 12288
    buffer_load_dwordx4 v[48:51], v246, s[52:55], s77 offen sc1
    s_add_u32 s77, s76, 0
    buffer_load_dwordx4 v[52:55], v246, s[52:55], s77 offen sc1
    s_add_u32 s77, s76, 4096
    buffer_load_dwordx4 v[56:59], v246, s[52:55], s77 offen sc1
    s_add_u32 s77, s76, 8192
    buffer_load_dwordx4 v[60:63], v246, s[52:55], s77 offen sc1
    s_add_u32 s77, s76, 12288
    buffer_load_dwordx4 v[64:67], v246, s[52:55], s77 offen sc1
    s_add_u32 s77, s97, 0
    buffer_load_dwordx4 v[68:71], v246, s[52:55], s77 offen sc1
    s_add_u32 s77, s97, 4096
    buffer_load_dwordx4 v[72:75], v246, s[52:55], s77 offen sc1
    s_add_u32 s77, s97, 8192
    buffer_load_dwordx4 v[76:79], v246, s[52:55], s77 offen sc1
    s_add_u32 s77, s97, 12288
    buffer_load_dwordx4 v[80:83], v246, s[52:55], s77 offen sc1
    s_mov_b32 s77, 0
    buffer_load_dwordx4 v[84:87], v247, s[52:55], s77 offen sc1
    s_mov_b32 s77, 4096
    buffer_load_dwordx4 v[88:91], v247, s[52:55], s77 offen sc1
    s_add_u32 s72, s72, 1
    s_waitcnt vmcnt(10)
    v_max3_u32 v252, v48, v49, v50
    v_max_u32 v252, v252, v51
    v_cmp_eq_u32 vcc, -1, v252
    s_cmp_ge_u32 s72, 524288
    s_nop 3
    s_cbranch_scc1 L_OR_7
    s_cbranch_vccnz L_OS_7
    s_branch L_OR_7
L_OS_8:
    s_add_u32 s77, s76, 0
    buffer_load_dwordx4 v[52:55], v246, s[52:55], s77 offen sc1
    s_add_u32 s77, s76, 4096
    buffer_load_dwordx4 v[56:59], v246, s[52:55], s77 offen sc1
    s_add_u32 s77, s76, 8192
    buffer_load_dwordx4 v[60:63], v246, s[52:55], s77 offen sc1
    s_add_u32 s77, s76, 12288
    buffer_load_dwordx4 v[64:67], v246, s[52:55], s77 offen sc1
    s_add_u32 s77, s97, 0
    buffer_load_dwordx4 v[68:71], v246, s[52:55], s77 offen sc1
    s_add_u32 s77, s97, 4096
    buffer_load_dwordx4 v[72:75], v246, s[52:55], s77 offen sc1
    s_add_u32 s77, s97, 8192
    buffer_load_dwordx4 v[76:79], v246, s[52:55], s77 offen sc1
    s_add_u32 s77, s97, 12288
    buffer_load_dwordx4 v[80:83], v246, s[52:55], s77 offen sc1
    s_mov_b32 s77, 0
    buffer_load_dwordx4 v[84:87], v247, s[52:55], s77 offen sc1
    s_mov_b32 s77, 4096
    buffer_load_dwordx4 v[88:91], v247, s[52:55], s77 offen sc1
    s_add_u32 s72, s72, 1
    s_waitcnt vmcnt(9)
    v_max3_u32 v252, v52, v53, v54
    v_max_u32 v252, v252, v55
    v_cmp_eq_u32 vcc, -1, v252
    s_cmp_ge_u32 s72, 524288
    s_nop 3
    s_cbranch_scc1 L_OR_8
    s_cbranch_vccnz L_OS_8
    s_branch L_OR_8
L_OS_9:
    s_add_u32 s77, s76, 4096
    buffer_load_dwordx4 v[56:59], v246, s[52:55], s77 offen sc1
    s_add_u32 s77, s76, 8192
    buffer_load_dwordx4 v[60:63], v246, s[52:55], s77 offen sc1
    s_add_u32 s77, s76, 12288
    buffer_load_dwordx4 v[64:67], v246, s[52:55], s77 offen sc1
    s_add_u32 s77, s97, 0
    buffer_load_dwordx4 v[68:71], v246, s[52:55], s77 offen sc1
    s_add_u32 s77, s97, 4096
    buffer_load_dwordx4 v[72:75], v246, s[52:55], s77 offen sc1
    s_add_u32 s77, s97, 8192
    buffer_load_dwordx4 v[76:79], v246, s[52:55], s77 offen sc1
    s_add_u32 s77, s97, 12288
    buffer_load_dwordx4 v[80:83], v246, s[52:55], s77 offen sc1
    s_mov_b32 s77, 0
    buffer_load_dwordx4 v[84:87], v247, s[52:55], s77 offen sc1
    s_mov_b32 s77, 4096
    buffer_load_dwordx4 v[88:91], v247, s[52:55], s77 offen sc1
    s_add_u32 s72, s72, 1
    s_waitcnt vmcnt(8)
    v_max3_u32 v252, v56, v57, v58
    v_max_u32 v252, v252, v59
    v_cmp_eq_u32 vcc, -1, v252
    s_cmp_ge_u32 s72, 524288
    s_nop 3
    s_cbranch_scc1 L_OR_9
    s_cbranch_vccnz L_OS_9
    s_branch L_OR_9
L_OS_10:
    s_add_u32 s77, s76, 8192
    buffer_load_dwordx4 v[60:63], v246, s[52:55], s77 offen sc1
    s_add_u32 s77, s76, 12288
    buffer_load_dwordx4 v[64:67], v246, s[52:55], s77 offen sc1
    s_add_u32 s77, s97, 0
    buffer_load_dwordx4 v[68:71], v246, s[52:55], s77 offen sc1
    s_add_u32 s77, s97, 4096
    buffer_load_dwordx4 v[72:75], v246, s[52:55], s77 offen sc1
    s_add_u32 s77, s97, 8192
    buffer_load_dwordx4 v[76:79], v246, s[52:55], s77 offen sc1
    s_add_u32 s77, s97, 12288
    buffer_load_dwordx4 v[80:83], v246, s[52:55], s77 offen sc1
    s_mov_b32 s77, 0
    buffer_load_dwordx4 v[84:87], v247, s[52:55], s77 offen sc1
    s_mov_b32 s77, 4096
    buffer_load_dwordx4 v[88:91], v247, s[52:55], s77 offen sc1
    s_add_u32 s72, s72, 1
    s_waitcnt vmcnt(7)
    v_max3_u32 v252, v60, v61, v62
    v_max_u32 v252, v252, v63
    v_cmp_eq_u32 vcc, -1, v252
    s_cmp_ge_u32 s72, 524288
    s_nop 3
    s_cbranch_scc1 L_OR_10
    s_cbranch_vccnz L_OS_10
    s_branch L_OR_10
L_OS_11:
    s_add_u32 s77, s76, 12288
    buffer_load_dwordx4 v[64:67], v246, s[52:55], s77 offen sc1
    s_add_u32 s77, s97, 0
    buffer_load_dwordx4 v[68:71], v246, s[52:55], s77 offen sc1
    s_add_u32 s77, s97, 4096
    buffer_load_dwordx4 v[72:75], v246, s[52:55], s77 offen sc1
    s_add_u32 s77, s97, 8192
    buffer_load_dwordx4 v[76:79], v246, s[52:55], s77 offen sc1
    s_add_u32 s77, s97, 12288
    buffer_load_dwordx4 v[80:83], v246, s[52:55], s77 offen sc1
    s_mov_b32 s77, 0
    buffer_load_dwordx4 v[84:87], v247, s[52:55], s77 offen sc1
    s_mov_b32 s77, 4096
    buffer_load_dwordx4 v[88:91], v247, s[52:55], s77 offen sc1
    s_add_u32 s72, s72, 1
    s_waitcnt vmcnt(6)
    v_max3_u32 v252, v64, v65, v66
    v_max_u32 v252, v252, v67
    v_cmp_eq_u32 vcc, -1, v252
    s_cmp_ge_u32 s72, 524288
    s_nop 3
    s_cbranch_scc1 L_OR_11
    s_cbranch_vccnz L_OS_11
    s_branch L_OR_11
L_OS_12:
    s_add_u32 s77, s97, 0
    buffer_load_dwordx4 v[68:71], v246, s[52:55], s77 offen sc1
    s_add_u32 s77, s97, 4096
    buffer_load_dwordx4 v[72:75], v246, s[52:55], s77 offen sc1
    s_add_u32 s77, s97, 8192
    buffer_load_dwordx4 v[76:79], v246, s[52:55], s77 offen sc1
    s_add_u32 s77, s97, 12288
    buffer_load_dwordx4 v[80:83], v246, s[52:55], s77 offen sc1
    s_mov_b32 s77, 0
    buffer_load_dwordx4 v[84:87], v247, s[52:55], s77 offen sc1
    s_mov_b32 s77, 4096
    buffer_load_dwordx4 v[88:91], v247, s[52:55], s77 offen sc1
    s_add_u32 s72, s72, 1
    s_waitcnt vmcnt(5)
    v_max3_u32 v252, v68, v69, v70
    v_max_u32 v252, v252, v71
    v_cmp_eq_u32 vcc, -1, v252
    s_cmp_ge_u32 s72, 524288
    s_nop 3
    s_cbranch_scc1 L_OR_12
    s_cbranch_vccnz L_OS_12
    s_branch L_OR_12
L_OS_13:
    s_add_u32 s77, s97, 4096
    buffer_load_dwordx4 v[72:75], v246, s[52:55], s77 offen sc1
    s_add_u32 s77, s97, 8192
    buffer_load_dwordx4 v[76:79], v246, s[52:55], s77 offen sc1
    s_add_u32 s77, s97, 12288
    buffer_load_dwordx4 v[80:83], v246, s[52:55], s77 offen sc1
    s_mov_b32 s77, 0
    buffer_load_dwordx4 v[84:87], v247, s[52:55], s77 offen sc1
    s_mov_b32 s77, 4096
    buffer_load_dwordx4 v[88:91], v247, s[52:55], s77 offen sc1
    s_add_u32 s72, s72, 1
    s_waitcnt vmcnt(4)
    v_max3_u32 v252, v72, v73, v74
    v_max_u32 v252, v252, v75
    v_cmp_eq_u32 vcc, -1, v252
    s_cmp_ge_u32 s72, 524288
    s_nop 3
    s_cbranch_scc1 L_OR_13
    s_cbranch_vccnz L_OS_13
    s_branch L_OR_13
L_OS_14:
    s_add_u32 s77, s97, 8192
    buffer_load_dwordx4 v[76:79], v246, s[52:55], s77 offen sc1
    s_add_u32 s77, s97, 12288
    buffer_load_dwordx4 v[80:83], v246, s[52:55], s77 offen sc1
    s_mov_b32 s77, 0
    buffer_load_dwordx4 v[84:87], v247, s[52:55], s77 offen sc1
    s_mov_b32 s77, 4096
    buffer_load_dwordx4 v[88:91], v247, s[52:55], s77 offen sc1
    s_add_u32 s72, s72, 1
    s_waitcnt vmcnt(3)
    v_max3_u32 v252, v76, v77, v78
    v_max_u32 v252, v252, v79
    v_cmp_eq_u32 vcc, -1, v252
    s_cmp_ge_u32 s72, 524288
    s_nop 3
    s_cbranch_scc1 L_OR_14
    s_cbranch_vccnz L_OS_14
    s_branch L_OR_14
L_OS_15:
    s_add_u32 s77, s97, 12288
    buffer_load_dwordx4 v[80:83], v246, s[52:55], s77 offen sc1
    s_mov_b32 s77, 0
    buffer_load_dwordx4 v[84:87], v247, s[52:55], s77 offen sc1
    s_mov_b32 s77, 4096
    buffer_load_dwordx4 v[88:91], v247, s[52:55], s77 offen sc1
    s_add_u32 s72, s72, 1
    s_waitcnt vmcnt(2)
    v_max3_u32 v252, v80, v81, v82
    v_max_u32 v252, v252, v83
    v_cmp_eq_u32 vcc, -1, v252
    s_cmp_ge_u32 s72, 524288
    s_nop 3
    s_cbranch_scc1 L_OR_15
    s_cbranch_vccnz L_OS_15
    s_branch L_OR_15
L_OS_16:
    s_mov_b32 s77, 0
    buffer_load_dwordx4 v[84:87], v247, s[52:55], s77 offen sc1
    s_mov_b32 s77, 4096
    buffer_load_dwordx4 v[88:91], v247, s[52:55], s77 offen sc1
    s_add_u32 s72, s72, 1
    s_waitcnt vmcnt(1)
    v_max3_u32 v252, v84, v85, v86
    v_max_u32 v252, v252, v87
    v_cmp_eq_u32 vcc, -1, v252
    s_cmp_ge_u32 s72, 524288
    s_nop 3
    s_cbranch_scc1 L_OR_16
    s_cbranch_vccnz L_OS_16
    s_branch L_OR_16
L_OS_17:
    s_mov_b32 s77, 4096
    buffer_load_dwordx4 v[88:91], v247, s[52:55], s77 offen sc1
    s_add_u32 s72, s72, 1
    s_waitcnt vmcnt(0)
    v_max3_u32 v252, v88, v89, v90
    v_max_u32 v252, v252, v91
    v_cmp_eq_u32 vcc, -1, v252
    s_cmp_ge_u32 s72, 524288
    s_nop 3
    s_cbranch_scc1 L_OR_17
    s_cbranch_vccnz L_OS_17
    s_branch L_OR_17
L_ATT:
    s_waitcnt lgkmcnt(0)
    s_barrier
    s_setprio 2
    v_mov_b32 v246, 0
    buffer_load_dwordx2 v[248:249], v246, s[56:59], 0 offen sc1
    v_and_b32 v200, 15, v250
    v_lshrrev_b32 v201, 4, v250
    v_bfe_u32 v202, v250, 2, 2
    v_and_b32 v203, 3, v250
    v_lshl_add_u32 v204, v201, 3, v202
    v_lshlrev_b32 v204, 4, v204
    v_and_b32 v205, 1, v203
    v_lshl_add_u32 v204, v205, 3, v204
    v_add_u32 v216, 136320, v204
    v_add_u32 v204, 145600, v204
    v_cmp_gt_u32 vcc, 2, v203
    s_nop 1
    v_cndmask_b32 v204, v204, v216, vcc
    v_mul_u32_u24 v205, 1040, v201
    v_lshl_add_u32 v205, v200, 4, v205
    v_add_u32 v206, 37440, v205
    s_lshl_b32 s77, s67, 8
    v_add_u32 v207, s77, v205
    v_add_u32 v208, s77, v206
    s_waitcnt vmcnt(0) lgkmcnt(0)
    v_mov_b32 v246, 163584
    v_mov_b32 v247, 1
    s_mov_b64 exec, 1
    ds_add_u32 v246, v247 offset:48
    s_mov_b64 exec, -1
    v_mov_b32 v246, 163584
    s_mov_b32 s72, 0
LW_21:
    ds_read_b32 v247, v246 offset:48
    s_waitcnt lgkmcnt(0)
    v_readfirstlane_b32 s77, v247
    s_add_u32 s72, s72, 1
    s_cmp_ge_u32 s77, 4
    s_cbranch_scc1 LWD_22
    s_sleep 1
    s_cmp_lt_u32 s72, 524288
    s_cbranch_scc1 LW_21
LWD_22:
    ds_read_b64_tr_b16 v[0:1], v204 offset:0
    ds_read_b64_tr_b16 v[2:3], v204 offset:64
    ds_read_b128 v[4:7], v207 offset:0
    ds_read_b64_tr_b16 v[8:9], v204 offset:512
    ds_read_b64_tr_b16 v[10:11], v204 offset:576
    ds_read_b128 v[12:15], v207 offset:4160
    ds_read_b64_tr_b16 v[16:17], v204 offset:1024
    ds_read_b64_tr_b16 v[18:19], v204 offset:1088
    ds_read_b128 v[20:23], v207 offset:8320
    ds_read_b64_tr_b16 v[24:25], v204 offset:1536
    ds_read_b64_tr_b16 v[26:27], v204 offset:1600
    ds_read_b128 v[28:31], v207 offset:12480
    ds_read_b64_tr_b16 v[32:33], v204 offset:2048
    ds_read_b64_tr_b16 v[34:35], v204 offset:2112
    ds_read_b128 v[36:39], v207 offset:16640
    s_waitcnt lgkmcnt(12)
    v_mfma_f32_16x16x32_bf16 v[144:147], v[0:3], v[4:7], 0
    v_mfma_f32_16x16x32_bf16 v[148:151], v[4:7], v[0:3], 0
    ds_read_b64_tr_b16 v[40:41], v204 offset:2560
    ds_read_b64_tr_b16 v[42:43], v204 offset:2624
    ds_read_b128 v[44:47], v207 offset:20800
    s_waitcnt lgkmcnt(12)
    v_mfma_f32_16x16x32_bf16 v[144:147], v[8:11], v[12:15], v[144:147]
    v_mfma_f32_16x16x32_bf16 v[148:151], v[12:15], v[8:11], v[148:151]
    ds_read_b64_tr_b16 v[48:49], v204 offset:3072
    ds_read_b64_tr_b16 v[50:51], v204 offset:3136
    ds_read_b128 v[52:55], v207 offset:24960
    s_waitcnt lgkmcnt(12)
    v_mfma_f32_16x16x32_bf16 v[144:147], v[16:19], v[20:23], v[144:147]
    v_mfma_f32_16x16x32_bf16 v[148:151], v[20:23], v[16:19], v[148:151]
    ds_read_b64_tr_b16 v[56:57], v204 offset:3584
    ds_read_b64_tr_b16 v[58:59], v204 offset:3648
    ds_read_b128 v[60:63], v207 offset:29120
    s_waitcnt lgkmcnt(12)
    v_mfma_f32_16x16x32_bf16 v[144:147], v[24:27], v[28:31], v[144:147]
    v_mfma_f32_16x16x32_bf16 v[148:151], v[28:31], v[24:27], v[148:151]
    ds_read_b64_tr_b16 v[64:65], v204 offset:4096
    ds_read_b64_tr_b16 v[66:67], v204 offset:4160
    ds_read_b128 v[68:71], v207 offset:33280
    s_waitcnt lgkmcnt(12)
    v_mfma_f32_16x16x32_bf16 v[144:147], v[32:35], v[36:39], v[144:147]
    v_mfma_f32_16x16x32_bf16 v[148:151], v[36:39], v[32:35], v[148:151]
    ds_read_b64_tr_b16 v[72:73], v204 offset:4608
    ds_read_b64_tr_b16 v[74:75], v204 offset:4672
    ds_read_b128 v[76:79], v208 offset:0
    s_waitcnt lgkmcnt(12)
    v_mfma_f32_16x16x32_bf16 v[144:147], v[40:43], v[44:47], v[144:147]
    v_mfma_f32_16x16x32_bf16 v[148:151], v[44:47], v[40:43], v[148:151]
    ds_read_b64_tr_b16 v[80:81], v204 offset:5120
    ds_read_b64_tr_b16 v[82:83], v204 offset:5184
    ds_read_b128 v[84:87], v208 offset:4160
    s_waitcnt lgkmcnt(12)
    v_mfma_f32_16x16x32_bf16 v[144:147], v[48:51], v[52:55], v[144:147]
    v_mfma_f32_16x16x32_bf16 v[148:151], v[52:55], v[48:51], v[148:151]
    ds_read_b64_tr_b16 v[88:89], v204 offset:5632
    ds_read_b64_tr_b16 v[90:91], v204 offset:5696
    ds_read_b128 v[92:95], v208 offset:8320
    s_waitcnt lgkmcnt(12)
    v_mfma_f32_16x16x32_bf16 v[144:147], v[56:59], v[60:63], v[144:147]
    v_mfma_f32_16x16x32_bf16 v[148:151], v[60:63], v[56:59], v[148:151]
    ds_read_b64_tr_b16 v[96:97], v204 offset:6144
    ds_read_b64_tr_b16 v[98:99], v204 offset:6208
    ds_read_b128 v[100:103], v208 offset:12480
    s_waitcnt lgkmcnt(12)
    v_mfma_f32_16x16x32_bf16 v[144:147], v[64:67], v[68:71], v[144:147]
    v_mfma_f32_16x16x32_bf16 v[148:151], v[68:71], v[64:67], v[148:151]
    ds_read_b64_tr_b16 v[104:105], v204 offset:6656
    ds_read_b64_tr_b16 v[106:107], v204 offset:6720
    ds_read_b128 v[108:111], v208 offset:16640
    s_waitcnt lgkmcnt(12)
    v_mfma_f32_16x16x32_bf16 v[144:147], v[72:75], v[76:79], v[144:147]
    v_mfma_f32_16x16x32_bf16 v[148:151], v[76:79], v[72:75], v[148:151]
    ds_read_b64_tr_b16 v[112:113], v204 offset:7168
    ds_read_b64_tr_b16 v[114:115], v204 offset:7232
    ds_read_b128 v[116:119], v208 offset:20800
    s_waitcnt lgkmcnt(12)
    v_mfma_f32_16x16x32_bf16 v[144:147], v[80:83], v[84:87], v[144:147]
    v_mfma_f32_16x16x32_bf16 v[148:151], v[84:87], v[80:83], v[148:151]
    ds_read_b64_tr_b16 v[120:121], v204 offset:7680
    ds_read_b64_tr_b16 v[122:123], v204 offset:7744
    ds_read_b128 v[124:127], v208 offset:24960
    s_waitcnt lgkmcnt(12)
    v_mfma_f32_16x16x32_bf16 v[144:147], v[88:91], v[92:95], v[144:147]
    v_mfma_f32_16x16x32_bf16 v[148:151], v[92:95], v[88:91], v[148:151]
    ds_read_b64_tr_b16 v[128:129], v204 offset:8192
    ds_read_b64_tr_b16 v[130:131], v204 offset:8256
    ds_read_b128 v[132:135], v208 offset:29120
    s_waitcnt lgkmcnt(12)
    v_mfma_f32_16x16x32_bf16 v[144:147], v[96:99], v[100:103], v[144:147]
    v_mfma_f32_16x16x32_bf16 v[148:151], v[100:103], v[96:99], v[148:151]
    ds_read_b64_tr_b16 v[136:137], v204 offset:8704
    ds_read_b64_tr_b16 v[138:139], v204 offset:8768
    ds_read_b128 v[140:143], v208 offset:33280
    s_waitcnt lgkmcnt(12)
    v_mfma_f32_16x16x32_bf16 v[144:147], v[104:107], v[108:111], v[144:147]
    v_mfma_f32_16x16x32_bf16 v[148:151], v[108:111], v[104:107], v[148:151]
    s_waitcnt lgkmcnt(9)
    v_mfma_f32_16x16x32_bf16 v[144:147], v[112:115], v[116:119], v[144:147]
    v_mfma_f32_16x16x32_bf16 v[148:151], v[116:119], v[112:115], v[148:151]
    s_waitcnt lgkmcnt(6)
    v_mfma_f32_16x16x32_bf16 v[144:147], v[120:123], v[124:127], v[144:147]
    v_mfma_f32_16x16x32_bf16 v[148:151], v[124:127], v[120:123], v[148:151]
    s_waitcnt lgkmcnt(3)
    v_mfma_f32_16x16x32_bf16 v[144:147], v[128:131], v[132:135], v[144:147]
    v_mfma_f32_16x16x32_bf16 v[148:151], v[132:135], v[128:131], v[148:151]
    s_waitcnt lgkmcnt(0)
    v_mfma_f32_16x16x32_bf16 v[144:147], v[136:139], v[140:143], v[144:147]
    v_mfma_f32_16x16x32_bf16 v[148:151], v[140:143], v[136:139], v[148:151]
    v_mov_b32 v246, 163584
    v_mov_b32 v247, 1
    s_mov_b64 exec, 1
    ds_add_u32 v246, v247 offset:0
    s_mov_b64 exec, -1
    s_lshr_b32 s79, s67, 1
    s_lshl_b32 s80, s64, 1
    s_add_u32 s79, s79, s80
    s_and_b32 s80, s67, 1
    s_lshl_b32 s81, s80, 4
    v_add_u32 v209, s81, v200
    v_mov_b32 v210, 1073741824
    v_cvt_pk_bf16_f32 v152, v144, v145
    v_cvt_pk_bf16_f32 v153, v146, v147
    v_cvt_pk_bf16_f32 v154, v148, v149
    v_cvt_pk_bf16_f32 v155, v150, v151
    s_cmp_ge_u32 s65, 6
    s_cbranch_scc1 L_KV_D
    s_cmp_ge_u32 s65, 3
    s_cbranch_scc1 L_KV_V
    s_cmp_eq_u32 s65, 2
    s_cbranch_scc1 L_KV_X
    s_mul_i32 s77, s79, 2304
    s_lshl_b32 s78, s65, 9
    s_add_u32 s77, s77, s78
    v_lshlrev_b32 v211, 4, v209
    v_and_b32 v212, 1, v201
    v_lshl_add_u32 v211, v212, 3, v211
    v_cmp_le_u32 vcc, 2, v201
    s_nop 1
    v_cndmask_b32 v211, v210, v211, vcc
    buffer_store_dwordx2 v[152:153], v211, s[52:55], s77 offen sc1
    s_branch L_KV_D
L_KV_X:
    s_mul_i32 s77, s79, 2304
    s_add_u32 s77, s77, 1024
    v_lshlrev_b32 v211, 2, v209
    v_cmp_eq_u32 vcc, 3, v201
    s_nop 1
    v_cndmask_b32 v211, v210, v211, vcc
    buffer_store_dword v153, v211, s[52:55], s77 offen sc1
    s_branch L_KV_D
L_KV_V:
    s_sub_u32 s77, s65, 3
    s_lshl_b32 s77, s77, 3
    s_min_u32 s77, s77, 10
    s_cmp_eq_u32 s65, 5
    s_cselect_b32 s78, 14, 8
    v_add_u32 v211, s77, v200
    v_lshrrev_b32 v212, 1, v201
    v_mul_u32_u24 v212, 18, v212
    v_add_u32 v211, v211, v212
    v_lshlrev_b32 v211, 4, v211
    v_and_b32 v212, 1, v201
    v_lshl_add_u32 v211, v212, 3, v211
    v_cmp_le_u32 vcc, s78, v200
    s_nop 1
    v_cndmask_b32 v211, v210, v211, vcc
    s_mul_i32 s77, s79, 2304
    s_mul_i32 s78, s80, 576
    s_add_u32 s77, s77, s78
    s_add_u32 s77, s77, 1024
    buffer_store_dwordx2 v[154:155], v211, s[52:55], s77 offen sc1
L_KV_D:
    s_mov_b32 s72, 0
L_TAG_P:
    s_waitcnt vmcnt(0)
    v_readfirstlane_b32 s98, v248
    v_readfirstlane_b32 s99, v249
    s_add_u32 s72, s72, 1
    s_sub_u32 s77, s26, s98
    s_add_u32 s77, s77, 100000
    s_cmp_gt_u32 s77, 103000
    s_cselect_b32 s77, 0, s98
    s_cmp_ge_u32 s72, 256
    s_cselect_b32 s77, s98, s77
    s_cmp_lg_u32 s77, 0
    s_cbranch_scc1 L_TAG_Q
    v_mov_b32 v246, 0
    buffer_load_dwordx2 v[248:249], v246, s[56:59], 0 offen sc1
    s_cmp_lt_u32 s72, 524288
    s_cbranch_scc1 L_TAG_P
L_TAG_Q:
    v_mov_b32 v246, 163712
    ds_write_b64 v246, v[248:249]
    s_waitcnt lgkmcnt(0)
    v_mov_b32 v246, 163584
    v_mov_b32 v247, 1
    s_mov_b64 exec, 1
    ds_add_rtn_u32 v247, v246, v247 offset:4
    s_waitcnt lgkmcnt(0)
    v_readfirstlane_b32 s79, v247
    s_mov_b64 exec, -1
    s_nop 0
    s_cmp_lg_u32 s79, 3
    s_cbranch_scc1 L_NOG1
    s_lshl_b32 s78, s65, 3
    s_add_u32 s77, s95, s78
    s_add_u32 s77, s77, 663680
    v_mov_b32 v246, 0
    v_mov_b32 v248, s98
    v_mov_b32 v249, s99
    s_mov_b64 exec, 1
    buffer_store_dwordx2 v[248:249], v246, s[52:55], s77 offen sc1
    s_mov_b64 exec, -1
L_NOG1:
    v_mov_b32 v246, 163584
    v_mov_b32 v247, 1
    s_mov_b64 exec, 1
    ds_add_u32 v246, v247 offset:12
    s_mov_b64 exec, -1
    v_mul_f32 v144, 0x3e274c22, v144
    v_mul_f32 v145, 0x3e274c22, v145
    v_mul_f32 v146, 0x3e274c22, v146
    v_mul_f32 v147, 0x3e274c22, v147
    v_cvt_pk_bf16_f32 v144, v144, v145
    v_cvt_pk_bf16_f32 v145, v146, v147
    s_lshr_b32 s80, s67, 1
    s_mul_i32 s80, s80, 1536
    s_and_b32 s81, s67, 1
    s_lshl_b32 s81, s81, 8
    s_add_u32 s80, s80, s81
    s_add_u32 s80, s80, 136320
    v_lshl_add_u32 v214, v200, 4, s80
    v_lshlrev_b32 v215, 2, v201
    v_add_u32 v212, 64, v215
    v_mul_u32_u24 v213, 3641, v212
    v_lshrrev_b32 v213, 16, v213
    v_mul_u32_u24 v82, 18, v213
    v_sub_u32 v212, v212, v82
    v_mul_u32_u24 v82, 3072, v213
    v_lshrrev_b32 v213, 3, v212
    v_lshl_add_u32 v82, v213, 9, v82
    v_and_b32 v212, 7, v212
    v_lshl_add_u32 v82, v212, 1, v82
    v_add_u32 v82, v214, v82
    v_add_u32 v212, 66, v215
    v_mul_u32_u24 v213, 3641, v212
    v_lshrrev_b32 v213, 16, v213
    v_mul_u32_u24 v83, 18, v213
    v_sub_u32 v212, v212, v83
    v_mul_u32_u24 v83, 3072, v213
    v_lshrrev_b32 v213, 3, v212
    v_lshl_add_u32 v83, v213, 9, v83
    v_and_b32 v212, 7, v212
    v_lshl_add_u32 v83, v212, 1, v83
    v_add_u32 v83, v214, v83
    v_mov_b32 v246, 163584
    s_mov_b32 s72, 0
LW_23:
    ds_read_b32 v247, v246 offset:0
    s_waitcnt lgkmcnt(0)
    v_readfirstlane_b32 s77, v247
    s_add_u32 s72, s72, 1
    s_cmp_ge_u32 s77, 4
    s_cbranch_scc1 LWD_24
    s_sleep 1
    s_cmp_lt_u32 s72, 524288
    s_cbranch_scc1 LW_23
LWD_24:
    s_mov_b32 exec_hi, 0
    ds_write_b32 v82, v144
    ds_write_b32 v83, v145
    s_mov_b64 exec, -1
    s_waitcnt lgkmcnt(0)
    v_mov_b32 v246, 163584
    v_mov_b32 v247, 1
    s_mov_b64 exec, 1
    ds_add_u32 v246, v247 offset:8
    s_mov_b64 exec, -1
    v_mov_b32 v192, 0
    v_mov_b32 v193, 0
    v_mov_b32 v194, 0
    v_mov_b32 v195, 0
    v_mov_b32 v196, 0
    v_mov_b32 v197, 0
    v_mov_b32 v198, 0
    v_mov_b32 v199, 0
    v_mov_b32 v200, 0
    v_mov_b32 v201, 0
    v_mov_b32 v202, 0
    v_mov_b32 v203, 0
    v_mov_b32 v204, 0
    v_mov_b32 v205, 0
    v_mov_b32 v206, 0
    v_mov_b32 v207, 0
    v_mov_b32 v208, 0
    v_mov_b32 v209, 0
    v_mov_b32 v219, 0x3f803f80
    v_mov_b32 v220, 0
    v_mov_b32 v221, 0
    v_mov_b32 v223, 0x3f803f80
    v_mov_b32 v224, 0
    v_mov_b32 v225, 0
    v_and_b32 v246, 31, v250
    v_mov_b32 v247, 0x3f803f80
    v_cmp_eq_u32 vcc, 18, v246
    s_mov_b32 s82, 0x3ffff
    s_mov_b32 s83, 0x3ffff
    v_cndmask_b32 v226, 0, v247, vcc
    v_cndmask_b32 v227, 0, v247, vcc
    v_cndmask_b32 v228, 0, v247, vcc
    v_cndmask_b32 v229, 0, v247, vcc
    v_cndmask_b32 v230, 0, v247, vcc
    v_cndmask_b32 v231, 0, v247, vcc
    v_cndmask_b32 v232, 0, v247, vcc
    v_cndmask_b32 v233, 0, v247, vcc
    v_cndmask_b32 v234, 0, v247, vcc
    v_cndmask_b32 v235, 0, v247, vcc
    v_cndmask_b32 v236, 0, v247, vcc
    v_cndmask_b32 v237, 0, v247, vcc
    v_cndmask_b32 v238, 0, v247, vcc
    v_cndmask_b32 v239, 0, v247, vcc
    v_cndmask_b32 v240, 0, v247, vcc
    v_cndmask_b32 v241, 0, v247, vcc
    v_mov_b32 v242, 0xdddddddd
    s_mul_i32 s79, s67, 17
    s_cmp_eq_u32 s67, 3
    s_cselect_b32 s79, 49, s79
    s_cmp_ge_u32 s67, 2
    s_cselect_b32 s100, 15, 17
    s_lshr_b32 s101, s100, 1
    s_mul_i32 s77, s79, 2304
    s_mul_i32 s75, s100, 2304
    v_lshl_add_u32 v243, v250, 4, s77
    v_lshl_add_u32 v244, v246, 2, s77
    s_nop 0
    v_lshrrev_b32 v245, 5, v250
    v_mul_u32_u24 v245, 18, v245
    v_add_u32 v245, v245, v246
    v_lshl_add_u32 v245, v245, 4, s77
    s_setprio 0
    v_mov_b32 v0, 0
    v_mov_b32 v1, 0
    v_mov_b32 v2, 0
    v_mov_b32 v3, 0
    v_mov_b32 v4, 0
    v_mov_b32 v5, 0
    v_mov_b32 v6, 0
    v_mov_b32 v7, 0
    v_mov_b32 v8, 0
    v_mov_b32 v9, 0
    v_mov_b32 v10, 0
    v_mov_b32 v11, 0
    v_mov_b32 v12, 0
    v_mov_b32 v13, 0
    v_mov_b32 v14, 0
    v_mov_b32 v15, 0
    v_mov_b32 v16, 0
    v_mov_b32 v17, 0
    v_mov_b32 v18, 0
    v_mov_b32 v19, 0
    v_mov_b32 v20, 0
    v_mov_b32 v21, 0
    v_mov_b32 v22, 0
    v_mov_b32 v23, 0
    v_mov_b32 v24, 0
    v_mov_b32 v25, 0
    v_mov_b32 v26, 0
    v_mov_b32 v27, 0
    v_mov_b32 v28, 0
    v_mov_b32 v29, 0
    v_mov_b32 v30, 0
    v_mov_b32 v31, 0
    v_mov_b32 v32, 0
    v_mov_b32 v33, 0
    v_mov_b32 v34, 0
    v_mov_b32 v35, 0
    v_mov_b32 v36, 0
    v_mov_b32 v37, 0
    v_mov_b32 v38, 0
    v_mov_b32 v39, 0
    v_mov_b32 v40, 0
    v_mov_b32 v41, 0
    v_mov_b32 v42, 0
    v_mov_b32 v43, 0
    v_mov_b32 v44, 0
    v_mov_b32 v45, 0
    v_mov_b32 v46, 0
    v_mov_b32 v47, 0
    v_mov_b32 v48, 0
    v_mov_b32 v49, 0
    v_mov_b32 v50, 0
    v_mov_b32 v51, 0
    v_mov_b32 v52, 0
    v_mov_b32 v53, 0
    v_mov_b32 v54, 0
    v_mov_b32 v55, 0
    v_mov_b32 v56, 0
    v_mov_b32 v57, 0
    v_mov_b32 v58, 0
    v_mov_b32 v59, 0
    v_mov_b32 v60, 0
    v_mov_b32 v61, 0
    v_mov_b32 v62, 0
    v_mov_b32 v63, 0
    v_mov_b32 v64, 0
    v_mov_b32 v65, 0
    v_mov_b32 v66, 0
    v_mov_b32 v67, 0
    v_mov_b32 v68, 0
    v_mov_b32 v69, 0
    v_mov_b32 v70, 0
    v_mov_b32 v71, 0
    v_mov_b32 v72, 0
    v_mov_b32 v73, 0
    v_mov_b32 v74, 0
    v_mov_b32 v75, 0
    v_mov_b32 v76, 0
    v_mov_b32 v77, 0
    v_mov_b32 v78, 0
    v_mov_b32 v79, 0
    v_mov_b32 v80, 0
    v_mov_b32 v81, 0
    v_mov_b32 v82, 0
    v_mov_b32 v83, 0
    v_mov_b32 v84, 0
    v_mov_b32 v85, 0
    v_mov_b32 v86, 0
    v_mov_b32 v87, 0
    v_mov_b32 v88, 0
    v_mov_b32 v89, 0
    v_mov_b32 v90, 0
    v_mov_b32 v91, 0
    v_mov_b32 v92, 0
    v_mov_b32 v93, 0
    v_mov_b32 v94, 0
    v_mov_b32 v95, 0
    v_mov_b32 v96, 0
    v_mov_b32 v97, 0
    v_mov_b32 v98, 0
    v_mov_b32 v99, 0
    v_mov_b32 v100, 0
    v_mov_b32 v101, 0
    v_mov_b32 v102, 0
    v_mov_b32 v103, 0
    v_mov_b32 v104, 0
    v_mov_b32 v105, 0
    v_mov_b32 v106, 0
    v_mov_b32 v107, 0
    v_mov_b32 v108, 0
    v_mov_b32 v109, 0
    v_mov_b32 v110, 0
    v_mov_b32 v111, 0
    v_mov_b32 v112, 0
    v_mov_b32 v113, 0
    v_mov_b32 v114, 0
    v_mov_b32 v115, 0
    v_mov_b32 v116, 0
    v_mov_b32 v117, 0
    v_mov_b32 v118, 0
    v_mov_b32 v119, 0
    v_mov_b32 v120, 0
    v_mov_b32 v121, 0
    v_mov_b32 v122, 0
    v_mov_b32 v123, 0
    v_mov_b32 v124, 0
    v_mov_b32 v125, 0
    v_mov_b32 v126, 0
    v_mov_b32 v127, 0
    v_mov_b32 v152, 0
    v_mov_b32 v153, 0
    v_mov_b32 v154, 0
    v_mov_b32 v155, 0
    v_mov_b32 v156, 0
    v_mov_b32 v157, 0
    v_mov_b32 v158, 0
    v_mov_b32 v159, 0
    v_mov_b32 v252, 163584
    s_mov_b32 s72, 0
LW_25:
    ds_read_b32 v253, v252 offset:8
    s_waitcnt lgkmcnt(0)
    v_readfirstlane_b32 s77, v253
    s_add_u32 s72, s72, 1
    s_cmp_ge_u32 s77, 6
    s_cbranch_scc1 LWD_26
    s_sleep 4
    s_cmp_lt_u32 s72, 524288
    s_cbranch_scc1 LW_25
LWD_26:
    s_add_u32 s77, s67, 1
    s_and_b32 s77, s77, 3
    s_mul_i32 s77, s77, 3072
    s_add_u32 s77, s77, 136320
    v_lshl_add_u32 v128, v250, 4, s77
    ds_read_b128 v[160:163], v128 offset:0
    ds_read_b128 v[164:167], v128 offset:1536
    s_add_u32 s77, s67, 2
    s_and_b32 s77, s77, 3
    s_mul_i32 s77, s77, 3072
    s_add_u32 s77, s77, 136320
    v_lshl_add_u32 v129, v250, 4, s77
    ds_read_b128 v[168:171], v129 offset:0
    ds_read_b128 v[172:175], v129 offset:1536
    s_add_u32 s77, s67, 3
    s_and_b32 s77, s77, 3
    s_mul_i32 s77, s77, 3072
    s_add_u32 s77, s77, 136320
    v_lshl_add_u32 v130, v250, 4, s77
    ds_read_b128 v[176:179], v130 offset:0
    ds_read_b128 v[180:183], v130 offset:1536
    s_add_u32 s77, s67, 4
    s_and_b32 s77, s77, 3
    s_mul_i32 s77, s77, 3072
    s_add_u32 s77, s77, 136320
    v_lshl_add_u32 v131, v250, 4, s77
    ds_read_b128 v[184:187], v131 offset:0
    ds_read_b128 v[188:191], v131 offset:1536
    s_mov_b32 exec_hi, 0
    ds_read_b32 v192, v128 offset:1024
    ds_read_b32 v194, v128 offset:2560
    ds_read_b32 v196, v129 offset:1024
    ds_read_b32 v198, v129 offset:2560
    ds_read_b32 v200, v130 offset:1024
    ds_read_b32 v202, v130 offset:2560
    ds_read_b32 v204, v131 offset:1024
    ds_read_b32 v206, v131 offset:2560
    s_mov_b64 exec, -1
    s_waitcnt lgkmcnt(0)
    v_lshrrev_b32 v247, 3, v250
    v_mul_u32_u24 v247, 720896, v247
    v_and_b32 v248, 7, v250
    v_lshl_add_u32 v247, v248, 3, v247
    s_mul_i32 s79, s67, 5767168
    s_add_u32 s79, s79, 925824
    s_mov_b32 s72, 0
FW_27:
    buffer_load_dwordx2 v[248:249], v247, s[52:55], s79 offen sc1
    s_waitcnt vmcnt(0)
    v_xor_b32 v248, s98, v248
    v_xor_b32 v249, s99, v249
    v_or_b32 v248, v248, v249
    v_cmp_ne_u32 vcc, 0, v248
    s_add_u32 s72, s72, 1
    s_nop 3
    s_cbranch_vccz FWD_28
    s_sleep 16
    s_cmp_lt_u32 s72, 524288
    s_cbranch_scc1 FW_27
FWD_28:
    v_mov_b32 v247, 163584
    v_mov_b32 v248, 1
    s_mov_b64 exec, 1
    ds_add_u32 v247, v248 offset:40
    s_mov_b64 exec, -1
    v_mov_b32 v247, 163584
    s_mov_b32 s72, 0
LW_29:
    ds_read_b32 v248, v247 offset:40
    s_waitcnt lgkmcnt(0)
    v_readfirstlane_b32 s77, v248
    s_add_u32 s72, s72, 1
    s_cmp_ge_u32 s77, 4
    s_cbranch_scc1 LWD_30
    s_sleep 1
    s_cmp_lt_u32 s72, 524288
    s_cbranch_scc1 LW_29
LWD_30:
    s_setprio 0
L_PASS:
    s_and_b32 s94, s64, 0
    s_cmp_ge_u32 s94, s100
    s_cselect_b32 s94, 0, s94
    s_mul_i32 s74, s94, 2304
    buffer_load_dwordx4 v[214:217], v243, s[52:55], s74 offen sc1
    buffer_load_dword v222, v244, s[52:55], s74 offen offset:1024 sc1
    s_mov_b64 exec, s[82:83]
    buffer_load_dwordx4 v[234:237], v245, s[52:55], s74 offen offset:1152 sc1
    buffer_load_dwordx4 v[238:241], v245, s[52:55], s74 offen offset:1728 sc1
    s_mov_b64 exec, -1
    s_add_u32 s74, s74, 2304
    buffer_load_dwordx4 v[210:213], v243, s[52:55], s74 offen sc1
    buffer_load_dword v218, v244, s[52:55], s74 offen offset:1024 sc1
    v_and_b32 v251, 31, v250
    v_lshrrev_b32 v246, 5, v250
    s_lshl_b32 s77, s65, 2
    s_add_u32 s77, s77, s67
    s_lshl_b32 s77, s77, 11
    s_add_u32 s77, s77, s95
    s_add_u32 s77, s77, 589824
    v_lshl_add_u32 v249, v251, 4, s77
    v_lshl_add_u32 v249, v246, 10, v249
    s_lshl_b32 s78, s65, 10
    s_add_u32 s77, s95, s78
    s_lshl_b32 s78, s67, 2
    s_add_u32 s77, s77, s78
    s_add_u32 s77, s77, 655360
    v_lshl_add_u32 v251, v251, 4, s77
    s_add_u32 s77, s67, 1
    s_and_b32 s77, s77, 3
    s_mul_i32 s77, s77, 15360
    s_add_u32 s77, s77, 92160
    v_lshl_add_u32 v246, v250, 4, s77
    s_add_u32 s77, s67, 2
    s_and_b32 s77, s77, 3
    s_mul_i32 s77, s77, 15360
    s_add_u32 s77, s77, 97280
    v_lshl_add_u32 v247, v250, 4, s77
    s_add_u32 s77, s67, 3
    s_and_b32 s77, s77, 3
    s_mul_i32 s77, s77, 15360
    s_add_u32 s77, s77, 102400
    v_lshl_add_u32 v248, v250, 4, s77
    s_waitcnt vmcnt(4)
    v_mfma_f32_32x32x16_bf16 v[128:143], v[214:217], v[160:163], 0
    v_mfma_f32_32x32x16_bf16 v[128:143], v[222:225], v[192:195], v[128:143]
    s_mov_b32 s70, s101
    s_nop 10
.p2align 3
L_AT_LOOP:
    v_exp_f32 v128, v128
    v_exp_f32 v129, v129
    v_smfmac_f32_32x32x32_bf16 v[112:127], v[230:233], v[152:159], v242
    s_mov_b64 exec, s[82:83]
    buffer_load_dwordx4 v[226:229], v245, s[52:55], s74 offen offset:1152 sc1
    buffer_load_dwordx4 v[230:233], v245, s[52:55], s74 offen offset:1728 sc1
    s_mov_b64 exec, -1
    s_add_u32 s74, s74, 2304
    v_exp_f32 v130, v130
    v_exp_f32 v131, v131
    v_exp_f32 v132, v132
    v_mfma_f32_32x32x16_bf16 v[144:159], v[214:217], v[164:167], 0
    v_exp_f32 v133, v133
    v_exp_f32 v134, v134
    v_exp_f32 v135, v135
    v_mfma_f32_32x32x16_bf16 v[144:159], v[222:225], v[194:197], v[144:159]
    v_exp_f32 v136, v136
    v_exp_f32 v137, v137
    v_exp_f32 v138, v138
    v_exp_f32 v139, v139
    s_waitcnt vmcnt(4)
    v_smfmac_f32_32x32x32_bf16 v[0:15], v[234:237], v[128:135], v242
    v_exp_f32 v140, v140
    v_exp_f32 v141, v141
    v_exp_f32 v142, v142
    v_exp_f32 v143, v143
    v_exp_f32 v144, v144
    v_exp_f32 v145, v145
    v_smfmac_f32_32x32x32_bf16 v[0:15], v[238:241], v[136:143], v242
    v_exp_f32 v146, v146
    v_exp_f32 v147, v147
    v_exp_f32 v148, v148
    v_mfma_f32_32x32x16_bf16 v[128:143], v[214:217], v[168:171], 0
    v_exp_f32 v149, v149
    v_exp_f32 v150, v150
    v_exp_f32 v151, v151
    v_mfma_f32_32x32x16_bf16 v[128:143], v[222:225], v[196:199], v[128:143]
    v_exp_f32 v152, v152
    v_exp_f32 v153, v153
    v_exp_f32 v154, v154
    v_exp_f32 v155, v155
    v_smfmac_f32_32x32x32_bf16 v[16:31], v[234:237], v[144:151], v242
    v_exp_f32 v156, v156
    v_exp_f32 v157, v157
    v_exp_f32 v158, v158
    v_exp_f32 v159, v159
    v_exp_f32 v128, v128
    v_exp_f32 v129, v129
    v_smfmac_f32_32x32x32_bf16 v[16:31], v[238:241], v[152:159], v242
    v_exp_f32 v130, v130
    v_exp_f32 v131, v131
    v_exp_f32 v132, v132
    v_mfma_f32_32x32x16_bf16 v[144:159], v[214:217], v[172:175], 0
    v_exp_f32 v133, v133
    v_exp_f32 v134, v134
    v_exp_f32 v135, v135
    v_mfma_f32_32x32x16_bf16 v[144:159], v[222:225], v[198:201], v[144:159]
    v_exp_f32 v136, v136
    v_exp_f32 v137, v137
    v_exp_f32 v138, v138
    v_exp_f32 v139, v139
    v_smfmac_f32_32x32x32_bf16 v[32:47], v[234:237], v[128:135], v242
    v_exp_f32 v140, v140
    v_exp_f32 v141, v141
    v_exp_f32 v142, v142
    v_exp_f32 v143, v143
    v_exp_f32 v144, v144
    v_exp_f32 v145, v145
    v_smfmac_f32_32x32x32_bf16 v[32:47], v[238:241], v[136:143], v242
    v_exp_f32 v146, v146
    v_exp_f32 v147, v147
    v_exp_f32 v148, v148
    v_mfma_f32_32x32x16_bf16 v[128:143], v[214:217], v[176:179], 0
    v_exp_f32 v149, v149
    v_exp_f32 v150, v150
    v_exp_f32 v151, v151
    v_mfma_f32_32x32x16_bf16 v[128:143], v[222:225], v[200:203], v[128:143]
    v_exp_f32 v152, v152
    v_exp_f32 v153, v153
    v_exp_f32 v154, v154
    v_exp_f32 v155, v155
    v_smfmac_f32_32x32x32_bf16 v[48:63], v[234:237], v[144:151], v242
    v_exp_f32 v156, v156
    v_exp_f32 v157, v157
    v_exp_f32 v158, v158
    v_exp_f32 v159, v159
    v_exp_f32 v128, v128
    v_exp_f32 v129, v129
    v_smfmac_f32_32x32x32_bf16 v[48:63], v[238:241], v[152:159], v242
    v_exp_f32 v130, v130
    v_exp_f32 v131, v131
    v_exp_f32 v132, v132
    v_mfma_f32_32x32x16_bf16 v[144:159], v[214:217], v[180:183], 0
    v_exp_f32 v133, v133
    v_exp_f32 v134, v134
    v_exp_f32 v135, v135
    v_mfma_f32_32x32x16_bf16 v[144:159], v[222:225], v[202:205], v[144:159]
    v_exp_f32 v136, v136
    v_exp_f32 v137, v137
    v_exp_f32 v138, v138
    v_exp_f32 v139, v139
    v_smfmac_f32_32x32x32_bf16 v[64:79], v[234:237], v[128:135], v242
    v_exp_f32 v140, v140
    v_exp_f32 v141, v141
    v_exp_f32 v142, v142
    v_exp_f32 v143, v143
    v_exp_f32 v144, v144
    v_exp_f32 v145, v145
    v_smfmac_f32_32x32x32_bf16 v[64:79], v[238:241], v[136:143], v242
    v_exp_f32 v146, v146
    v_exp_f32 v147, v147
    v_exp_f32 v148, v148
    v_mfma_f32_32x32x16_bf16 v[128:143], v[214:217], v[184:187], 0
    v_exp_f32 v149, v149
    v_exp_f32 v150, v150
    v_exp_f32 v151, v151
    v_mfma_f32_32x32x16_bf16 v[128:143], v[222:225], v[204:207], v[128:143]
    v_exp_f32 v152, v152
    v_exp_f32 v153, v153
    v_exp_f32 v154, v154
    v_exp_f32 v155, v155
    v_smfmac_f32_32x32x32_bf16 v[80:95], v[234:237], v[144:151], v242
    v_exp_f32 v156, v156
    v_exp_f32 v157, v157
    v_exp_f32 v158, v158
    v_exp_f32 v159, v159
    v_exp_f32 v128, v128
    v_exp_f32 v129, v129
    v_smfmac_f32_32x32x32_bf16 v[80:95], v[238:241], v[152:159], v242
    v_exp_f32 v130, v130
    v_exp_f32 v131, v131
    v_exp_f32 v132, v132
    v_mfma_f32_32x32x16_bf16 v[144:159], v[214:217], v[188:191], 0
    v_exp_f32 v133, v133
    v_exp_f32 v134, v134
    v_exp_f32 v135, v135
    v_mfma_f32_32x32x16_bf16 v[144:159], v[222:225], v[206:209], v[144:159]
    v_exp_f32 v136, v136
    v_exp_f32 v137, v137
    v_exp_f32 v138, v138
    v_exp_f32 v139, v139
    v_smfmac_f32_32x32x32_bf16 v[96:111], v[234:237], v[128:135], v242
    v_exp_f32 v140, v140
    v_exp_f32 v141, v141
    v_exp_f32 v142, v142
    v_exp_f32 v143, v143
    v_exp_f32 v144, v144
    v_exp_f32 v145, v145
    v_smfmac_f32_32x32x32_bf16 v[96:111], v[238:241], v[136:143], v242
    v_exp_f32 v146, v146
    v_exp_f32 v147, v147
    v_exp_f32 v148, v148
    s_waitcnt vmcnt(2)
    v_mfma_f32_32x32x16_bf16 v[128:143], v[210:213], v[160:163], 0
    v_exp_f32 v149, v149
    v_exp_f32 v150, v150
    v_exp_f32 v151, v151
    v_mfma_f32_32x32x16_bf16 v[128:143], v[218:221], v[192:195], v[128:143]
    buffer_load_dwordx4 v[214:217], v243, s[52:55], s74 offen sc1
    buffer_load_dword v222, v244, s[52:55], s74 offen offset:1024 sc1
    v_exp_f32 v152, v152
    v_exp_f32 v153, v153
    v_exp_f32 v154, v154
    v_exp_f32 v155, v155
    v_smfmac_f32_32x32x32_bf16 v[112:127], v[234:237], v[144:151], v242
    v_exp_f32 v156, v156
    v_exp_f32 v157, v157
    v_exp_f32 v158, v158
    v_exp_f32 v159, v159
L_AT_MID:
    v_exp_f32 v128, v128
    v_exp_f32 v129, v129
    v_smfmac_f32_32x32x32_bf16 v[112:127], v[238:241], v[152:159], v242
    s_mov_b64 exec, s[82:83]
    buffer_load_dwordx4 v[234:237], v245, s[52:55], s74 offen offset:1152 sc1
    buffer_load_dwordx4 v[238:241], v245, s[52:55], s74 offen offset:1728 sc1
    s_mov_b64 exec, -1
    s_add_u32 s74, s74, 2304
    v_exp_f32 v130, v130
    v_exp_f32 v131, v131
    v_exp_f32 v132, v132
    v_mfma_f32_32x32x16_bf16 v[144:159], v[210:213], v[164:167], 0
    v_exp_f32 v133, v133
    v_exp_f32 v134, v134
    v_exp_f32 v135, v135
    v_mfma_f32_32x32x16_bf16 v[144:159], v[218:221], v[194:197], v[144:159]
    v_exp_f32 v136, v136
    v_exp_f32 v137, v137
    v_exp_f32 v138, v138
    v_exp_f32 v139, v139
    s_waitcnt vmcnt(4)
    v_smfmac_f32_32x32x32_bf16 v[0:15], v[226:229], v[128:135], v242
    v_exp_f32 v140, v140
    v_exp_f32 v141, v141
    v_exp_f32 v142, v142
    v_exp_f32 v143, v143
    v_exp_f32 v144, v144
    v_exp_f32 v145, v145
    v_smfmac_f32_32x32x32_bf16 v[0:15], v[230:233], v[136:143], v242
    v_exp_f32 v146, v146
    v_exp_f32 v147, v147
    v_exp_f32 v148, v148
    v_mfma_f32_32x32x16_bf16 v[128:143], v[210:213], v[168:171], 0
    v_exp_f32 v149, v149
    v_exp_f32 v150, v150
    v_exp_f32 v151, v151
    v_mfma_f32_32x32x16_bf16 v[128:143], v[218:221], v[196:199], v[128:143]
    v_exp_f32 v152, v152
    v_exp_f32 v153, v153
    v_exp_f32 v154, v154
    v_exp_f32 v155, v155
    v_smfmac_f32_32x32x32_bf16 v[16:31], v[226:229], v[144:151], v242
    v_exp_f32 v156, v156
    v_exp_f32 v157, v157
    v_exp_f32 v158, v158
    v_exp_f32 v159, v159
    v_exp_f32 v128, v128
    v_exp_f32 v129, v129
    v_smfmac_f32_32x32x32_bf16 v[16:31], v[230:233], v[152:159], v242
    v_exp_f32 v130, v130
    v_exp_f32 v131, v131
    v_exp_f32 v132, v132
    v_mfma_f32_32x32x16_bf16 v[144:159], v[210:213], v[172:175], 0
    v_exp_f32 v133, v133
    v_exp_f32 v134, v134
    v_exp_f32 v135, v135
    v_mfma_f32_32x32x16_bf16 v[144:159], v[218:221], v[198:201], v[144:159]
    v_exp_f32 v136, v136
    v_exp_f32 v137, v137
    v_exp_f32 v138, v138
    v_exp_f32 v139, v139
    v_smfmac_f32_32x32x32_bf16 v[32:47], v[226:229], v[128:135], v242
    v_exp_f32 v140, v140
    v_exp_f32 v141, v141
    v_exp_f32 v142, v142
    v_exp_f32 v143, v143
    v_exp_f32 v144, v144
    v_exp_f32 v145, v145
    v_smfmac_f32_32x32x32_bf16 v[32:47], v[230:233], v[136:143], v242
    v_exp_f32 v146, v146
    v_exp_f32 v147, v147
    v_exp_f32 v148, v148
    v_mfma_f32_32x32x16_bf16 v[128:143], v[210:213], v[176:179], 0
    v_exp_f32 v149, v149
    v_exp_f32 v150, v150
    v_exp_f32 v151, v151
    v_mfma_f32_32x32x16_bf16 v[128:143], v[218:221], v[200:203], v[128:143]
    v_exp_f32 v152, v152
    v_exp_f32 v153, v153
    v_exp_f32 v154, v154
    v_exp_f32 v155, v155
    v_smfmac_f32_32x32x32_bf16 v[48:63], v[226:229], v[144:151], v242
    v_exp_f32 v156, v156
    v_exp_f32 v157, v157
    v_exp_f32 v158, v158
    v_exp_f32 v159, v159
    v_exp_f32 v128, v128
    v_exp_f32 v129, v129
    v_smfmac_f32_32x32x32_bf16 v[48:63], v[230:233], v[152:159], v242
    v_exp_f32 v130, v130
    v_exp_f32 v131, v131
    v_exp_f32 v132, v132
    v_mfma_f32_32x32x16_bf16 v[144:159], v[210:213], v[180:183], 0
    v_exp_f32 v133, v133
    v_exp_f32 v134, v134
    v_exp_f32 v135, v135
    v_mfma_f32_32x32x16_bf16 v[144:159], v[218:221], v[202:205], v[144:159]
    v_exp_f32 v136, v136
    v_exp_f32 v137, v137
    v_exp_f32 v138, v138
    v_exp_f32 v139, v139
    v_smfmac_f32_32x32x32_bf16 v[64:79], v[226:229], v[128:135], v242
    v_exp_f32 v140, v140
    v_exp_f32 v141, v141
    v_exp_f32 v142, v142
    v_exp_f32 v143, v143
    v_exp_f32 v144, v144
    v_exp_f32 v145, v145
    v_smfmac_f32_32x32x32_bf16 v[64:79], v[230:233], v[136:143], v242
    v_exp_f32 v146, v146
    v_exp_f32 v147, v147
    v_exp_f32 v148, v148
    v_mfma_f32_32x32x16_bf16 v[128:143], v[210:213], v[184:187], 0
    v_exp_f32 v149, v149
    v_exp_f32 v150, v150
    v_exp_f32 v151, v151
    v_mfma_f32_32x32x16_bf16 v[128:143], v[218:221], v[204:207], v[128:143]
    v_exp_f32 v152, v152
    v_exp_f32 v153, v153
    v_exp_f32 v154, v154
    v_exp_f32 v155, v155
    v_smfmac_f32_32x32x32_bf16 v[80:95], v[226:229], v[144:151], v242
    v_exp_f32 v156, v156
    v_exp_f32 v157, v157
    v_exp_f32 v158, v158
    v_exp_f32 v159, v159
    v_exp_f32 v128, v128
    v_exp_f32 v129, v129
    v_smfmac_f32_32x32x32_bf16 v[80:95], v[230:233], v[152:159], v242
    v_exp_f32 v130, v130
    v_exp_f32 v131, v131
    v_exp_f32 v132, v132
    v_mfma_f32_32x32x16_bf16 v[144:159], v[210:213], v[188:191], 0
    v_exp_f32 v133, v133
    v_exp_f32 v134, v134
    v_exp_f32 v135, v135
    v_mfma_f32_32x32x16_bf16 v[144:159], v[218:221], v[206:209], v[144:159]
    v_exp_f32 v136, v136
    v_exp_f32 v137, v137
    v_exp_f32 v138, v138
    v_exp_f32 v139, v139
    v_smfmac_f32_32x32x32_bf16 v[96:111], v[226:229], v[128:135], v242
    v_exp_f32 v140, v140
    v_exp_f32 v141, v141
    v_exp_f32 v142, v142
    v_exp_f32 v143, v143
    v_exp_f32 v144, v144
    v_exp_f32 v145, v145
    v_smfmac_f32_32x32x32_bf16 v[96:111], v[230:233], v[136:143], v242
    v_exp_f32 v146, v146
    v_exp_f32 v147, v147
    v_exp_f32 v148, v148
    s_waitcnt vmcnt(2)
    v_mfma_f32_32x32x16_bf16 v[128:143], v[214:217], v[160:163], 0
    v_exp_f32 v149, v149
    v_exp_f32 v150, v150
    v_exp_f32 v151, v151
    v_mfma_f32_32x32x16_bf16 v[128:143], v[222:225], v[192:195], v[128:143]
    buffer_load_dwordx4 v[210:213], v243, s[52:55], s74 offen sc1
    buffer_load_dword v218, v244, s[52:55], s74 offen offset:1024 sc1
    v_exp_f32 v152, v152
    v_exp_f32 v153, v153
    v_exp_f32 v154, v154
    v_exp_f32 v155, v155
    v_smfmac_f32_32x32x32_bf16 v[112:127], v[226:229], v[144:151], v242
    v_exp_f32 v156, v156
    v_exp_f32 v157, v157
    v_exp_f32 v158, v158
    v_exp_f32 v159, v159
    s_sub_u32 s70, s70, 1
    s_cmp_lg_u32 s70, 0
    s_cbranch_scc1 L_AT_LOOP
    v_mov_b32 v252, 163584
    s_mov_b32 s72, 0
LW_31:
    ds_read_b32 v253, v252 offset:24
    s_waitcnt lgkmcnt(0)
    v_readfirstlane_b32 s77, v253
    s_add_u32 s72, s72, 1
    s_cmp_ge_u32 s77, 4
    s_cbranch_scc1 LWD_32
    s_sleep 1
    s_cmp_lt_u32 s72, 524288
    s_cbranch_scc1 LW_31
LWD_32:
    v_exp_f32 v128, v128
    v_exp_f32 v129, v129
    v_smfmac_f32_32x32x32_bf16 v[112:127], v[230:233], v[152:159], v242
    v_exp_f32 v130, v130
    v_exp_f32 v131, v131
    v_exp_f32 v132, v132
    v_mfma_f32_32x32x16_bf16 v[144:159], v[214:217], v[164:167], 0
    v_exp_f32 v133, v133
    v_exp_f32 v134, v134
    v_exp_f32 v135, v135
    v_mfma_f32_32x32x16_bf16 v[144:159], v[222:225], v[194:197], v[144:159]
    v_exp_f32 v136, v136
    v_exp_f32 v137, v137
    v_exp_f32 v138, v138
    v_exp_f32 v139, v139
    s_waitcnt vmcnt(2)
    v_smfmac_f32_32x32x32_bf16 v[0:15], v[234:237], v[128:135], v242
    v_exp_f32 v140, v140
    v_exp_f32 v141, v141
    v_exp_f32 v142, v142
    v_exp_f32 v143, v143
    v_exp_f32 v144, v144
    v_exp_f32 v145, v145
    v_smfmac_f32_32x32x32_bf16 v[0:15], v[238:241], v[136:143], v242
    v_exp_f32 v146, v146
    v_exp_f32 v147, v147
    v_exp_f32 v148, v148
    v_mfma_f32_32x32x16_bf16 v[128:143], v[214:217], v[168:171], 0
    v_exp_f32 v149, v149
    v_exp_f32 v150, v150
    v_exp_f32 v151, v151
    v_mfma_f32_32x32x16_bf16 v[128:143], v[222:225], v[196:199], v[128:143]
    v_exp_f32 v152, v152
    v_exp_f32 v153, v153
    v_exp_f32 v154, v154
    v_exp_f32 v155, v155
    v_smfmac_f32_32x32x32_bf16 v[16:31], v[234:237], v[144:151], v242
    v_exp_f32 v156, v156
    v_exp_f32 v157, v157
    ds_write_b128 v246, v[0:3] offset:0
    ds_write_b128 v246, v[4:7] offset:1024
    v_exp_f32 v158, v158
    v_exp_f32 v159, v159
    v_exp_f32 v128, v128
    v_exp_f32 v129, v129
    v_smfmac_f32_32x32x32_bf16 v[16:31], v[238:241], v[152:159], v242
    v_exp_f32 v130, v130
    v_exp_f32 v131, v131
    v_exp_f32 v132, v132
    v_mfma_f32_32x32x16_bf16 v[144:159], v[214:217], v[172:175], 0
    v_exp_f32 v133, v133
    v_exp_f32 v134, v134
    v_exp_f32 v135, v135
    v_mfma_f32_32x32x16_bf16 v[144:159], v[222:225], v[198:201], v[144:159]
    v_exp_f32 v136, v136
    v_exp_f32 v137, v137
    v_exp_f32 v138, v138
    v_exp_f32 v139, v139
    v_smfmac_f32_32x32x32_bf16 v[32:47], v[234:237], v[128:135], v242
    v_exp_f32 v140, v140
    v_exp_f32 v141, v141
    ds_write_b128 v246, v[16:19] offset:2560
    ds_write_b128 v246, v[20:23] offset:3584
    v_exp_f32 v142, v142
    v_exp_f32 v143, v143
    v_exp_f32 v144, v144
    v_exp_f32 v145, v145
    v_smfmac_f32_32x32x32_bf16 v[32:47], v[238:241], v[136:143], v242
    v_exp_f32 v146, v146
    v_exp_f32 v147, v147
    v_exp_f32 v148, v148
    v_mfma_f32_32x32x16_bf16 v[128:143], v[214:217], v[176:179], 0
    v_exp_f32 v149, v149
    v_exp_f32 v150, v150
    v_exp_f32 v151, v151
    v_mfma_f32_32x32x16_bf16 v[128:143], v[222:225], v[200:203], v[128:143]
    v_exp_f32 v152, v152
    v_exp_f32 v153, v153
    v_exp_f32 v154, v154
    v_exp_f32 v155, v155
    v_smfmac_f32_32x32x32_bf16 v[48:63], v[234:237], v[144:151], v242
    v_exp_f32 v156, v156
    v_exp_f32 v157, v157
    ds_write_b128 v247, v[32:35] offset:0
    ds_write_b128 v247, v[36:39] offset:1024
    v_exp_f32 v158, v158
    v_exp_f32 v159, v159
    v_exp_f32 v128, v128
    v_exp_f32 v129, v129
    v_smfmac_f32_32x32x32_bf16 v[48:63], v[238:241], v[152:159], v242
    v_exp_f32 v130, v130
    v_exp_f32 v131, v131
    v_exp_f32 v132, v132
    v_mfma_f32_32x32x16_bf16 v[144:159], v[214:217], v[180:183], 0
    v_exp_f32 v133, v133
    v_exp_f32 v134, v134
    v_exp_f32 v135, v135
    v_mfma_f32_32x32x16_bf16 v[144:159], v[222:225], v[202:205], v[144:159]
    v_exp_f32 v136, v136
    v_exp_f32 v137, v137
    v_exp_f32 v138, v138
    v_exp_f32 v139, v139
    v_smfmac_f32_32x32x32_bf16 v[64:79], v[234:237], v[128:135], v242
    v_exp_f32 v140, v140
    v_exp_f32 v141, v141
    ds_write_b128 v247, v[48:51] offset:2560
    ds_write_b128 v247, v[52:55] offset:3584
    v_exp_f32 v142, v142
    v_exp_f32 v143, v143
    v_exp_f32 v144, v144
    v_exp_f32 v145, v145
    v_smfmac_f32_32x32x32_bf16 v[64:79], v[238:241], v[136:143], v242
    v_exp_f32 v146, v146
    v_exp_f32 v147, v147
    v_exp_f32 v148, v148
    v_mfma_f32_32x32x16_bf16 v[128:143], v[214:217], v[184:187], 0
    v_exp_f32 v149, v149
    v_exp_f32 v150, v150
    v_exp_f32 v151, v151
    v_mfma_f32_32x32x16_bf16 v[128:143], v[222:225], v[204:207], v[128:143]
    v_exp_f32 v152, v152
    v_exp_f32 v153, v153
    v_exp_f32 v154, v154
    v_exp_f32 v155, v155
    v_smfmac_f32_32x32x32_bf16 v[80:95], v[234:237], v[144:151], v242
    v_exp_f32 v156, v156
    v_exp_f32 v157, v157
    ds_write_b128 v248, v[64:67] offset:0
    ds_write_b128 v248, v[68:71] offset:1024
    v_exp_f32 v158, v158
    v_exp_f32 v159, v159
    v_exp_f32 v128, v128
    v_exp_f32 v129, v129
    v_smfmac_f32_32x32x32_bf16 v[80:95], v[238:241], v[152:159], v242
    v_exp_f32 v130, v130
    v_exp_f32 v131, v131
    v_exp_f32 v132, v132
    v_mfma_f32_32x32x16_bf16 v[144:159], v[214:217], v[188:191], 0
    v_exp_f32 v133, v133
    v_exp_f32 v134, v134
    v_exp_f32 v135, v135
    v_mfma_f32_32x32x16_bf16 v[144:159], v[222:225], v[206:209], v[144:159]
    v_exp_f32 v136, v136
    v_exp_f32 v137, v137
    v_exp_f32 v138, v138
    v_exp_f32 v139, v139
    v_smfmac_f32_32x32x32_bf16 v[96:111], v[234:237], v[128:135], v242
    v_exp_f32 v140, v140
    v_exp_f32 v141, v141
    ds_write_b128 v248, v[80:83] offset:2560
    ds_write_b128 v248, v[84:87] offset:3584
    v_exp_f32 v142, v142
    v_exp_f32 v143, v143
    v_exp_f32 v144, v144
    v_exp_f32 v145, v145
    v_smfmac_f32_32x32x32_bf16 v[96:111], v[238:241], v[136:143], v242
    v_exp_f32 v146, v146
    v_exp_f32 v147, v147
    v_exp_f32 v148, v148
    v_exp_f32 v149, v149
    v_exp_f32 v150, v150
    v_exp_f32 v151, v151
    v_exp_f32 v152, v152
    v_exp_f32 v153, v153
    v_exp_f32 v154, v154
    v_exp_f32 v155, v155
    v_smfmac_f32_32x32x32_bf16 v[112:127], v[234:237], v[144:151], v242
    v_exp_f32 v156, v156
    v_exp_f32 v157, v157
    v_exp_f32 v158, v158
    v_exp_f32 v159, v159
    s_nop 1
    v_smfmac_f32_32x32x32_bf16 v[112:127], v[238:241], v[152:159], v242
    s_mov_b32 exec_hi, 0
    ds_write_b128 v246, v[8:11] offset:2048
    ds_write_b128 v246, v[24:27] offset:4608
    ds_write_b128 v247, v[40:43] offset:2048
    ds_write_b128 v247, v[56:59] offset:4608
    ds_write_b128 v248, v[72:75] offset:2048
    ds_write_b128 v248, v[88:91] offset:4608
    s_mov_b64 exec, -1
    v_add_f32 v128, v10, v26
    v_add_f32 v129, v42, v58
    v_add_f32 v130, v74, v90
    v_min3_f32 v131, v10, v26, v42
    v_min3_f32 v132, v58, v74, v90
    v_add_f32 v128, v128, v129
    v_add_f32 v130, v130, v106
    v_min3_f32 v131, v131, v132, v106
    v_add_f32 v128, v128, v130
    v_add_f32 v128, v128, v122
    v_min_f32 v131, v131, v122
    v_cmp_nge_f32 vcc, 0x53800000, v128
    v_mov_b32 v129, 0x1f800000
    s_mov_b32 s79, vcc_lo
    v_cmp_nge_f32 vcc, v131, v129
    s_nop 1
    s_or_b32 s79, s79, vcc_lo
    s_cmp_lg_u32 s79, 0
    s_cselect_b32 s79, 0x10001, 1
    s_waitcnt lgkmcnt(0)
    v_mov_b32 v128, 163584
    v_mov_b32 v129, s79
    s_mov_b64 exec, 1
    ds_add_u32 v128, v129 offset:32
    s_mov_b64 exec, -1
    s_mul_i32 s77, s67, 15360
    s_add_u32 s77, s77, 92160
    v_lshl_add_u32 v246, v250, 4, s77
    s_lshl_b32 s80, s73, 2
    s_add_u32 s80, s80, 4
    v_mov_b32 v128, 163584
    s_mov_b32 s72, 0
LW_33:
    ds_read_b32 v129, v128 offset:32
    s_waitcnt lgkmcnt(0)
    v_readfirstlane_b32 s79, v129
    s_add_u32 s72, s72, 1
    s_and_b32 s78, s79, 0xffff
    s_cmp_ge_u32 s78, s80
    s_cbranch_scc1 LWD_34
    s_sleep 1
    s_cmp_lt_u32 s72, 524288
    s_cbranch_scc1 LW_33
LWD_34:
    s_cmp_lg_u32 s73, 0
    s_cbranch_scc1 L_SAFE
    s_cmp_ge_u32 s79, 0x10000
    s_cbranch_scc1 L_FALLBACK
L_SAFE:
    ds_read_b128 v[0:3], v246 offset:0
    ds_read_b128 v[4:7], v246 offset:1024
    ds_read_b128 v[8:11], v246 offset:2048
    ds_read_b128 v[12:15], v246 offset:5120
    ds_read_b128 v[16:19], v246 offset:6144
    ds_read_b128 v[20:23], v246 offset:7168
    ds_read_b128 v[24:27], v246 offset:10240
    ds_read_b128 v[28:31], v246 offset:11264
    ds_read_b128 v[32:35], v246 offset:12288
    ds_read_b128 v[36:39], v246 offset:2560
    ds_read_b128 v[40:43], v246 offset:3584
    ds_read_b128 v[44:47], v246 offset:4608
    ds_read_b128 v[48:51], v246 offset:7680
    ds_read_b128 v[52:55], v246 offset:8704
    ds_read_b128 v[56:59], v246 offset:9728
    ds_read_b128 v[60:63], v246 offset:12800
    ds_read_b128 v[64:67], v246 offset:13824
    ds_read_b128 v[68:71], v246 offset:14848
    s_waitcnt lgkmcnt(15)
    v_add_f32 v106, v106, v10
    v_pk_add_f32 v[96:97], v[96:97], v[0:1]
    v_pk_add_f32 v[98:99], v[98:99], v[2:3]
    v_pk_add_f32 v[100:101], v[100:101], v[4:5]
    v_pk_add_f32 v[102:103], v[102:103], v[6:7]
    v_pk_add_f32 v[104:105], v[104:105], v[8:9]
    s_waitcnt lgkmcnt(12)
    v_add_f32 v106, v106, v22
    v_pk_add_f32 v[96:97], v[96:97], v[12:13]
    v_pk_add_f32 v[98:99], v[98:99], v[14:15]
    v_pk_add_f32 v[100:101], v[100:101], v[16:17]
    v_pk_add_f32 v[102:103], v[102:103], v[18:19]
    v_pk_add_f32 v[104:105], v[104:105], v[20:21]
    s_waitcnt lgkmcnt(9)
    v_add_f32 v106, v106, v34
    v_pk_add_f32 v[96:97], v[96:97], v[24:25]
    v_pk_add_f32 v[98:99], v[98:99], v[26:27]
    v_pk_add_f32 v[100:101], v[100:101], v[28:29]
    v_pk_add_f32 v[102:103], v[102:103], v[30:31]
    v_pk_add_f32 v[104:105], v[104:105], v[32:33]
    v_mov_b32 v128, v106
    v_mov_b32 v129, v106
    s_nop 1
    v_permlane32_swap_b32 v128, v129
    s_nop 1
    v_mul_f32 v128, s71, v128
    v_rcp_f32 v128, v128
    s_nop 0
    v_pk_mul_f32 v[96:97], v[96:97], v[128:129] op_sel_hi:[1,0]
    v_pk_mul_f32 v[98:99], v[98:99], v[128:129] op_sel_hi:[1,0]
    v_pk_mul_f32 v[100:101], v[100:101], v[128:129] op_sel_hi:[1,0]
    v_pk_mul_f32 v[102:103], v[102:103], v[128:129] op_sel_hi:[1,0]
    v_pk_mul_f32 v[104:105], v[104:105], v[128:129] op_sel_hi:[1,0]
    v_cvt_pk_bf16_f32 v132, v96, v97
    v_cvt_pk_bf16_f32 v133, v98, v99
    v_cvt_pk_bf16_f32 v134, v100, v101
    v_cvt_pk_bf16_f32 v135, v102, v103
    v_cvt_pk_bf16_f32 v136, v104, v105
    v_min_u32 v132, -2, v132
    v_min_u32 v133, -2, v133
    v_min_u32 v134, -2, v134
    v_min_u32 v135, -2, v135
    v_min_u32 v136, -2, v136
    buffer_store_dwordx4 v[132:135], v249, s[52:55], 0 offen offset:0 sc1
    s_mov_b32 exec_hi, 0
    buffer_store_dword v136, v251, s[52:55], 0 offen offset:0 sc1
    s_mov_b64 exec, -1
    s_waitcnt lgkmcnt(6)
    v_add_f32 v122, v122, v46
    v_pk_add_f32 v[112:113], v[112:113], v[36:37]
    v_pk_add_f32 v[114:115], v[114:115], v[38:39]
    v_pk_add_f32 v[116:117], v[116:117], v[40:41]
    v_pk_add_f32 v[118:119], v[118:119], v[42:43]
    v_pk_add_f32 v[120:121], v[120:121], v[44:45]
    s_waitcnt lgkmcnt(3)
    v_add_f32 v122, v122, v58
    v_pk_add_f32 v[112:113], v[112:113], v[48:49]
    v_pk_add_f32 v[114:115], v[114:115], v[50:51]
    v_pk_add_f32 v[116:117], v[116:117], v[52:53]
    v_pk_add_f32 v[118:119], v[118:119], v[54:55]
    v_pk_add_f32 v[120:121], v[120:121], v[56:57]
    s_waitcnt lgkmcnt(0)
    v_add_f32 v122, v122, v70
    v_pk_add_f32 v[112:113], v[112:113], v[60:61]
    v_pk_add_f32 v[114:115], v[114:115], v[62:63]
    v_pk_add_f32 v[116:117], v[116:117], v[64:65]
    v_pk_add_f32 v[118:119], v[118:119], v[66:67]
    v_pk_add_f32 v[120:121], v[120:121], v[68:69]
    v_mov_b32 v128, v122
    v_mov_b32 v129, v122
    s_nop 1
    v_permlane32_swap_b32 v128, v129
    s_nop 1
    v_mul_f32 v128, s71, v128
    v_rcp_f32 v128, v128
    s_nop 0
    v_pk_mul_f32 v[112:113], v[112:113], v[128:129] op_sel_hi:[1,0]
    v_pk_mul_f32 v[114:115], v[114:115], v[128:129] op_sel_hi:[1,0]
    v_pk_mul_f32 v[116:117], v[116:117], v[128:129] op_sel_hi:[1,0]
    v_pk_mul_f32 v[118:119], v[118:119], v[128:129] op_sel_hi:[1,0]
    v_pk_mul_f32 v[120:121], v[120:121], v[128:129] op_sel_hi:[1,0]
    v_cvt_pk_bf16_f32 v140, v112, v113
    v_cvt_pk_bf16_f32 v141, v114, v115
    v_cvt_pk_bf16_f32 v142, v116, v117
    v_cvt_pk_bf16_f32 v143, v118, v119
    v_cvt_pk_bf16_f32 v144, v120, v121
    v_min_u32 v140, -2, v140
    v_min_u32 v141, -2, v141
    v_min_u32 v142, -2, v142
    v_min_u32 v143, -2, v143
    v_min_u32 v144, -2, v144
    buffer_store_dwordx4 v[140:143], v249, s[52:55], 0 offen offset:512 sc1
    s_mov_b32 exec_hi, 0
    buffer_store_dword v144, v251, s[52:55], 0 offen offset:512 sc1
    s_mov_b64 exec, -1
    v_mov_b32 v128, 163584
    v_mov_b32 v129, 1
    s_mov_b64 exec, 1
    ds_add_u32 v128, v129 offset:36
    s_mov_b64 exec, -1
    s_branch L_FIN
L_FALLBACK:
    s_mov_b32 s73, 1
    s_mov_b32 s74, 0
    s_mov_b32 s70, 0
    v_mov_b32 v0, 0xff800000
    v_mov_b32 v1, 0xff800000
    v_mov_b32 v2, 0xff800000
    v_mov_b32 v3, 0xff800000
    v_mov_b32 v4, 0xff800000
    v_mov_b32 v5, 0xff800000
    v_mov_b32 v6, 0xff800000
    v_mov_b32 v7, 0xff800000
L_FB_LOOP:
    buffer_load_dwordx4 v[210:213], v243, s[52:55], s74 offen sc1
    buffer_load_dword v218, v244, s[52:55], s74 offen offset:1024 sc1
    s_add_u32 s74, s74, 2304
    s_waitcnt vmcnt(0)
    v_mfma_f32_32x32x16_bf16 v[128:143], v[210:213], v[160:163], 0
    v_mfma_f32_32x32x16_bf16 v[128:143], v[218:221], v[192:195], v[128:143]
    s_nop 11
    v_max3_f32 v0, v0, v128, v129
    v_max3_f32 v0, v0, v130, v131
    v_max3_f32 v0, v0, v132, v133
    v_max3_f32 v0, v0, v134, v135
    v_max3_f32 v0, v0, v136, v137
    v_max3_f32 v0, v0, v138, v139
    v_max3_f32 v0, v0, v140, v141
    v_max3_f32 v0, v0, v142, v143
    v_mfma_f32_32x32x16_bf16 v[128:143], v[210:213], v[164:167], 0
    v_mfma_f32_32x32x16_bf16 v[128:143], v[218:221], v[194:197], v[128:143]
    s_nop 11
    v_max3_f32 v1, v1, v128, v129
    v_max3_f32 v1, v1, v130, v131
    v_max3_f32 v1, v1, v132, v133
    v_max3_f32 v1, v1, v134, v135
    v_max3_f32 v1, v1, v136, v137
    v_max3_f32 v1, v1, v138, v139
    v_max3_f32 v1, v1, v140, v141
    v_max3_f32 v1, v1, v142, v143
    v_mfma_f32_32x32x16_bf16 v[128:143], v[210:213], v[168:171], 0
    v_mfma_f32_32x32x16_bf16 v[128:143], v[218:221], v[196:199], v[128:143]
    s_nop 11
    v_max3_f32 v2, v2, v128, v129
    v_max3_f32 v2, v2, v130, v131
    v_max3_f32 v2, v2, v132, v133
    v_max3_f32 v2, v2, v134, v135
    v_max3_f32 v2, v2, v136, v137
    v_max3_f32 v2, v2, v138, v139
    v_max3_f32 v2, v2, v140, v141
    v_max3_f32 v2, v2, v142, v143
    v_mfma_f32_32x32x16_bf16 v[128:143], v[210:213], v[172:175], 0
    v_mfma_f32_32x32x16_bf16 v[128:143], v[218:221], v[198:201], v[128:143]
    s_nop 11
    v_max3_f32 v3, v3, v128, v129
    v_max3_f32 v3, v3, v130, v131
    v_max3_f32 v3, v3, v132, v133
    v_max3_f32 v3, v3, v134, v135
    v_max3_f32 v3, v3, v136, v137
    v_max3_f32 v3, v3, v138, v139
    v_max3_f32 v3, v3, v140, v141
    v_max3_f32 v3, v3, v142, v143
    v_mfma_f32_32x32x16_bf16 v[128:143], v[210:213], v[176:179], 0
    v_mfma_f32_32x32x16_bf16 v[128:143], v[218:221], v[200:203], v[128:143]
    s_nop 11
    v_max3_f32 v4, v4, v128, v129
    v_max3_f32 v4, v4, v130, v131
    v_max3_f32 v4, v4, v132, v133
    v_max3_f32 v4, v4, v134, v135
    v_max3_f32 v4, v4, v136, v137
    v_max3_f32 v4, v4, v138, v139
    v_max3_f32 v4, v4, v140, v141
    v_max3_f32 v4, v4, v142, v143
    v_mfma_f32_32x32x16_bf16 v[128:143], v[210:213], v[180:183], 0
    v_mfma_f32_32x32x16_bf16 v[128:143], v[218:221], v[202:205], v[128:143]
    s_nop 11
    v_max3_f32 v5, v5, v128, v129
    v_max3_f32 v5, v5, v130, v131
    v_max3_f32 v5, v5, v132, v133
    v_max3_f32 v5, v5, v134, v135
    v_max3_f32 v5, v5, v136, v137
    v_max3_f32 v5, v5, v138, v139
    v_max3_f32 v5, v5, v140, v141
    v_max3_f32 v5, v5, v142, v143
    v_mfma_f32_32x32x16_bf16 v[128:143], v[210:213], v[184:187], 0
    v_mfma_f32_32x32x16_bf16 v[128:143], v[218:221], v[204:207], v[128:143]
    s_nop 11
    v_max3_f32 v6, v6, v128, v129
    v_max3_f32 v6, v6, v130, v131
    v_max3_f32 v6, v6, v132, v133
    v_max3_f32 v6, v6, v134, v135
    v_max3_f32 v6, v6, v136, v137
    v_max3_f32 v6, v6, v138, v139
    v_max3_f32 v6, v6, v140, v141
    v_max3_f32 v6, v6, v142, v143
    v_mfma_f32_32x32x16_bf16 v[128:143], v[210:213], v[188:191], 0
    v_mfma_f32_32x32x16_bf16 v[128:143], v[218:221], v[206:209], v[128:143]
    s_nop 11
    v_max3_f32 v7, v7, v128, v129
    v_max3_f32 v7, v7, v130, v131
    v_max3_f32 v7, v7, v132, v133
    v_max3_f32 v7, v7, v134, v135
    v_max3_f32 v7, v7, v136, v137
    v_max3_f32 v7, v7, v138, v139
    v_max3_f32 v7, v7, v140, v141
    v_max3_f32 v7, v7, v142, v143
    s_add_u32 s70, s70, 1
    s_cmp_lt_u32 s70, s100
    s_cbranch_scc1 L_FB_LOOP
    v_and_b32 v247, 31, v250
    v_mov_b32 v8, v0
    s_nop 1
    v_permlane32_swap_b32 v0, v8
    s_nop 1
    v_max_f32 v0, v0, v8
    s_lshl_b32 s77, s67, 1
    s_add_u32 s77, s77, 2
    s_and_b32 s77, s77, 7
    s_lshl_b32 s77, s77, 7
    s_add_u32 s77, s77, 153600
    v_lshl_add_u32 v16, v247, 2, s77
    s_lshl_b32 s78, s67, 10
    v_add_u32 v9, s78, v16
    ds_write_b32 v9, v0
    v_mov_b32 v8, v1
    s_nop 1
    v_permlane32_swap_b32 v1, v8
    s_nop 1
    v_max_f32 v1, v1, v8
    s_lshl_b32 s77, s67, 1
    s_add_u32 s77, s77, 3
    s_and_b32 s77, s77, 7
    s_lshl_b32 s77, s77, 7
    s_add_u32 s77, s77, 153600
    v_lshl_add_u32 v17, v247, 2, s77
    s_lshl_b32 s78, s67, 10
    v_add_u32 v9, s78, v17
    ds_write_b32 v9, v1
    v_mov_b32 v8, v2
    s_nop 1
    v_permlane32_swap_b32 v2, v8
    s_nop 1
    v_max_f32 v2, v2, v8
    s_lshl_b32 s77, s67, 1
    s_add_u32 s77, s77, 4
    s_and_b32 s77, s77, 7
    s_lshl_b32 s77, s77, 7
    s_add_u32 s77, s77, 153600
    v_lshl_add_u32 v18, v247, 2, s77
    s_lshl_b32 s78, s67, 10
    v_add_u32 v9, s78, v18
    ds_write_b32 v9, v2
    v_mov_b32 v8, v3
    s_nop 1
    v_permlane32_swap_b32 v3, v8
    s_nop 1
    v_max_f32 v3, v3, v8
    s_lshl_b32 s77, s67, 1
    s_add_u32 s77, s77, 5
    s_and_b32 s77, s77, 7
    s_lshl_b32 s77, s77, 7
    s_add_u32 s77, s77, 153600
    v_lshl_add_u32 v19, v247, 2, s77
    s_lshl_b32 s78, s67, 10
    v_add_u32 v9, s78, v19
    ds_write_b32 v9, v3
    v_mov_b32 v8, v4
    s_nop 1
    v_permlane32_swap_b32 v4, v8
    s_nop 1
    v_max_f32 v4, v4, v8
    s_lshl_b32 s77, s67, 1
    s_add_u32 s77, s77, 6
    s_and_b32 s77, s77, 7
    s_lshl_b32 s77, s77, 7
    s_add_u32 s77, s77, 153600
    v_lshl_add_u32 v20, v247, 2, s77
    s_lshl_b32 s78, s67, 10
    v_add_u32 v9, s78, v20
    ds_write_b32 v9, v4
    v_mov_b32 v8, v5
    s_nop 1
    v_permlane32_swap_b32 v5, v8
    s_nop 1
    v_max_f32 v5, v5, v8
    s_lshl_b32 s77, s67, 1
    s_add_u32 s77, s77, 7
    s_and_b32 s77, s77, 7
    s_lshl_b32 s77, s77, 7
    s_add_u32 s77, s77, 153600
    v_lshl_add_u32 v21, v247, 2, s77
    s_lshl_b32 s78, s67, 10
    v_add_u32 v9, s78, v21
    ds_write_b32 v9, v5
    v_mov_b32 v8, v6
    s_nop 1
    v_permlane32_swap_b32 v6, v8
    s_nop 1
    v_max_f32 v6, v6, v8
    s_lshl_b32 s77, s67, 1
    s_add_u32 s77, s77, 8
    s_and_b32 s77, s77, 7
    s_lshl_b32 s77, s77, 7
    s_add_u32 s77, s77, 153600
    v_lshl_add_u32 v22, v247, 2, s77
    s_lshl_b32 s78, s67, 10
    v_add_u32 v9, s78, v22
    ds_write_b32 v9, v6
    v_mov_b32 v8, v7
    s_nop 1
    v_permlane32_swap_b32 v7, v8
    s_nop 1
    v_max_f32 v7, v7, v8
    s_lshl_b32 s77, s67, 1
    s_add_u32 s77, s77, 9
    s_and_b32 s77, s77, 7
    s_lshl_b32 s77, s77, 7
    s_add_u32 s77, s77, 153600
    v_lshl_add_u32 v23, v247, 2, s77
    s_lshl_b32 s78, s67, 10
    v_add_u32 v9, s78, v23
    ds_write_b32 v9, v7
    s_waitcnt lgkmcnt(0)
    v_mov_b32 v128, 163584
    v_mov_b32 v129, 1
    s_mov_b64 exec, 1
    ds_add_u32 v128, v129 offset:44
    s_mov_b64 exec, -1
    v_mov_b32 v128, 163584
    s_mov_b32 s72, 0
LW_35:
    ds_read_b32 v129, v128 offset:44
    s_waitcnt lgkmcnt(0)
    v_readfirstlane_b32 s77, v129
    s_add_u32 s72, s72, 1
    s_cmp_ge_u32 s77, 4
    s_cbranch_scc1 LWD_36
    s_sleep 1
    s_cmp_lt_u32 s72, 524288
    s_cbranch_scc1 LW_35
LWD_36:
    s_mov_b32 exec_hi, 0
    ds_read_b32 v8, v16 offset:0
    ds_read_b32 v9, v16 offset:1024
    ds_read_b32 v10, v16 offset:2048
    ds_read_b32 v11, v16 offset:3072
    s_waitcnt lgkmcnt(0)
    v_max3_f32 v8, v8, v9, v10
    v_max_f32 v8, v8, v11
    v_cvt_pk_bf16_f32 v9, v8, v8
    v_and_b32 v9, 0xffff0000, v9
    v_sub_f32 v10, v8, v9
    v_cvt_pk_bf16_f32 v193, -v9, -v10
    ds_read_b32 v8, v17 offset:0
    ds_read_b32 v9, v17 offset:1024
    ds_read_b32 v10, v17 offset:2048
    ds_read_b32 v11, v17 offset:3072
    s_waitcnt lgkmcnt(0)
    v_max3_f32 v8, v8, v9, v10
    v_max_f32 v8, v8, v11
    v_cvt_pk_bf16_f32 v9, v8, v8
    v_and_b32 v9, 0xffff0000, v9
    v_sub_f32 v10, v8, v9
    v_cvt_pk_bf16_f32 v195, -v9, -v10
    ds_read_b32 v8, v18 offset:0
    ds_read_b32 v9, v18 offset:1024
    ds_read_b32 v10, v18 offset:2048
    ds_read_b32 v11, v18 offset:3072
    s_waitcnt lgkmcnt(0)
    v_max3_f32 v8, v8, v9, v10
    v_max_f32 v8, v8, v11
    v_cvt_pk_bf16_f32 v9, v8, v8
    v_and_b32 v9, 0xffff0000, v9
    v_sub_f32 v10, v8, v9
    v_cvt_pk_bf16_f32 v197, -v9, -v10
    ds_read_b32 v8, v19 offset:0
    ds_read_b32 v9, v19 offset:1024
    ds_read_b32 v10, v19 offset:2048
    ds_read_b32 v11, v19 offset:3072
    s_waitcnt lgkmcnt(0)
    v_max3_f32 v8, v8, v9, v10
    v_max_f32 v8, v8, v11
    v_cvt_pk_bf16_f32 v9, v8, v8
    v_and_b32 v9, 0xffff0000, v9
    v_sub_f32 v10, v8, v9
    v_cvt_pk_bf16_f32 v199, -v9, -v10
    ds_read_b32 v8, v20 offset:0
    ds_read_b32 v9, v20 offset:1024
    ds_read_b32 v10, v20 offset:2048
    ds_read_b32 v11, v20 offset:3072
    s_waitcnt lgkmcnt(0)
    v_max3_f32 v8, v8, v9, v10
    v_max_f32 v8, v8, v11
    v_cvt_pk_bf16_f32 v9, v8, v8
    v_and_b32 v9, 0xffff0000, v9
    v_sub_f32 v10, v8, v9
    v_cvt_pk_bf16_f32 v201, -v9, -v10
    ds_read_b32 v8, v21 offset:0
    ds_read_b32 v9, v21 offset:1024
    ds_read_b32 v10, v21 offset:2048
    ds_read_b32 v11, v21 offset:3072
    s_waitcnt lgkmcnt(0)
    v_max3_f32 v8, v8, v9, v10
    v_max_f32 v8, v8, v11
    v_cvt_pk_bf16_f32 v9, v8, v8
    v_and_b32 v9, 0xffff0000, v9
    v_sub_f32 v10, v8, v9
    v_cvt_pk_bf16_f32 v203, -v9, -v10
    ds_read_b32 v8, v22 offset:0
    ds_read_b32 v9, v22 offset:1024
    ds_read_b32 v10, v22 offset:2048
    ds_read_b32 v11, v22 offset:3072
    s_waitcnt lgkmcnt(0)
    v_max3_f32 v8, v8, v9, v10
    v_max_f32 v8, v8, v11
    v_cvt_pk_bf16_f32 v9, v8, v8
    v_and_b32 v9, 0xffff0000, v9
    v_sub_f32 v10, v8, v9
    v_cvt_pk_bf16_f32 v205, -v9, -v10
    ds_read_b32 v8, v23 offset:0
    ds_read_b32 v9, v23 offset:1024
    ds_read_b32 v10, v23 offset:2048
    ds_read_b32 v11, v23 offset:3072
    s_waitcnt lgkmcnt(0)
    v_max3_f32 v8, v8, v9, v10
    v_max_f32 v8, v8, v11
    v_cvt_pk_bf16_f32 v9, v8, v8
    v_and_b32 v9, 0xffff0000, v9
    v_sub_f32 v10, v8, v9
    v_cvt_pk_bf16_f32 v207, -v9, -v10
    s_mov_b64 exec, -1
    v_mov_b32 v0, 0
    v_mov_b32 v1, 0
    v_mov_b32 v2, 0
    v_mov_b32 v3, 0
    v_mov_b32 v4, 0
    v_mov_b32 v5, 0
    v_mov_b32 v6, 0
    v_mov_b32 v7, 0
    v_mov_b32 v8, 0
    v_mov_b32 v9, 0
    v_mov_b32 v10, 0
    v_mov_b32 v11, 0
    v_mov_b32 v12, 0
    v_mov_b32 v13, 0
    v_mov_b32 v14, 0
    v_mov_b32 v15, 0
    v_mov_b32 v16, 0
    v_mov_b32 v17, 0
    v_mov_b32 v18, 0
    v_mov_b32 v19, 0
    v_mov_b32 v20, 0
    v_mov_b32 v21, 0
    v_mov_b32 v22, 0
    v_mov_b32 v23, 0
    v_mov_b32 v24, 0
    v_mov_b32 v25, 0
    v_mov_b32 v26, 0
    v_mov_b32 v27, 0
    v_mov_b32 v28, 0
    v_mov_b32 v29, 0
    v_mov_b32 v30, 0
    v_mov_b32 v31, 0
    v_mov_b32 v32, 0
    v_mov_b32 v33, 0
    v_mov_b32 v34, 0
    v_mov_b32 v35, 0
    v_mov_b32 v36, 0
    v_mov_b32 v37, 0
    v_mov_b32 v38, 0
    v_mov_b32 v39, 0
    v_mov_b32 v40, 0
    v_mov_b32 v41, 0
    v_mov_b32 v42, 0
    v_mov_b32 v43, 0
    v_mov_b32 v44, 0
    v_mov_b32 v45, 0
    v_mov_b32 v46, 0
    v_mov_b32 v47, 0
    v_mov_b32 v48, 0
    v_mov_b32 v49, 0
    v_mov_b32 v50, 0
    v_mov_b32 v51, 0
    v_mov_b32 v52, 0
    v_mov_b32 v53, 0
    v_mov_b32 v54, 0
    v_mov_b32 v55, 0
    v_mov_b32 v56, 0
    v_mov_b32 v57, 0
    v_mov_b32 v58, 0
    v_mov_b32 v59, 0
    v_mov_b32 v60, 0
    v_mov_b32 v61, 0
    v_mov_b32 v62, 0
    v_mov_b32 v63, 0
    v_mov_b32 v64, 0
    v_mov_b32 v65, 0
    v_mov_b32 v66, 0
    v_mov_b32 v67, 0
    v_mov_b32 v68, 0
    v_mov_b32 v69, 0
    v_mov_b32 v70, 0
    v_mov_b32 v71, 0
    v_mov_b32 v72, 0
    v_mov_b32 v73, 0
    v_mov_b32 v74, 0
    v_mov_b32 v75, 0
    v_mov_b32 v76, 0
    v_mov_b32 v77, 0
    v_mov_b32 v78, 0
    v_mov_b32 v79, 0
    v_mov_b32 v80, 0
    v_mov_b32 v81, 0
    v_mov_b32 v82, 0
    v_mov_b32 v83, 0
    v_mov_b32 v84, 0
    v_mov_b32 v85, 0
    v_mov_b32 v86, 0
    v_mov_b32 v87, 0
    v_mov_b32 v88, 0
    v_mov_b32 v89, 0
    v_mov_b32 v90, 0
    v_mov_b32 v91, 0
    v_mov_b32 v92, 0
    v_mov_b32 v93, 0
    v_mov_b32 v94, 0
    v_mov_b32 v95, 0
    v_mov_b32 v96, 0
    v_mov_b32 v97, 0
    v_mov_b32 v98, 0
    v_mov_b32 v99, 0
    v_mov_b32 v100, 0
    v_mov_b32 v101, 0
    v_mov_b32 v102, 0
    v_mov_b32 v103, 0
    v_mov_b32 v104, 0
    v_mov_b32 v105, 0
    v_mov_b32 v106, 0
    v_mov_b32 v107, 0
    v_mov_b32 v108, 0
    v_mov_b32 v109, 0
    v_mov_b32 v110, 0
    v_mov_b32 v111, 0
    v_mov_b32 v112, 0
    v_mov_b32 v113, 0
    v_mov_b32 v114, 0
    v_mov_b32 v115, 0
    v_mov_b32 v116, 0
    v_mov_b32 v117, 0
    v_mov_b32 v118, 0
    v_mov_b32 v119, 0
    v_mov_b32 v120, 0
    v_mov_b32 v121, 0
    v_mov_b32 v122, 0
    v_mov_b32 v123, 0
    v_mov_b32 v124, 0
    v_mov_b32 v125, 0
    v_mov_b32 v126, 0
    v_mov_b32 v127, 0
    v_mov_b32 v152, 0
    v_mov_b32 v153, 0
    v_mov_b32 v154, 0
    v_mov_b32 v155, 0
    v_mov_b32 v156, 0
    v_mov_b32 v157, 0
    v_mov_b32 v158, 0
    v_mov_b32 v159, 0
    s_branch L_PASS
L_FIN:
L_END:
    s_endpgm
.section .rodata,"a"
.p2align 6
.amdhsa_kernel parallel_sum__grouped_kv_mqa__dense_activation_silu__prompt_kernel
  .amdhsa_next_free_vgpr 256
  .amdhsa_next_free_sgpr 102
  .amdhsa_accum_offset 256
  .amdhsa_group_segment_fixed_size 0
  .amdhsa_kernarg_size 88
  .amdhsa_user_sgpr_count 2
  .amdhsa_user_sgpr_kernarg_segment_ptr 1
  .amdhsa_system_sgpr_workgroup_id_x 1
.end_amdhsa_kernel
```
